```python
import torch

def _softmax(x, axis=-1):
    return torch.softmax(x, dim=axis)
def _gelu(x):
    return torch.nn.functional.gelu(x, approximate="tanh")
def _silu(x):
    return torch.nn.functional.silu(x)
def _sigmoid(x):
    return torch.sigmoid(x)
def _layernorm(x, axis=-1, eps=1e-5):
    m = x.mean(dim=axis, keepdim=True)
    v = x.var(dim=axis, keepdim=True, unbiased=False)
    return (x - m) / torch.sqrt(v + eps)
def _scatter_add(tgt, idx, src, axis=0):
    return tgt.clone().index_add_(axis, idx, src)
def _segment_sum(src, seg, n):
    out = torch.zeros((n,) + src.shape[1:], dtype=src.dtype)
    return out.index_add_(0, seg, src)
def _pad(x, pw):
    flat = tuple(v for pair in reversed(pw) for v in pair)
    return torch.nn.functional.pad(x, flat)

kernel_name = 'sequential_preLN__sliding_block__glu_gated_swiglu__prompt'

def setup_inputs():

    _w = (lambda a: (lambda t: t.to(torch.bfloat16) if t.is_floating_point() else t)(torch.as_tensor(a)))
    def _A_setup():
        B, S, D = 1, 2048, 512
        return {
            "x": _w((lambda *s: torch.randn(*s, dtype=torch.bfloat16) * 0.05)(B, S, D)),
            "wqkv": _w((lambda *s: torch.randn(*s, dtype=torch.bfloat16) * 0.05)(D, 3 * D)),
            "wo": _w((lambda *s: torch.randn(*s, dtype=torch.bfloat16) * 0.05)(D, D)),
        }
    _A_in = _A_setup()

    def _B_setup():
        B, S, D, F = 1, 2048, 512, 1792
        return {
            "x": _w((lambda *s: torch.randn(*s, dtype=torch.bfloat16) * 0.05)(B, S, D)),
            "w1": _w((lambda *s: torch.randn(*s, dtype=torch.bfloat16) * 0.8)(D, F) * (2.0 / D) ** 0.5),
            "w3": _w((lambda *s: torch.randn(*s, dtype=torch.bfloat16) * 0.8)(D, F) * (2.0 / D) ** 0.5),
            "w2": _w((lambda *s: torch.randn(*s, dtype=torch.bfloat16) * 0.8)(F, D) * (2.0 / F) ** 0.5),
        }
    _B_in = _B_setup()

    return {
        "A_x": _A_in["x"],
        "A_wqkv": _A_in["wqkv"],
        "A_wo": _A_in["wo"],
        "B_x": _B_in["x"],
        "B_w1": _B_in["w1"],
        "B_w3": _B_in["w3"],
        "B_w2": _B_in["w2"],
    }

def reference(A_x, A_wqkv, A_wo, B_x, B_w1, B_w3, B_w2):
    def _A_ref(x, wqkv, wo):
        B, S, D = x.shape
        H = 32; Dh = D // H; W = 256
        qkv = (lambda x, *d: x.permute(*d))((x @ wqkv).reshape(B, S, 3, H, Dh), 2, 0, 3, 1, 4)
        q, k, v = qkv[0], qkv[1], qkv[2]
        scores = torch.einsum("bhqd,bhkd->bhqk", q, k) * (Dh ** -0.5)
        idx = torch.arange(S)
        mask = (idx[:, None] - idx[None, :] >= 0) & (idx[:, None] - idx[None, :] < W)
        scores = torch.where(mask[None, None], scores, -1e9)
        p = _softmax(scores, axis=-1)
        o = torch.einsum("bhqk,bhkd->bhqd", p, v)
        return (lambda x, *d: x.permute(*d))(o, 0, 2, 1, 3).reshape(B, S, D) @ wo

    def _B_ref(x, w1, w3, w2):
        gate = torch.einsum("bsd,df->bsf", x, w1)
        up = torch.einsum("bsd,df->bsf", x, w3)
        h = _silu(gate) * up
        out = torch.einsum("bsf,fd->bsd", h, w2)
        return out

    x = A_x
    h = x + _A_ref(_layernorm(x, axis=-1), A_wqkv, A_wo)
    h2 = h + _B_ref(_layernorm(h, axis=-1), B_w1, B_w3, B_w2)
    return h2
```

```asm
; @launch kernel=k1_qkv_kernel grid=(256,1,1) block=(256,1,1) lds=144384
; @launch kernel=k2_mega_kernel grid=(256,1,1) block=(256,1,1) lds=163840
.amdgcn_target "amdgcn-amd-amdhsa--gfx950"
.text
.globl k1_qkv_kernel
.p2align 8
.type k1_qkv_kernel,@function
k1_qkv_kernel:
    s_cmp_ge_u32 s2, 256
    s_cbranch_scc1 L_end_k1_qkv_kernel
    s_load_dwordx16 s[64:79], s[0:1], 0
    s_load_dwordx4 s[80:83], s[0:1], 64
    v_and_b32 v1, 63, v0
    v_lshrrev_b32 v2, 6, v0
    s_nop 0
    v_readfirstlane_b32 s3, v2
    s_lshr_b32 s22, s2, 3
    s_and_b32 s20, s2, 3
    s_lshl_b32 s20, s20, 2
    s_and_b32 s23, s22, 3
    s_add_u32 s20, s20, s23
    s_bfe_u32 s21, s2, 0x10002
    s_lshl_b32 s21, s21, 3
    s_lshr_b32 s23, s22, 2
    s_add_u32 s21, s21, s23
    s_and_b32 s16, s22, 3
    s_lshl_b32 s16, s16, 1
    s_add_u32 s16, s16, s23
    s_lshl_b32 s22, s20, 7
    s_lshl_b32 s23, s3, 5
    s_add_u32 s22, s22, s23
    v_and_b32 v3, 15, v1
    v_lshrrev_b32 v4, 4, v1
    v_bfe_u32 v9, v1, 2, 2
    s_add_u32 s40, s3, 0
    s_add_u32 s41, s3, 1
    s_add_u32 s42, s3, 2
    s_add_u32 s43, s3, 3
    s_cmp_ge_u32 s43, 6
    s_cselect_b32 s26, 6, 0
    s_sub_u32 s43, s43, s26
    s_add_u32 s44, s3, 4
    s_cmp_ge_u32 s44, 6
    s_cselect_b32 s26, 6, 0
    s_sub_u32 s44, s44, s26
    s_add_u32 s45, s3, 5
    s_cmp_ge_u32 s45, 6
    s_cselect_b32 s26, 6, 0
    s_sub_u32 s45, s45, s26
    v_lshrrev_b32 v10, 3, v1
    v_and_b32 v11, 7, v1
    v_xor_b32 v11, v11, v10
    v_lshlrev_b32 v10, 10, v10
    v_lshl_add_u32 v5, v11, 4, v10
    s_lshl_b32 s30, s22, 10
    s_lshl_b32 s31, s3, 12
    s_mul_i32 s24, s3, 192
    v_add_u32 v10, s24, v1
    v_add_u32 v11, 0, v10
    v_mul_u32_u24 v12, 5462, v11
    v_lshrrev_b32 v12, 16, v12
    v_mul_u32_u24 v13, 12, v12
    v_sub_u32 v13, v11, v13
    v_bfe_u32 v14, v12, 3, 1
    v_lshlrev_b32 v14, 1, v14
    v_xor_b32 v13, v13, v14
    v_mul_u32_u24 v14, 3072, v12
    v_lshl_add_u32 v16, v13, 4, v14
    v_add_u32 v11, 64, v10
    v_mul_u32_u24 v12, 5462, v11
    v_lshrrev_b32 v12, 16, v12
    v_mul_u32_u24 v13, 12, v12
    v_sub_u32 v13, v11, v13
    v_bfe_u32 v14, v12, 3, 1
    v_lshlrev_b32 v14, 1, v14
    v_xor_b32 v13, v13, v14
    v_mul_u32_u24 v14, 3072, v12
    v_lshl_add_u32 v17, v13, 4, v14
    v_add_u32 v11, 128, v10
    v_mul_u32_u24 v12, 5462, v11
    v_lshrrev_b32 v12, 16, v12
    v_mul_u32_u24 v13, 12, v12
    v_sub_u32 v13, v11, v13
    v_bfe_u32 v14, v12, 3, 1
    v_lshlrev_b32 v14, 1, v14
    v_xor_b32 v13, v13, v14
    v_mul_u32_u24 v14, 3072, v12
    v_lshl_add_u32 v18, v13, 4, v14
    s_mul_i32 s24, s21, 192
    s_mul_i32 s25, s3, 3072
    v_add_u32 v10, s22, v3
    v_lshlrev_b32 v7, 5, v10
    v_bfe_u32 v10, v1, 4, 1
    v_lshl_add_u32 v7, v10, 9, v7
    v_bfe_u32 v10, v1, 5, 1
    v_lshl_add_u32 v7, v10, 4, v7
    v_and_b32 v10, 7, v1
    v_xor_b32 v10, v10, v4
    v_lshlrev_b32 v11, 7, v3
    v_lshl_add_u32 v11, v10, 4, v11
    v_add_u32 v19, s31, v11
    v_xor_b32 v20, 64, v19
    v_add_u32 v21, 0xe000, v19
    v_add_u32 v22, 0xe000, v20
    v_add_u32 v23, 0x1c000, v19
    v_add_u32 v24, 0x1c000, v20
    v_lshl_add_u32 v10, v4, 3, v9
    v_mul_u32_u24 v10, 192, v10
    v_bfe_u32 v11, v1, 1, 1
    v_lshl_add_u32 v10, v11, 4, v10
    v_and_b32 v11, 1, v1
    v_lshl_add_u32 v10, v11, 3, v10
    v_add_u32 v10, 0x4000, v10
    v_bfe_u32 v11, v1, 4, 1
    v_lshlrev_b32 v11, 5, v11
    s_sub_u32 s26, s40, 0
    s_lshl_b32 s26, s26, 5
    v_add_u32 v12, s26, v10
    s_and_b32 s27, s40, 1
    s_lshl_b32 s27, s27, 1
    s_sub_u32 s27, 1, s27
    v_mul_lo_u32 v13, s27, v11
    v_add_u32 v25, v12, v13
    s_sub_u32 s26, s41, 1
    s_lshl_b32 s26, s26, 5
    v_add_u32 v12, s26, v10
    s_and_b32 s27, s41, 1
    s_lshl_b32 s27, s27, 1
    s_sub_u32 s27, 1, s27
    v_mul_lo_u32 v13, s27, v11
    v_add_u32 v26, v12, v13
    s_sub_u32 s26, s43, 3
    s_lshl_b32 s26, s26, 5
    v_add_u32 v12, s26, v10
    s_and_b32 s27, s43, 1
    s_lshl_b32 s27, s27, 1
    s_sub_u32 s27, 1, s27
    v_mul_lo_u32 v13, s27, v11
    v_add_u32 v27, v12, v13
    s_sub_u32 s26, s44, 4
    s_lshl_b32 s26, s26, 5
    v_add_u32 v12, s26, v10
    s_and_b32 s27, s44, 1
    s_lshl_b32 s27, s27, 1
    s_sub_u32 s27, 1, s27
    v_mul_lo_u32 v13, s27, v11
    v_add_u32 v28, v12, v13
    s_sub_u32 s26, s45, 5
    s_lshl_b32 s26, s26, 5
    v_add_u32 v12, s26, v10
    s_and_b32 s27, s45, 1
    s_lshl_b32 s27, s27, 1
    s_sub_u32 s27, 1, s27
    v_mul_lo_u32 v13, s27, v11
    v_add_u32 v29, v12, v13
    v_add_u32 v30, 0xe000, v25
    v_add_u32 v31, 0xe000, v26
    v_add_u32 v32, 0xe000, v27
    v_add_u32 v33, 0xe000, v28
    v_add_u32 v34, 0xe000, v29
    v_add_u32 v35, 0x1c000, v25
    v_add_u32 v36, 0x1c000, v26
    v_add_u32 v37, 0x1c000, v27
    v_add_u32 v38, 0x1c000, v28
    v_add_u32 v39, 0x1c000, v29
    v_mov_b32 v40, 0x3f803f80
    v_mov_b32 v41, 0x3f803f80
    v_mov_b32 v42, 0x3f803f80
    v_mov_b32 v43, 0x3f803f80
    s_waitcnt lgkmcnt(0)
    s_mov_b32 s4, s64
    s_mov_b32 s5, s65
    s_mov_b32 s6, 0x200000
    s_mov_b32 s7, 0x00020000
    s_mov_b32 s8, s66
    s_mov_b32 s9, s67
    s_mov_b32 s10, 0x180000
    s_mov_b32 s11, 0x00020000
    s_mov_b32 s12, s82
    s_mov_b32 s13, s83
    s_mov_b32 s14, 0x2000000
    s_mov_b32 s15, 0x00020000
    s_add_u32 m0, s25, 0x4000
    s_add_u32 s18, s16, 0
    s_and_b32 s18, s18, 7
    s_mul_i32 s17, s18, 0x30000
    s_add_u32 s17, s17, s24
    s_lshl_b32 s18, s18, 7
    s_add_u32 s18, s18, s30
    buffer_load_dwordx4 v16, s[8:11], s17 offen lds
    s_add_u32 m0, s31, 0x0
    s_add_u32 s26, s18, 0x0
    buffer_load_dwordx4 v5, s[4:7], s26 offen lds
    s_add_u32 m0, s25, 0x4400
    buffer_load_dwordx4 v17, s[8:11], s17 offen lds
    s_add_u32 m0, s31, 0x400
    s_add_u32 s26, s18, 0x2000
    buffer_load_dwordx4 v5, s[4:7], s26 offen lds
    s_add_u32 m0, s25, 0x4800
    buffer_load_dwordx4 v18, s[8:11], s17 offen lds
    s_add_u32 m0, s31, 0x800
    s_add_u32 s26, s18, 0x4000
    buffer_load_dwordx4 v5, s[4:7], s26 offen lds
    s_add_u32 m0, s31, 0xc00
    s_add_u32 s26, s18, 0x6000
    buffer_load_dwordx4 v5, s[4:7], s26 offen lds
    s_add_u32 m0, s25, 0xb000
    s_add_u32 s18, s16, 1
    s_and_b32 s18, s18, 7
    s_mul_i32 s17, s18, 0x30000
    s_add_u32 s17, s17, s24
    s_lshl_b32 s18, s18, 7
    s_add_u32 s18, s18, s30
    buffer_load_dwordx4 v16, s[8:11], s17 offen lds
    s_add_u32 m0, s31, 0x7000
    s_add_u32 s26, s18, 0x0
    buffer_load_dwordx4 v5, s[4:7], s26 offen lds
    s_add_u32 m0, s25, 0xb400
    buffer_load_dwordx4 v17, s[8:11], s17 offen lds
    s_add_u32 m0, s31, 0x7400
    s_add_u32 s26, s18, 0x2000
    buffer_load_dwordx4 v5, s[4:7], s26 offen lds
    s_add_u32 m0, s25, 0xb800
    buffer_load_dwordx4 v18, s[8:11], s17 offen lds
    s_add_u32 m0, s31, 0x7800
    s_add_u32 s26, s18, 0x4000
    buffer_load_dwordx4 v5, s[4:7], s26 offen lds
    s_add_u32 m0, s31, 0x7c00
    s_add_u32 s26, s18, 0x6000
    buffer_load_dwordx4 v5, s[4:7], s26 offen lds
    s_waitcnt vmcnt(7)
    s_barrier
    ds_read_b128 v[156:159], v19 offset:0
    ds_read_b128 v[160:163], v19 offset:2048
    ds_read_b64_tr_b16 v[76:77], v25 offset:0
    ds_read_b64_tr_b16 v[78:79], v25 offset:768
    s_add_u32 m0, s25, 0x12000
    s_add_u32 s18, s16, 2
    s_and_b32 s18, s18, 7
    s_mul_i32 s17, s18, 0x30000
    s_add_u32 s17, s17, s24
    s_lshl_b32 s18, s18, 7
    s_add_u32 s18, s18, s30
    buffer_load_dwordx4 v16, s[8:11], s17 offen lds
    s_add_u32 m0, s31, 0xe000
    s_add_u32 s26, s18, 0x0
    buffer_load_dwordx4 v5, s[4:7], s26 offen lds
    ds_read_b64_tr_b16 v[80:81], v26 offset:32
    ds_read_b64_tr_b16 v[82:83], v26 offset:800
    s_add_u32 m0, s25, 0x12400
    buffer_load_dwordx4 v17, s[8:11], s17 offen lds
    ds_read_b64_tr_b16 v[84:85], v25 offset:64
    ds_read_b64_tr_b16 v[86:87], v25 offset:832
    s_add_u32 m0, s31, 0xe400
    s_add_u32 s26, s18, 0x2000
    buffer_load_dwordx4 v5, s[4:7], s26 offen lds
    ds_read_b64_tr_b16 v[88:89], v27 offset:96
    ds_read_b64_tr_b16 v[90:91], v27 offset:864
    s_add_u32 m0, s25, 0x12800
    buffer_load_dwordx4 v18, s[8:11], s17 offen lds
    ds_read_b64_tr_b16 v[92:93], v28 offset:128
    ds_read_b64_tr_b16 v[94:95], v28 offset:896
    s_add_u32 m0, s31, 0xe800
    s_add_u32 s26, s18, 0x4000
    buffer_load_dwordx4 v5, s[4:7], s26 offen lds
    ds_read_b64_tr_b16 v[96:97], v29 offset:160
    ds_read_b64_tr_b16 v[98:99], v29 offset:928
    s_add_u32 m0, s31, 0xec00
    s_add_u32 s26, s18, 0x6000
    buffer_load_dwordx4 v5, s[4:7], s26 offen lds
    s_waitcnt lgkmcnt(10)
    v_mfma_f32_16x16x32_bf16 v[108:111], v[76:79], v[156:159], 0
    ds_read_b128 v[164:167], v20 offset:0
    v_mfma_f32_16x16x32_bf16 v[132:135], v[76:79], v[160:163], 0
    ds_read_b128 v[168:171], v20 offset:2048
    v_mfma_f32_16x16x32_bf16 v[60:63], v[76:79], v[40:43], 0
    ds_read_b64_tr_b16 v[100:101], v25 offset:6144
    ds_read_b64_tr_b16 v[102:103], v25 offset:6912
    s_add_u32 m0, s25, 0x19000
    s_add_u32 s18, s16, 3
    s_and_b32 s18, s18, 7
    s_mul_i32 s17, s18, 0x30000
    s_add_u32 s17, s17, s24
    s_lshl_b32 s18, s18, 7
    s_add_u32 s18, s18, s30
    buffer_load_dwordx4 v16, s[8:11], s17 offen lds
    s_add_u32 m0, s31, 0x15000
    s_add_u32 s26, s18, 0x0
    buffer_load_dwordx4 v5, s[4:7], s26 offen lds
    s_waitcnt lgkmcnt(12)
    v_mfma_f32_16x16x32_bf16 v[112:115], v[80:83], v[156:159], 0
    ds_read_b64_tr_b16 v[104:105], v26 offset:6176
    v_mfma_f32_16x16x32_bf16 v[136:139], v[80:83], v[160:163], 0
    ds_read_b64_tr_b16 v[106:107], v26 offset:6944
    v_mfma_f32_16x16x32_bf16 v[44:47], v[40:43], v[156:159], 0
    s_add_u32 m0, s25, 0x19400
    buffer_load_dwordx4 v17, s[8:11], s17 offen lds
    v_mfma_f32_16x16x32_bf16 v[52:55], v[156:159], v[156:159], 0
    s_waitcnt lgkmcnt(12)
    v_mfma_f32_16x16x32_bf16 v[116:119], v[84:87], v[156:159], 0
    ds_read_b64_tr_b16 v[76:77], v25 offset:6208
    v_mfma_f32_16x16x32_bf16 v[140:143], v[84:87], v[160:163], 0
    ds_read_b64_tr_b16 v[78:79], v25 offset:6976
    v_mfma_f32_16x16x32_bf16 v[48:51], v[40:43], v[160:163], 0
    s_add_u32 m0, s31, 0x15400
    s_add_u32 s26, s18, 0x2000
    buffer_load_dwordx4 v5, s[4:7], s26 offen lds
    v_mfma_f32_16x16x32_bf16 v[56:59], v[160:163], v[160:163], 0
    s_waitcnt lgkmcnt(12)
    v_mfma_f32_16x16x32_bf16 v[120:123], v[88:91], v[156:159], 0
    ds_read_b64_tr_b16 v[80:81], v27 offset:6240
    v_mfma_f32_16x16x32_bf16 v[144:147], v[88:91], v[160:163], 0
    ds_read_b64_tr_b16 v[82:83], v27 offset:7008
    v_mfma_f32_16x16x32_bf16 v[64:67], v[88:91], v[40:43], 0
    s_add_u32 m0, s25, 0x19800
    buffer_load_dwordx4 v18, s[8:11], s17 offen lds
    s_waitcnt lgkmcnt(12)
    v_mfma_f32_16x16x32_bf16 v[124:127], v[92:95], v[156:159], 0
    ds_read_b64_tr_b16 v[84:85], v28 offset:6272
    v_mfma_f32_16x16x32_bf16 v[148:151], v[92:95], v[160:163], 0
    ds_read_b64_tr_b16 v[86:87], v28 offset:7040
    s_add_u32 m0, s31, 0x15800
    s_add_u32 s26, s18, 0x4000
    buffer_load_dwordx4 v5, s[4:7], s26 offen lds
    s_waitcnt lgkmcnt(12)
    v_mfma_f32_16x16x32_bf16 v[128:131], v[96:99], v[156:159], 0
    ds_read_b64_tr_b16 v[88:89], v29 offset:6304
    v_mfma_f32_16x16x32_bf16 v[152:155], v[96:99], v[160:163], 0
    ds_read_b64_tr_b16 v[90:91], v29 offset:7072
    s_add_u32 m0, s31, 0x15c00
    s_add_u32 s26, s18, 0x6000
    buffer_load_dwordx4 v5, s[4:7], s26 offen lds
    s_waitcnt lgkmcnt(10)
    v_mfma_f32_16x16x32_bf16 v[108:111], v[100:103], v[164:167], v[108:111]
    v_mfma_f32_16x16x32_bf16 v[132:135], v[100:103], v[168:171], v[132:135]
    v_mfma_f32_16x16x32_bf16 v[60:63], v[100:103], v[40:43], v[60:63]
    s_waitcnt vmcnt(14)
    s_barrier
    ds_read_b128 v[156:159], v19 offset:28672
    ds_read_b128 v[160:163], v19 offset:30720
    ds_read_b64_tr_b16 v[92:93], v25 offset:28672
    ds_read_b64_tr_b16 v[94:95], v25 offset:29440
    s_add_u32 m0, s25, 0x20000
    s_add_u32 s18, s16, 4
    s_and_b32 s18, s18, 7
    s_mul_i32 s17, s18, 0x30000
    s_add_u32 s17, s17, s24
    s_lshl_b32 s18, s18, 7
    s_add_u32 s18, s18, s30
    buffer_load_dwordx4 v16, s[8:11], s17 offen lds
    s_waitcnt lgkmcnt(12)
    v_mfma_f32_16x16x32_bf16 v[112:115], v[104:107], v[164:167], v[112:115]
    ds_read_b64_tr_b16 v[96:97], v26 offset:28704
    v_mfma_f32_16x16x32_bf16 v[136:139], v[104:107], v[168:171], v[136:139]
    ds_read_b64_tr_b16 v[98:99], v26 offset:29472
    v_mfma_f32_16x16x32_bf16 v[44:47], v[40:43], v[164:167], v[44:47]
    s_add_u32 m0, s31, 0x1c000
    s_add_u32 s26, s18, 0x0
    buffer_load_dwordx4 v5, s[4:7], s26 offen lds
    v_mfma_f32_16x16x32_bf16 v[52:55], v[164:167], v[164:167], v[52:55]
    s_waitcnt lgkmcnt(12)
    v_mfma_f32_16x16x32_bf16 v[116:119], v[76:79], v[164:167], v[116:119]
    ds_read_b64_tr_b16 v[100:101], v25 offset:28736
    v_mfma_f32_16x16x32_bf16 v[140:143], v[76:79], v[168:171], v[140:143]
    ds_read_b64_tr_b16 v[102:103], v25 offset:29504
    v_mfma_f32_16x16x32_bf16 v[48:51], v[40:43], v[168:171], v[48:51]
    s_add_u32 m0, s25, 0x20400
    buffer_load_dwordx4 v17, s[8:11], s17 offen lds
    v_mfma_f32_16x16x32_bf16 v[56:59], v[168:171], v[168:171], v[56:59]
    s_waitcnt lgkmcnt(12)
    v_mfma_f32_16x16x32_bf16 v[120:123], v[80:83], v[164:167], v[120:123]
    ds_read_b64_tr_b16 v[104:105], v27 offset:28768
    v_mfma_f32_16x16x32_bf16 v[144:147], v[80:83], v[168:171], v[144:147]
    ds_read_b64_tr_b16 v[106:107], v27 offset:29536
    v_mfma_f32_16x16x32_bf16 v[64:67], v[80:83], v[40:43], v[64:67]
    s_add_u32 m0, s31, 0x1c400
    s_add_u32 s26, s18, 0x2000
    buffer_load_dwordx4 v5, s[4:7], s26 offen lds
    s_waitcnt lgkmcnt(12)
    v_mfma_f32_16x16x32_bf16 v[124:127], v[84:87], v[164:167], v[124:127]
    ds_read_b64_tr_b16 v[76:77], v28 offset:28800
    v_mfma_f32_16x16x32_bf16 v[148:151], v[84:87], v[168:171], v[148:151]
    ds_read_b64_tr_b16 v[78:79], v28 offset:29568
    s_add_u32 m0, s25, 0x20800
    buffer_load_dwordx4 v18, s[8:11], s17 offen lds
    s_waitcnt lgkmcnt(12)
    v_mfma_f32_16x16x32_bf16 v[128:131], v[88:91], v[164:167], v[128:131]
    ds_read_b64_tr_b16 v[80:81], v29 offset:28832
    v_mfma_f32_16x16x32_bf16 v[152:155], v[88:91], v[168:171], v[152:155]
    ds_read_b64_tr_b16 v[82:83], v29 offset:29600
    s_waitcnt lgkmcnt(10)
    v_mfma_f32_16x16x32_bf16 v[108:111], v[92:95], v[156:159], v[108:111]
    ds_read_b128 v[164:167], v20 offset:28672
    v_mfma_f32_16x16x32_bf16 v[132:135], v[92:95], v[160:163], v[132:135]
    ds_read_b128 v[168:171], v20 offset:30720
    v_mfma_f32_16x16x32_bf16 v[60:63], v[92:95], v[40:43], v[60:63]
    ds_read_b64_tr_b16 v[84:85], v25 offset:34816
    ds_read_b64_tr_b16 v[86:87], v25 offset:35584
    s_add_u32 m0, s31, 0x1c800
    s_add_u32 s26, s18, 0x4000
    buffer_load_dwordx4 v5, s[4:7], s26 offen lds
    s_waitcnt lgkmcnt(12)
    v_mfma_f32_16x16x32_bf16 v[112:115], v[96:99], v[156:159], v[112:115]
    ds_read_b64_tr_b16 v[88:89], v26 offset:34848
    v_mfma_f32_16x16x32_bf16 v[136:139], v[96:99], v[160:163], v[136:139]
    ds_read_b64_tr_b16 v[90:91], v26 offset:35616
    v_mfma_f32_16x16x32_bf16 v[44:47], v[40:43], v[156:159], v[44:47]
    s_add_u32 m0, s31, 0x1cc00
    s_add_u32 s26, s18, 0x6000
    buffer_load_dwordx4 v5, s[4:7], s26 offen lds
    v_mfma_f32_16x16x32_bf16 v[52:55], v[156:159], v[156:159], v[52:55]
    s_waitcnt lgkmcnt(12)
    v_mfma_f32_16x16x32_bf16 v[116:119], v[100:103], v[156:159], v[116:119]
    ds_read_b64_tr_b16 v[92:93], v25 offset:34880
    v_mfma_f32_16x16x32_bf16 v[140:143], v[100:103], v[160:163], v[140:143]
    ds_read_b64_tr_b16 v[94:95], v25 offset:35648
    v_mfma_f32_16x16x32_bf16 v[48:51], v[40:43], v[160:163], v[48:51]
    v_lshrrev_b32 v196, 3, v0
    v_and_b32 v197, 7, v0
    v_and_b32 v198, 3, v196
    v_lshlrev_b32 v198, 1, v198
    v_xor_b32 v198, v198, v197
    v_lshlrev_b32 v198, 4, v198
    v_lshl_add_u32 v199, v196, 7, v198
    v_add_u32 v199, 0x15000, v199
    v_lshlrev_b32 v197, 4, v197
    v_lshlrev_b32 v203, 4, v1
    v_mfma_f32_16x16x32_bf16 v[56:59], v[160:163], v[160:163], v[56:59]
    s_waitcnt lgkmcnt(12)
    v_mfma_f32_16x16x32_bf16 v[120:123], v[104:107], v[156:159], v[120:123]
    ds_read_b64_tr_b16 v[96:97], v27 offset:34912
    v_mfma_f32_16x16x32_bf16 v[144:147], v[104:107], v[160:163], v[144:147]
    ds_read_b64_tr_b16 v[98:99], v27 offset:35680
    v_mfma_f32_16x16x32_bf16 v[64:67], v[104:107], v[40:43], v[64:67]
    s_and_b32 s58, s2, 15
    s_lshr_b32 s59, s2, 4
    s_mul_i32 s56, s58, 114688
    s_lshl_b32 s57, s59, 7
    s_add_u32 s56, s56, s57
    s_lshl_b32 s57, s59, 17
    s_lshl_b32 s58, s58, 12
    s_add_u32 s57, s57, s58
    s_lshr_b32 s58, s3, 1
    s_lshl_b32 s58, s58, 16
    s_add_u32 s57, s57, s58
    s_and_b32 s58, s3, 1
    s_lshl_b32 s58, s58, 10
    s_add_u32 s57, s57, s58
    s_add_u32 s57, s57, 0x1900000
    s_mov_b32 s46, s57
    s_add_u32 s47, s57, 2048
    v_mul_u32_u24 v198, 3584, v196
    v_add_u32 v198, v198, v197
    s_mov_b32 s52, s72
    s_mov_b32 s53, s73
    s_mov_b32 s54, 0x1c0000
    s_mov_b32 s55, 0x00020000
    buffer_load_dwordx4 v[172:175], v198, s[52:55], s56 offen
    s_waitcnt lgkmcnt(12)
    v_mfma_f32_16x16x32_bf16 v[124:127], v[76:79], v[156:159], v[124:127]
    ds_read_b64_tr_b16 v[100:101], v28 offset:34944
    v_mfma_f32_16x16x32_bf16 v[148:151], v[76:79], v[160:163], v[148:151]
    ds_read_b64_tr_b16 v[102:103], v28 offset:35712
    s_mov_b32 s52, s74
    s_mov_b32 s53, s75
    buffer_load_dwordx4 v[176:179], v198, s[52:55], s56 offen
    s_waitcnt lgkmcnt(12)
    v_mfma_f32_16x16x32_bf16 v[128:131], v[80:83], v[156:159], v[128:131]
    ds_read_b64_tr_b16 v[104:105], v29 offset:34976
    v_mfma_f32_16x16x32_bf16 v[152:155], v[80:83], v[160:163], v[152:155]
    ds_read_b64_tr_b16 v[106:107], v29 offset:35744
    s_waitcnt lgkmcnt(10)
    v_mfma_f32_16x16x32_bf16 v[108:111], v[84:87], v[164:167], v[108:111]
    v_mfma_f32_16x16x32_bf16 v[132:135], v[84:87], v[168:171], v[132:135]
    v_mfma_f32_16x16x32_bf16 v[60:63], v[84:87], v[40:43], v[60:63]
    s_waitcnt vmcnt(16)
    s_barrier
    ds_read_b128 v[156:159], v21 offset:0
    ds_read_b128 v[160:163], v21 offset:2048
    ds_read_b64_tr_b16 v[76:77], v30 offset:0
    ds_read_b64_tr_b16 v[78:79], v30 offset:768
    s_add_u32 m0, s25, 0x4000
    s_add_u32 s18, s16, 5
    s_and_b32 s18, s18, 7
    s_mul_i32 s17, s18, 0x30000
    s_add_u32 s17, s17, s24
    s_lshl_b32 s18, s18, 7
    s_add_u32 s18, s18, s30
    buffer_load_dwordx4 v16, s[8:11], s17 offen lds
    s_waitcnt lgkmcnt(12)
    v_mfma_f32_16x16x32_bf16 v[112:115], v[88:91], v[164:167], v[112:115]
    ds_read_b64_tr_b16 v[80:81], v31 offset:32
    v_mfma_f32_16x16x32_bf16 v[136:139], v[88:91], v[168:171], v[136:139]
    ds_read_b64_tr_b16 v[82:83], v31 offset:800
    v_mfma_f32_16x16x32_bf16 v[44:47], v[40:43], v[164:167], v[44:47]
    s_add_u32 m0, s31, 0x0
    s_add_u32 s26, s18, 0x0
    buffer_load_dwordx4 v5, s[4:7], s26 offen lds
    v_mfma_f32_16x16x32_bf16 v[52:55], v[164:167], v[164:167], v[52:55]
    s_waitcnt lgkmcnt(12)
    v_mfma_f32_16x16x32_bf16 v[116:119], v[92:95], v[164:167], v[116:119]
    ds_read_b64_tr_b16 v[84:85], v30 offset:64
    v_mfma_f32_16x16x32_bf16 v[140:143], v[92:95], v[168:171], v[140:143]
    ds_read_b64_tr_b16 v[86:87], v30 offset:832
    v_mfma_f32_16x16x32_bf16 v[48:51], v[40:43], v[168:171], v[48:51]
    s_add_u32 m0, s25, 0x4400
    buffer_load_dwordx4 v17, s[8:11], s17 offen lds
    v_mfma_f32_16x16x32_bf16 v[56:59], v[168:171], v[168:171], v[56:59]
    s_waitcnt lgkmcnt(12)
    v_mfma_f32_16x16x32_bf16 v[120:123], v[96:99], v[164:167], v[120:123]
    ds_read_b64_tr_b16 v[88:89], v32 offset:96
    v_mfma_f32_16x16x32_bf16 v[144:147], v[96:99], v[168:171], v[144:147]
    ds_read_b64_tr_b16 v[90:91], v32 offset:864
    v_mfma_f32_16x16x32_bf16 v[64:67], v[96:99], v[40:43], v[64:67]
    s_waitcnt lgkmcnt(12)
    v_mfma_f32_16x16x32_bf16 v[124:127], v[100:103], v[164:167], v[124:127]
    ds_read_b64_tr_b16 v[92:93], v33 offset:128
    v_mfma_f32_16x16x32_bf16 v[148:151], v[100:103], v[168:171], v[148:151]
    ds_read_b64_tr_b16 v[94:95], v33 offset:896
    s_add_u32 m0, s31, 0x400
    s_add_u32 s26, s18, 0x2000
    buffer_load_dwordx4 v5, s[4:7], s26 offen lds
    s_waitcnt lgkmcnt(12)
    v_mfma_f32_16x16x32_bf16 v[128:131], v[104:107], v[164:167], v[128:131]
    ds_read_b64_tr_b16 v[96:97], v34 offset:160
    v_mfma_f32_16x16x32_bf16 v[152:155], v[104:107], v[168:171], v[152:155]
    ds_read_b64_tr_b16 v[98:99], v34 offset:928
    s_add_u32 m0, s25, 0x4800
    buffer_load_dwordx4 v18, s[8:11], s17 offen lds
    s_waitcnt lgkmcnt(10)
    v_mfma_f32_16x16x32_bf16 v[108:111], v[76:79], v[156:159], v[108:111]
    ds_read_b128 v[164:167], v22 offset:0
    v_mfma_f32_16x16x32_bf16 v[132:135], v[76:79], v[160:163], v[132:135]
    ds_read_b128 v[168:171], v22 offset:2048
    v_mfma_f32_16x16x32_bf16 v[60:63], v[76:79], v[40:43], v[60:63]
    ds_read_b64_tr_b16 v[100:101], v30 offset:6144
    ds_read_b64_tr_b16 v[102:103], v30 offset:6912
    s_add_u32 m0, s31, 0x800
    s_add_u32 s26, s18, 0x4000
    buffer_load_dwordx4 v5, s[4:7], s26 offen lds
    s_waitcnt lgkmcnt(12)
    v_mfma_f32_16x16x32_bf16 v[112:115], v[80:83], v[156:159], v[112:115]
    ds_read_b64_tr_b16 v[104:105], v31 offset:6176
    v_mfma_f32_16x16x32_bf16 v[136:139], v[80:83], v[160:163], v[136:139]
    ds_read_b64_tr_b16 v[106:107], v31 offset:6944
    v_mfma_f32_16x16x32_bf16 v[44:47], v[40:43], v[156:159], v[44:47]
    v_mfma_f32_16x16x32_bf16 v[52:55], v[156:159], v[156:159], v[52:55]
    s_waitcnt lgkmcnt(12)
    v_mfma_f32_16x16x32_bf16 v[116:119], v[84:87], v[156:159], v[116:119]
    ds_read_b64_tr_b16 v[76:77], v30 offset:6208
    v_mfma_f32_16x16x32_bf16 v[140:143], v[84:87], v[160:163], v[140:143]
    ds_read_b64_tr_b16 v[78:79], v30 offset:6976
    v_mfma_f32_16x16x32_bf16 v[48:51], v[40:43], v[160:163], v[48:51]
    s_add_u32 m0, s31, 0xc00
    s_add_u32 s26, s18, 0x6000
    buffer_load_dwordx4 v5, s[4:7], s26 offen lds
    v_mfma_f32_16x16x32_bf16 v[56:59], v[160:163], v[160:163], v[56:59]
    s_waitcnt lgkmcnt(12)
    v_mfma_f32_16x16x32_bf16 v[120:123], v[88:91], v[156:159], v[120:123]
    ds_read_b64_tr_b16 v[80:81], v32 offset:6240
    v_mfma_f32_16x16x32_bf16 v[144:147], v[88:91], v[160:163], v[144:147]
    ds_read_b64_tr_b16 v[82:83], v32 offset:7008
    v_mfma_f32_16x16x32_bf16 v[64:67], v[88:91], v[40:43], v[64:67]
    s_add_u32 s34, s2, 256
    s_and_b32 s58, s34, 15
    s_lshr_b32 s59, s34, 4
    s_mul_i32 s56, s58, 114688
    s_lshl_b32 s57, s59, 7
    s_add_u32 s56, s56, s57
    s_lshl_b32 s57, s59, 17
    s_lshl_b32 s58, s58, 12
    s_add_u32 s57, s57, s58
    s_lshr_b32 s58, s3, 1
    s_lshl_b32 s58, s58, 16
    s_add_u32 s57, s57, s58
    s_and_b32 s58, s3, 1
    s_lshl_b32 s58, s58, 10
    s_add_u32 s57, s57, s58
    s_add_u32 s57, s57, 0x1900000
    s_sub_u32 s34, s2, 192
    s_lshl_b32 s34, s34, 1
    s_and_b32 s58, s34, 7
    s_lshr_b32 s59, s34, 3
    s_lshl_b32 s35, s59, 15
    s_lshl_b32 s36, s58, 7
    s_add_u32 s35, s35, s36
    s_mul_i32 s36, s58, 65536
    s_lshl_b32 s59, s59, 12
    s_add_u32 s36, s36, s59
    s_lshl_b32 s59, s3, 10
    s_add_u32 s36, s36, s59
    s_add_u32 s36, s36, 0x1c80000
    s_cmp_lt_u32 s2, 192
    s_cselect_b32 s32, -1, 0
    s_mov_b32 s33, s32
    s_cselect_b32 s56, s56, s35
    s_cselect_b32 s48, s57, s36
    s_cselect_b32 s58, 0, 128
    s_add_u32 s37, s56, s58
    s_mov_b32 s58, 65536
    s_cmp_lt_u32 s2, 192
    s_cselect_b32 s58, 2048, s58
    s_add_u32 s49, s48, s58
    s_mov_b32 s58, 1024
    s_cmp_lt_u32 s2, 192
    s_cselect_b32 s58, 3584, s58
    v_mul_u32_u24 v200, s58, v196
    v_add_u32 v200, v200, v197
    s_cselect_b32 s52, s72, s68
    s_cselect_b32 s53, s73, s69
    s_mov_b32 s54, 0x80000
    s_cselect_b32 s54, 0x1c0000, s54
    buffer_load_dwordx4 v[180:183], v200, s[52:55], s56 offen
    s_waitcnt lgkmcnt(12)
    v_mfma_f32_16x16x32_bf16 v[124:127], v[92:95], v[156:159], v[124:127]
    ds_read_b64_tr_b16 v[84:85], v33 offset:6272
    v_mfma_f32_16x16x32_bf16 v[148:151], v[92:95], v[160:163], v[148:151]
    ds_read_b64_tr_b16 v[86:87], v33 offset:7040
    s_cmp_lt_u32 s2, 192
    s_cselect_b32 s52, s74, s68
    s_cselect_b32 s53, s75, s69
    buffer_load_dwordx4 v[184:187], v200, s[52:55], s37 offen
    s_waitcnt lgkmcnt(12)
    v_mfma_f32_16x16x32_bf16 v[128:131], v[96:99], v[156:159], v[128:131]
    ds_read_b64_tr_b16 v[88:89], v34 offset:6304
    v_mfma_f32_16x16x32_bf16 v[152:155], v[96:99], v[160:163], v[152:155]
    ds_read_b64_tr_b16 v[90:91], v34 offset:7072
    s_waitcnt lgkmcnt(10)
    v_mfma_f32_16x16x32_bf16 v[108:111], v[100:103], v[164:167], v[108:111]
    v_mfma_f32_16x16x32_bf16 v[132:135], v[100:103], v[168:171], v[132:135]
    v_mfma_f32_16x16x32_bf16 v[60:63], v[100:103], v[40:43], v[60:63]
    s_waitcnt vmcnt(18)
    s_barrier
    ds_read_b128 v[156:159], v21 offset:28672
    ds_read_b128 v[160:163], v21 offset:30720
    ds_read_b64_tr_b16 v[92:93], v30 offset:28672
    ds_read_b64_tr_b16 v[94:95], v30 offset:29440
    s_add_u32 m0, s25, 0xb000
    s_add_u32 s18, s16, 6
    s_and_b32 s18, s18, 7
    s_mul_i32 s17, s18, 0x30000
    s_add_u32 s17, s17, s24
    s_lshl_b32 s18, s18, 7
    s_add_u32 s18, s18, s30
    buffer_load_dwordx4 v16, s[8:11], s17 offen lds
    s_waitcnt lgkmcnt(12)
    v_mfma_f32_16x16x32_bf16 v[112:115], v[104:107], v[164:167], v[112:115]
    ds_read_b64_tr_b16 v[96:97], v31 offset:28704
    v_mfma_f32_16x16x32_bf16 v[136:139], v[104:107], v[168:171], v[136:139]
    ds_read_b64_tr_b16 v[98:99], v31 offset:29472
    v_mfma_f32_16x16x32_bf16 v[44:47], v[40:43], v[164:167], v[44:47]
    s_add_u32 m0, s31, 0x7000
    s_add_u32 s26, s18, 0x0
    buffer_load_dwordx4 v5, s[4:7], s26 offen lds
    v_mfma_f32_16x16x32_bf16 v[52:55], v[164:167], v[164:167], v[52:55]
    s_waitcnt lgkmcnt(12)
    v_mfma_f32_16x16x32_bf16 v[116:119], v[76:79], v[164:167], v[116:119]
    ds_read_b64_tr_b16 v[100:101], v30 offset:28736
    v_mfma_f32_16x16x32_bf16 v[140:143], v[76:79], v[168:171], v[140:143]
    ds_read_b64_tr_b16 v[102:103], v30 offset:29504
    v_mfma_f32_16x16x32_bf16 v[48:51], v[40:43], v[168:171], v[48:51]
    s_add_u32 m0, s25, 0xb400
    buffer_load_dwordx4 v17, s[8:11], s17 offen lds
    v_mfma_f32_16x16x32_bf16 v[56:59], v[168:171], v[168:171], v[56:59]
    s_waitcnt lgkmcnt(12)
    v_mfma_f32_16x16x32_bf16 v[120:123], v[80:83], v[164:167], v[120:123]
    ds_read_b64_tr_b16 v[104:105], v32 offset:28768
    v_mfma_f32_16x16x32_bf16 v[144:147], v[80:83], v[168:171], v[144:147]
    ds_read_b64_tr_b16 v[106:107], v32 offset:29536
    v_mfma_f32_16x16x32_bf16 v[64:67], v[80:83], v[40:43], v[64:67]
    s_waitcnt lgkmcnt(12)
    v_mfma_f32_16x16x32_bf16 v[124:127], v[84:87], v[164:167], v[124:127]
    ds_read_b64_tr_b16 v[76:77], v33 offset:28800
    v_mfma_f32_16x16x32_bf16 v[148:151], v[84:87], v[168:171], v[148:151]
    ds_read_b64_tr_b16 v[78:79], v33 offset:29568
    s_add_u32 m0, s31, 0x7400
    s_add_u32 s26, s18, 0x2000
    buffer_load_dwordx4 v5, s[4:7], s26 offen lds
    s_waitcnt lgkmcnt(12)
    v_mfma_f32_16x16x32_bf16 v[128:131], v[88:91], v[164:167], v[128:131]
    ds_read_b64_tr_b16 v[80:81], v34 offset:28832
    v_mfma_f32_16x16x32_bf16 v[152:155], v[88:91], v[168:171], v[152:155]
    ds_read_b64_tr_b16 v[82:83], v34 offset:29600
    s_add_u32 m0, s25, 0xb800
    buffer_load_dwordx4 v18, s[8:11], s17 offen lds
    s_waitcnt lgkmcnt(10)
    v_mfma_f32_16x16x32_bf16 v[108:111], v[92:95], v[156:159], v[108:111]
    ds_read_b128 v[164:167], v22 offset:28672
    v_mfma_f32_16x16x32_bf16 v[132:135], v[92:95], v[160:163], v[132:135]
    ds_read_b128 v[168:171], v22 offset:30720
    v_mfma_f32_16x16x32_bf16 v[60:63], v[92:95], v[40:43], v[60:63]
    ds_read_b64_tr_b16 v[84:85], v30 offset:34816
    ds_read_b64_tr_b16 v[86:87], v30 offset:35584
    s_add_u32 m0, s31, 0x7800
    s_add_u32 s26, s18, 0x4000
    buffer_load_dwordx4 v5, s[4:7], s26 offen lds
    s_waitcnt lgkmcnt(12)
    v_mfma_f32_16x16x32_bf16 v[112:115], v[96:99], v[156:159], v[112:115]
    ds_read_b64_tr_b16 v[88:89], v31 offset:34848
    v_mfma_f32_16x16x32_bf16 v[136:139], v[96:99], v[160:163], v[136:139]
    ds_read_b64_tr_b16 v[90:91], v31 offset:35616
    v_mfma_f32_16x16x32_bf16 v[44:47], v[40:43], v[156:159], v[44:47]
    v_mfma_f32_16x16x32_bf16 v[52:55], v[156:159], v[156:159], v[52:55]
    s_waitcnt lgkmcnt(12)
    v_mfma_f32_16x16x32_bf16 v[116:119], v[100:103], v[156:159], v[116:119]
    ds_read_b64_tr_b16 v[92:93], v30 offset:34880
    v_mfma_f32_16x16x32_bf16 v[140:143], v[100:103], v[160:163], v[140:143]
    ds_read_b64_tr_b16 v[94:95], v30 offset:35648
    v_mfma_f32_16x16x32_bf16 v[48:51], v[40:43], v[160:163], v[48:51]
    s_add_u32 m0, s31, 0x7c00
    s_add_u32 s26, s18, 0x6000
    buffer_load_dwordx4 v5, s[4:7], s26 offen lds
    v_mfma_f32_16x16x32_bf16 v[56:59], v[160:163], v[160:163], v[56:59]
    s_waitcnt lgkmcnt(12)
    v_mfma_f32_16x16x32_bf16 v[120:123], v[104:107], v[156:159], v[120:123]
    ds_read_b64_tr_b16 v[96:97], v32 offset:34912
    v_mfma_f32_16x16x32_bf16 v[144:147], v[104:107], v[160:163], v[144:147]
    ds_read_b64_tr_b16 v[98:99], v32 offset:35680
    v_mfma_f32_16x16x32_bf16 v[64:67], v[104:107], v[40:43], v[64:67]
    s_and_b32 s58, s2, 7
    s_lshr_b32 s59, s2, 3
    s_lshl_b32 s56, s59, 15
    s_lshl_b32 s50, s58, 7
    s_add_u32 s56, s56, s50
    s_mul_i32 s50, s58, 229376
    s_lshl_b32 s59, s59, 12
    s_add_u32 s50, s50, s59
    s_lshl_b32 s59, s3, 10
    s_add_u32 s50, s50, s59
    s_add_u32 s50, s50, 0x1d00000
    s_cmp_lt_u32 s2, 192
    s_cselect_b32 s58, 0x100000, 0
    s_add_u32 s57, s56, s58
    s_cmp_lt_u32 s2, 192
    s_cselect_b32 s58, 0x20000, 0
    s_add_u32 s51, s50, s58
    v_lshl_add_u32 v201, v196, 10, v197
    s_mov_b32 s52, s76
    s_mov_b32 s53, s77
    s_mov_b32 s54, 0x1c0000
    s_mov_b32 s55, 0x00020000
    buffer_load_dwordx4 v[188:191], v201, s[52:55], s56 offen
    s_waitcnt lgkmcnt(12)
    v_mfma_f32_16x16x32_bf16 v[124:127], v[76:79], v[156:159], v[124:127]
    ds_read_b64_tr_b16 v[100:101], v33 offset:34944
    v_mfma_f32_16x16x32_bf16 v[148:151], v[76:79], v[160:163], v[148:151]
    ds_read_b64_tr_b16 v[102:103], v33 offset:35712
    buffer_load_dwordx4 v[192:195], v201, s[52:55], s57 offen
    s_waitcnt lgkmcnt(12)
    v_mfma_f32_16x16x32_bf16 v[128:131], v[80:83], v[156:159], v[128:131]
    ds_read_b64_tr_b16 v[104:105], v34 offset:34976
    v_mfma_f32_16x16x32_bf16 v[152:155], v[80:83], v[160:163], v[152:155]
    ds_read_b64_tr_b16 v[106:107], v34 offset:35744
    s_waitcnt lgkmcnt(10)
    v_mfma_f32_16x16x32_bf16 v[108:111], v[84:87], v[164:167], v[108:111]
    v_mfma_f32_16x16x32_bf16 v[132:135], v[84:87], v[168:171], v[132:135]
    v_mfma_f32_16x16x32_bf16 v[60:63], v[84:87], v[40:43], v[60:63]
    s_waitcnt vmcnt(20)
    s_barrier
    ds_read_b128 v[156:159], v23 offset:0
    ds_read_b128 v[160:163], v23 offset:2048
    ds_read_b64_tr_b16 v[76:77], v35 offset:0
    ds_read_b64_tr_b16 v[78:79], v35 offset:768
    s_add_u32 m0, s25, 0x12000
    s_add_u32 s18, s16, 7
    s_and_b32 s18, s18, 7
    s_mul_i32 s17, s18, 0x30000
    s_add_u32 s17, s17, s24
    s_lshl_b32 s18, s18, 7
    s_add_u32 s18, s18, s30
    buffer_load_dwordx4 v16, s[8:11], s17 offen lds
    s_waitcnt lgkmcnt(12)
    v_mfma_f32_16x16x32_bf16 v[112:115], v[88:91], v[164:167], v[112:115]
    ds_read_b64_tr_b16 v[80:81], v36 offset:32
    v_mfma_f32_16x16x32_bf16 v[136:139], v[88:91], v[168:171], v[136:139]
    ds_read_b64_tr_b16 v[82:83], v36 offset:800
    v_mfma_f32_16x16x32_bf16 v[44:47], v[40:43], v[164:167], v[44:47]
    s_add_u32 m0, s31, 0xe000
    s_add_u32 s26, s18, 0x0
    buffer_load_dwordx4 v5, s[4:7], s26 offen lds
    v_mfma_f32_16x16x32_bf16 v[52:55], v[164:167], v[164:167], v[52:55]
    s_waitcnt lgkmcnt(12)
    v_mfma_f32_16x16x32_bf16 v[116:119], v[92:95], v[164:167], v[116:119]
    ds_read_b64_tr_b16 v[84:85], v35 offset:64
    v_mfma_f32_16x16x32_bf16 v[140:143], v[92:95], v[168:171], v[140:143]
    ds_read_b64_tr_b16 v[86:87], v35 offset:832
    v_mfma_f32_16x16x32_bf16 v[48:51], v[40:43], v[168:171], v[48:51]
    v_mfma_f32_16x16x32_bf16 v[56:59], v[168:171], v[168:171], v[56:59]
    s_waitcnt lgkmcnt(12)
    v_mfma_f32_16x16x32_bf16 v[120:123], v[96:99], v[164:167], v[120:123]
    ds_read_b64_tr_b16 v[88:89], v37 offset:96
    v_mfma_f32_16x16x32_bf16 v[144:147], v[96:99], v[168:171], v[144:147]
    ds_read_b64_tr_b16 v[90:91], v37 offset:864
    v_mfma_f32_16x16x32_bf16 v[64:67], v[96:99], v[40:43], v[64:67]
    s_add_u32 m0, s25, 0x12400
    buffer_load_dwordx4 v17, s[8:11], s17 offen lds
    s_waitcnt lgkmcnt(12)
    v_mfma_f32_16x16x32_bf16 v[124:127], v[100:103], v[164:167], v[124:127]
    ds_read_b64_tr_b16 v[92:93], v38 offset:128
    v_mfma_f32_16x16x32_bf16 v[148:151], v[100:103], v[168:171], v[148:151]
    ds_read_b64_tr_b16 v[94:95], v38 offset:896
    s_waitcnt lgkmcnt(12)
    v_mfma_f32_16x16x32_bf16 v[128:131], v[104:107], v[164:167], v[128:131]
    ds_read_b64_tr_b16 v[96:97], v39 offset:160
    v_mfma_f32_16x16x32_bf16 v[152:155], v[104:107], v[168:171], v[152:155]
    ds_read_b64_tr_b16 v[98:99], v39 offset:928
    s_add_u32 m0, s31, 0xe400
    s_add_u32 s26, s18, 0x2000
    buffer_load_dwordx4 v5, s[4:7], s26 offen lds
    s_waitcnt lgkmcnt(10)
    v_mfma_f32_16x16x32_bf16 v[108:111], v[76:79], v[156:159], v[108:111]
    ds_read_b128 v[164:167], v24 offset:0
    v_mfma_f32_16x16x32_bf16 v[132:135], v[76:79], v[160:163], v[132:135]
    ds_read_b128 v[168:171], v24 offset:2048
    v_mfma_f32_16x16x32_bf16 v[60:63], v[76:79], v[40:43], v[60:63]
    ds_read_b64_tr_b16 v[100:101], v35 offset:6144
    ds_read_b64_tr_b16 v[102:103], v35 offset:6912
    s_add_u32 m0, s25, 0x12800
    buffer_load_dwordx4 v18, s[8:11], s17 offen lds
    s_waitcnt lgkmcnt(12)
    v_mfma_f32_16x16x32_bf16 v[112:115], v[80:83], v[156:159], v[112:115]
    ds_read_b64_tr_b16 v[104:105], v36 offset:6176
    v_mfma_f32_16x16x32_bf16 v[136:139], v[80:83], v[160:163], v[136:139]
    ds_read_b64_tr_b16 v[106:107], v36 offset:6944
    v_mfma_f32_16x16x32_bf16 v[44:47], v[40:43], v[156:159], v[44:47]
    v_mfma_f32_16x16x32_bf16 v[52:55], v[156:159], v[156:159], v[52:55]
    s_waitcnt lgkmcnt(12)
    v_mfma_f32_16x16x32_bf16 v[116:119], v[84:87], v[156:159], v[116:119]
    ds_read_b64_tr_b16 v[76:77], v35 offset:6208
    v_mfma_f32_16x16x32_bf16 v[140:143], v[84:87], v[160:163], v[140:143]
    ds_read_b64_tr_b16 v[78:79], v35 offset:6976
    v_mfma_f32_16x16x32_bf16 v[48:51], v[40:43], v[160:163], v[48:51]
    s_add_u32 m0, s31, 0xe800
    s_add_u32 s26, s18, 0x4000
    buffer_load_dwordx4 v5, s[4:7], s26 offen lds
    v_mfma_f32_16x16x32_bf16 v[56:59], v[160:163], v[160:163], v[56:59]
    s_waitcnt lgkmcnt(12)
    v_mfma_f32_16x16x32_bf16 v[120:123], v[88:91], v[156:159], v[120:123]
    ds_read_b64_tr_b16 v[80:81], v37 offset:6240
    v_mfma_f32_16x16x32_bf16 v[144:147], v[88:91], v[160:163], v[144:147]
    ds_read_b64_tr_b16 v[82:83], v37 offset:7008
    v_mfma_f32_16x16x32_bf16 v[64:67], v[88:91], v[40:43], v[64:67]
    s_waitcnt lgkmcnt(12)
    v_mfma_f32_16x16x32_bf16 v[124:127], v[92:95], v[156:159], v[124:127]
    ds_read_b64_tr_b16 v[84:85], v38 offset:6272
    v_mfma_f32_16x16x32_bf16 v[148:151], v[92:95], v[160:163], v[148:151]
    ds_read_b64_tr_b16 v[86:87], v38 offset:7040
    s_add_u32 m0, s31, 0xec00
    s_add_u32 s26, s18, 0x6000
    buffer_load_dwordx4 v5, s[4:7], s26 offen lds
    s_waitcnt lgkmcnt(12)
    v_mfma_f32_16x16x32_bf16 v[128:131], v[96:99], v[156:159], v[128:131]
    ds_read_b64_tr_b16 v[88:89], v39 offset:6304
    v_mfma_f32_16x16x32_bf16 v[152:155], v[96:99], v[160:163], v[152:155]
    ds_read_b64_tr_b16 v[90:91], v39 offset:7072
    s_waitcnt lgkmcnt(10)
    v_mfma_f32_16x16x32_bf16 v[108:111], v[100:103], v[164:167], v[108:111]
    v_mfma_f32_16x16x32_bf16 v[132:135], v[100:103], v[168:171], v[132:135]
    v_mfma_f32_16x16x32_bf16 v[60:63], v[100:103], v[40:43], v[60:63]
    s_waitcnt vmcnt(18)
    s_barrier
    ds_read_b128 v[156:159], v19 offset:0
    ds_read_b128 v[160:163], v19 offset:2048
    ds_read_b64_tr_b16 v[92:93], v25 offset:0
    ds_read_b64_tr_b16 v[94:95], v25 offset:768
    s_waitcnt lgkmcnt(12)
    v_mfma_f32_16x16x32_bf16 v[112:115], v[104:107], v[164:167], v[112:115]
    ds_read_b64_tr_b16 v[96:97], v26 offset:32
    v_mfma_f32_16x16x32_bf16 v[136:139], v[104:107], v[168:171], v[136:139]
    ds_read_b64_tr_b16 v[98:99], v26 offset:800
    v_mfma_f32_16x16x32_bf16 v[44:47], v[40:43], v[164:167], v[44:47]
    v_mfma_f32_16x16x32_bf16 v[52:55], v[164:167], v[164:167], v[52:55]
    s_waitcnt lgkmcnt(12)
    v_mfma_f32_16x16x32_bf16 v[116:119], v[76:79], v[164:167], v[116:119]
    ds_read_b64_tr_b16 v[100:101], v25 offset:64
    v_mfma_f32_16x16x32_bf16 v[140:143], v[76:79], v[168:171], v[140:143]
    ds_read_b64_tr_b16 v[102:103], v25 offset:832
    v_mfma_f32_16x16x32_bf16 v[48:51], v[40:43], v[168:171], v[48:51]
    v_mfma_f32_16x16x32_bf16 v[56:59], v[168:171], v[168:171], v[56:59]
    s_waitcnt lgkmcnt(12)
    v_mfma_f32_16x16x32_bf16 v[120:123], v[80:83], v[164:167], v[120:123]
    ds_read_b64_tr_b16 v[104:105], v27 offset:96
    v_mfma_f32_16x16x32_bf16 v[144:147], v[80:83], v[168:171], v[144:147]
    ds_read_b64_tr_b16 v[106:107], v27 offset:864
    v_mfma_f32_16x16x32_bf16 v[64:67], v[80:83], v[40:43], v[64:67]
    s_waitcnt lgkmcnt(12)
    v_mfma_f32_16x16x32_bf16 v[124:127], v[84:87], v[164:167], v[124:127]
    ds_read_b64_tr_b16 v[76:77], v28 offset:128
    v_mfma_f32_16x16x32_bf16 v[148:151], v[84:87], v[168:171], v[148:151]
    ds_read_b64_tr_b16 v[78:79], v28 offset:896
    s_waitcnt lgkmcnt(12)
    v_mfma_f32_16x16x32_bf16 v[128:131], v[88:91], v[164:167], v[128:131]
    ds_read_b64_tr_b16 v[80:81], v29 offset:160
    v_mfma_f32_16x16x32_bf16 v[152:155], v[88:91], v[168:171], v[152:155]
    ds_read_b64_tr_b16 v[82:83], v29 offset:928
    s_waitcnt lgkmcnt(10)
    v_mfma_f32_16x16x32_bf16 v[108:111], v[92:95], v[156:159], v[108:111]
    ds_read_b128 v[164:167], v20 offset:0
    v_mfma_f32_16x16x32_bf16 v[132:135], v[92:95], v[160:163], v[132:135]
    ds_read_b128 v[168:171], v20 offset:2048
    v_mfma_f32_16x16x32_bf16 v[60:63], v[92:95], v[40:43], v[60:63]
    ds_read_b64_tr_b16 v[84:85], v25 offset:6144
    ds_read_b64_tr_b16 v[86:87], v25 offset:6912
    s_waitcnt lgkmcnt(12)
    v_mfma_f32_16x16x32_bf16 v[112:115], v[96:99], v[156:159], v[112:115]
    ds_read_b64_tr_b16 v[88:89], v26 offset:6176
    v_mfma_f32_16x16x32_bf16 v[136:139], v[96:99], v[160:163], v[136:139]
    ds_read_b64_tr_b16 v[90:91], v26 offset:6944
    v_mfma_f32_16x16x32_bf16 v[44:47], v[40:43], v[156:159], v[44:47]
    v_mfma_f32_16x16x32_bf16 v[52:55], v[156:159], v[156:159], v[52:55]
    s_waitcnt lgkmcnt(12)
    v_mfma_f32_16x16x32_bf16 v[116:119], v[100:103], v[156:159], v[116:119]
    ds_read_b64_tr_b16 v[92:93], v25 offset:6208
    v_mfma_f32_16x16x32_bf16 v[140:143], v[100:103], v[160:163], v[140:143]
    ds_read_b64_tr_b16 v[94:95], v25 offset:6976
    v_mfma_f32_16x16x32_bf16 v[48:51], v[40:43], v[160:163], v[48:51]
    v_mfma_f32_16x16x32_bf16 v[56:59], v[160:163], v[160:163], v[56:59]
    s_waitcnt lgkmcnt(12)
    v_mfma_f32_16x16x32_bf16 v[120:123], v[104:107], v[156:159], v[120:123]
    ds_read_b64_tr_b16 v[96:97], v27 offset:6240
    v_mfma_f32_16x16x32_bf16 v[144:147], v[104:107], v[160:163], v[144:147]
    ds_read_b64_tr_b16 v[98:99], v27 offset:7008
    v_mfma_f32_16x16x32_bf16 v[64:67], v[104:107], v[40:43], v[64:67]
    s_waitcnt lgkmcnt(12)
    v_mfma_f32_16x16x32_bf16 v[124:127], v[76:79], v[156:159], v[124:127]
    ds_read_b64_tr_b16 v[100:101], v28 offset:6272
    v_mfma_f32_16x16x32_bf16 v[148:151], v[76:79], v[160:163], v[148:151]
    ds_read_b64_tr_b16 v[102:103], v28 offset:7040
    s_waitcnt lgkmcnt(12)
    v_mfma_f32_16x16x32_bf16 v[128:131], v[80:83], v[156:159], v[128:131]
    ds_read_b64_tr_b16 v[104:105], v29 offset:6304
    v_mfma_f32_16x16x32_bf16 v[152:155], v[80:83], v[160:163], v[152:155]
    ds_read_b64_tr_b16 v[106:107], v29 offset:7072
    s_waitcnt lgkmcnt(10)
    v_mfma_f32_16x16x32_bf16 v[108:111], v[84:87], v[164:167], v[108:111]
    v_mfma_f32_16x16x32_bf16 v[132:135], v[84:87], v[168:171], v[132:135]
    v_mfma_f32_16x16x32_bf16 v[60:63], v[84:87], v[40:43], v[60:63]
    s_waitcnt vmcnt(9)
    s_barrier
    ds_read_b128 v[156:159], v19 offset:28672
    ds_read_b128 v[160:163], v19 offset:30720
    ds_read_b64_tr_b16 v[76:77], v25 offset:28672
    ds_read_b64_tr_b16 v[78:79], v25 offset:29440
    s_waitcnt vmcnt(7)
    v_xor_b32 v198, s3, v9
    v_lshlrev_b32 v198, 5, v198
    v_and_b32 v197, 3, v1
    v_lshl_add_u32 v198, v197, 3, v198
    v_lshl_add_u32 v198, v9, 7, v198
    v_add_u32 v198, 0x15000, v198
    v_lshl_add_u32 v200, v4, 9, v198
    v_bfe_u32 v197, v1, 5, 1
    v_lshl_add_u32 v201, v197, 11, v198
    v_bfe_u32 v197, v1, 4, 1
    v_lshl_add_u32 v201, v197, 9, v201
    v_add_u32 v202, 1024, v201
    v_add_u32 v197, 2048, v200
    s_cmp_lt_u32 s2, 192
    s_cselect_b32 s56, -1, 0
    s_mov_b32 s57, s56
    v_cndmask_b32_e64 v201, v201, v200, s[56:57]
    v_cndmask_b32_e64 v202, v202, v197, s[56:57]
    s_waitcnt lgkmcnt(12)
    v_mfma_f32_16x16x32_bf16 v[112:115], v[88:91], v[164:167], v[112:115]
    ds_read_b64_tr_b16 v[80:81], v26 offset:28704
    v_mfma_f32_16x16x32_bf16 v[136:139], v[88:91], v[168:171], v[136:139]
    ds_read_b64_tr_b16 v[82:83], v26 offset:29472
    v_mfma_f32_16x16x32_bf16 v[44:47], v[40:43], v[164:167], v[44:47]
    ds_write_b128 v199, v[172:175] offset:0
    v_mfma_f32_16x16x32_bf16 v[52:55], v[164:167], v[164:167], v[52:55]
    s_waitcnt lgkmcnt(13)
    v_mfma_f32_16x16x32_bf16 v[116:119], v[92:95], v[164:167], v[116:119]
    ds_read_b64_tr_b16 v[84:85], v25 offset:28736
    v_mfma_f32_16x16x32_bf16 v[140:143], v[92:95], v[168:171], v[140:143]
    ds_read_b64_tr_b16 v[86:87], v25 offset:29504
    v_mfma_f32_16x16x32_bf16 v[48:51], v[40:43], v[168:171], v[48:51]
    v_mfma_f32_16x16x32_bf16 v[56:59], v[168:171], v[168:171], v[56:59]
    s_waitcnt lgkmcnt(13)
    v_mfma_f32_16x16x32_bf16 v[120:123], v[96:99], v[164:167], v[120:123]
    ds_read_b64_tr_b16 v[88:89], v27 offset:28768
    v_mfma_f32_16x16x32_bf16 v[144:147], v[96:99], v[168:171], v[144:147]
    ds_read_b64_tr_b16 v[90:91], v27 offset:29536
    v_mfma_f32_16x16x32_bf16 v[64:67], v[96:99], v[40:43], v[64:67]
    s_waitcnt lgkmcnt(14)
    ds_write_b128 v199, v[176:179] offset:4096
    s_waitcnt lgkmcnt(14)
    v_mfma_f32_16x16x32_bf16 v[124:127], v[100:103], v[164:167], v[124:127]
    ds_read_b64_tr_b16 v[92:93], v28 offset:28800
    v_mfma_f32_16x16x32_bf16 v[148:151], v[100:103], v[168:171], v[148:151]
    s_waitcnt lgkmcnt(14)
    ds_read_b64_tr_b16 v[94:95], v28 offset:29568
    s_waitcnt lgkmcnt(14)
    v_mfma_f32_16x16x32_bf16 v[128:131], v[104:107], v[164:167], v[128:131]
    ds_read_b64_tr_b16 v[96:97], v29 offset:28832
    v_mfma_f32_16x16x32_bf16 v[152:155], v[104:107], v[168:171], v[152:155]
    s_waitcnt lgkmcnt(14)
    ds_read_b64_tr_b16 v[98:99], v29 offset:29600
    s_waitcnt lgkmcnt(14)
    ds_write_b128 v199, v[180:183] offset:8192
    s_waitcnt lgkmcnt(13)
    v_mfma_f32_16x16x32_bf16 v[108:111], v[76:79], v[156:159], v[108:111]
    ds_read_b128 v[164:167], v20 offset:28672
    v_mfma_f32_16x16x32_bf16 v[132:135], v[76:79], v[160:163], v[132:135]
    ds_read_b128 v[168:171], v20 offset:30720
    v_mfma_f32_16x16x32_bf16 v[60:63], v[76:79], v[40:43], v[60:63]
    s_waitcnt lgkmcnt(14)
    ds_read_b64_tr_b16 v[100:101], v25 offset:34816
    s_waitcnt lgkmcnt(14)
    ds_read_b64_tr_b16 v[102:103], v25 offset:35584
    s_waitcnt lgkmcnt(14)
    ds_write_b128 v199, v[184:187] offset:12288
    v_mfma_f32_16x16x32_bf16 v[112:115], v[80:83], v[156:159], v[112:115]
    s_waitcnt lgkmcnt(14)
    ds_read_b64_tr_b16 v[104:105], v26 offset:34848
    v_mfma_f32_16x16x32_bf16 v[136:139], v[80:83], v[160:163], v[136:139]
    s_waitcnt lgkmcnt(14)
    ds_read_b64_tr_b16 v[106:107], v26 offset:35616
    v_mfma_f32_16x16x32_bf16 v[44:47], v[40:43], v[156:159], v[44:47]
    v_mfma_f32_16x16x32_bf16 v[52:55], v[156:159], v[156:159], v[52:55]
    v_mfma_f32_16x16x32_bf16 v[116:119], v[84:87], v[156:159], v[116:119]
    s_waitcnt lgkmcnt(14)
    ds_read_b64_tr_b16 v[76:77], v25 offset:34880
    v_mfma_f32_16x16x32_bf16 v[140:143], v[84:87], v[160:163], v[140:143]
    s_waitcnt lgkmcnt(14)
    ds_read_b64_tr_b16 v[78:79], v25 offset:35648
    v_mfma_f32_16x16x32_bf16 v[48:51], v[40:43], v[160:163], v[48:51]
    s_waitcnt lgkmcnt(14)
    ds_write_b128 v199, v[188:191] offset:16384
    v_mfma_f32_16x16x32_bf16 v[56:59], v[160:163], v[160:163], v[56:59]
    v_mfma_f32_16x16x32_bf16 v[120:123], v[88:91], v[156:159], v[120:123]
    s_waitcnt lgkmcnt(14)
    ds_read_b64_tr_b16 v[80:81], v27 offset:34912
    v_mfma_f32_16x16x32_bf16 v[144:147], v[88:91], v[160:163], v[144:147]
    s_waitcnt lgkmcnt(14)
    ds_read_b64_tr_b16 v[82:83], v27 offset:35680
    v_mfma_f32_16x16x32_bf16 v[64:67], v[88:91], v[40:43], v[64:67]
    v_mfma_f32_16x16x32_bf16 v[124:127], v[92:95], v[156:159], v[124:127]
    s_waitcnt lgkmcnt(14)
    ds_read_b64_tr_b16 v[84:85], v28 offset:34944
    v_mfma_f32_16x16x32_bf16 v[148:151], v[92:95], v[160:163], v[148:151]
    s_waitcnt lgkmcnt(14)
    ds_read_b64_tr_b16 v[86:87], v28 offset:35712
    s_waitcnt lgkmcnt(14)
    ds_write_b128 v199, v[192:195] offset:20480
    v_mfma_f32_16x16x32_bf16 v[128:131], v[96:99], v[156:159], v[128:131]
    s_waitcnt lgkmcnt(14)
    ds_read_b64_tr_b16 v[88:89], v29 offset:34976
    v_mfma_f32_16x16x32_bf16 v[152:155], v[96:99], v[160:163], v[152:155]
    s_waitcnt lgkmcnt(14)
    ds_read_b64_tr_b16 v[90:91], v29 offset:35744
    s_waitcnt lgkmcnt(13)
    v_mfma_f32_16x16x32_bf16 v[108:111], v[100:103], v[164:167], v[108:111]
    v_mfma_f32_16x16x32_bf16 v[132:135], v[100:103], v[168:171], v[132:135]
    v_mfma_f32_16x16x32_bf16 v[60:63], v[100:103], v[40:43], v[60:63]
    s_waitcnt lgkmcnt(2)
    s_waitcnt vmcnt(0)
    s_barrier
    ds_read_b128 v[156:159], v21 offset:0
    ds_read_b128 v[160:163], v21 offset:2048
    ds_read_b64_tr_b16 v[92:93], v30 offset:0
    ds_read_b64_tr_b16 v[94:95], v30 offset:768
    ds_read_b64_tr_b16 v[172:173], v200 offset:0
    ds_read_b64_tr_b16 v[174:175], v200 offset:2048
    v_mfma_f32_16x16x32_bf16 v[112:115], v[104:107], v[164:167], v[112:115]
    ds_read_b64_tr_b16 v[96:97], v31 offset:32
    v_mfma_f32_16x16x32_bf16 v[136:139], v[104:107], v[168:171], v[136:139]
    ds_read_b64_tr_b16 v[98:99], v31 offset:800
    v_mfma_f32_16x16x32_bf16 v[44:47], v[40:43], v[164:167], v[44:47]
    ds_read_b64_tr_b16 v[176:177], v200 offset:4096
    ds_read_b64_tr_b16 v[178:179], v200 offset:6144
    v_mfma_f32_16x16x32_bf16 v[52:55], v[164:167], v[164:167], v[52:55]
    v_mfma_f32_16x16x32_bf16 v[116:119], v[76:79], v[164:167], v[116:119]
    ds_read_b64_tr_b16 v[100:101], v30 offset:64
    v_mfma_f32_16x16x32_bf16 v[140:143], v[76:79], v[168:171], v[140:143]
    ds_read_b64_tr_b16 v[102:103], v30 offset:832
    v_mfma_f32_16x16x32_bf16 v[48:51], v[40:43], v[168:171], v[48:51]
    ds_read_b64_tr_b16 v[180:181], v201 offset:8192
    s_waitcnt lgkmcnt(14)
    ds_read_b64_tr_b16 v[182:183], v202 offset:8192
    v_mfma_f32_16x16x32_bf16 v[56:59], v[168:171], v[168:171], v[56:59]
    v_mfma_f32_16x16x32_bf16 v[120:123], v[80:83], v[164:167], v[120:123]
    s_waitcnt lgkmcnt(14)
    ds_read_b64_tr_b16 v[104:105], v32 offset:96
    v_mfma_f32_16x16x32_bf16 v[144:147], v[80:83], v[168:171], v[144:147]
    s_waitcnt lgkmcnt(14)
    ds_read_b64_tr_b16 v[106:107], v32 offset:864
    v_mfma_f32_16x16x32_bf16 v[64:67], v[80:83], v[40:43], v[64:67]
    s_waitcnt lgkmcnt(14)
    ds_read_b64_tr_b16 v[184:185], v201 offset:12288
    s_waitcnt lgkmcnt(14)
    ds_read_b64_tr_b16 v[186:187], v202 offset:12288
    v_mfma_f32_16x16x32_bf16 v[124:127], v[84:87], v[164:167], v[124:127]
    s_waitcnt lgkmcnt(14)
    ds_read_b64_tr_b16 v[76:77], v33 offset:128
    v_mfma_f32_16x16x32_bf16 v[148:151], v[84:87], v[168:171], v[148:151]
    s_waitcnt lgkmcnt(14)
    ds_read_b64_tr_b16 v[78:79], v33 offset:896
    s_waitcnt lgkmcnt(14)
    ds_read_b64_tr_b16 v[188:189], v200 offset:16384
    s_waitcnt lgkmcnt(14)
    ds_read_b64_tr_b16 v[190:191], v200 offset:18432
    v_mfma_f32_16x16x32_bf16 v[128:131], v[88:91], v[164:167], v[128:131]
    s_waitcnt lgkmcnt(14)
    ds_read_b64_tr_b16 v[80:81], v34 offset:160
    v_mfma_f32_16x16x32_bf16 v[152:155], v[88:91], v[168:171], v[152:155]
    s_waitcnt lgkmcnt(14)
    ds_read_b64_tr_b16 v[82:83], v34 offset:928
    s_waitcnt lgkmcnt(14)
    ds_read_b64_tr_b16 v[192:193], v200 offset:20480
    s_waitcnt lgkmcnt(14)
    ds_read_b64_tr_b16 v[194:195], v200 offset:22528
    v_mfma_f32_16x16x32_bf16 v[108:111], v[92:95], v[156:159], v[108:111]
    s_waitcnt lgkmcnt(14)
    ds_read_b128 v[164:167], v22 offset:0
    v_mfma_f32_16x16x32_bf16 v[132:135], v[92:95], v[160:163], v[132:135]
    s_waitcnt lgkmcnt(14)
    ds_read_b128 v[168:171], v22 offset:2048
    v_mfma_f32_16x16x32_bf16 v[60:63], v[92:95], v[40:43], v[60:63]
    s_waitcnt lgkmcnt(14)
    ds_read_b64_tr_b16 v[84:85], v30 offset:6144
    s_waitcnt lgkmcnt(14)
    ds_read_b64_tr_b16 v[86:87], v30 offset:6912
    buffer_store_dwordx4 v[172:175], v203, s[12:15], s46 offen sc1
    v_mfma_f32_16x16x32_bf16 v[112:115], v[96:99], v[156:159], v[112:115]
    s_waitcnt lgkmcnt(14)
    ds_read_b64_tr_b16 v[88:89], v31 offset:6176
    v_mfma_f32_16x16x32_bf16 v[136:139], v[96:99], v[160:163], v[136:139]
    s_waitcnt lgkmcnt(14)
    ds_read_b64_tr_b16 v[90:91], v31 offset:6944
    v_mfma_f32_16x16x32_bf16 v[44:47], v[40:43], v[156:159], v[44:47]
    buffer_store_dwordx4 v[176:179], v203, s[12:15], s47 offen sc1
    v_mfma_f32_16x16x32_bf16 v[52:55], v[156:159], v[156:159], v[52:55]
    v_mfma_f32_16x16x32_bf16 v[116:119], v[100:103], v[156:159], v[116:119]
    s_waitcnt lgkmcnt(14)
    ds_read_b64_tr_b16 v[92:93], v30 offset:6208
    v_mfma_f32_16x16x32_bf16 v[140:143], v[100:103], v[160:163], v[140:143]
    s_waitcnt lgkmcnt(14)
    ds_read_b64_tr_b16 v[94:95], v30 offset:6976
    v_mfma_f32_16x16x32_bf16 v[48:51], v[40:43], v[160:163], v[48:51]
    buffer_store_dwordx4 v[180:183], v203, s[12:15], s48 offen sc1
    v_mfma_f32_16x16x32_bf16 v[56:59], v[160:163], v[160:163], v[56:59]
    v_mfma_f32_16x16x32_bf16 v[120:123], v[104:107], v[156:159], v[120:123]
    s_waitcnt lgkmcnt(14)
    ds_read_b64_tr_b16 v[96:97], v32 offset:6240
    v_mfma_f32_16x16x32_bf16 v[144:147], v[104:107], v[160:163], v[144:147]
    s_waitcnt lgkmcnt(14)
    ds_read_b64_tr_b16 v[98:99], v32 offset:7008
    v_mfma_f32_16x16x32_bf16 v[64:67], v[104:107], v[40:43], v[64:67]
    buffer_store_dwordx4 v[184:187], v203, s[12:15], s49 offen sc1
    v_mfma_f32_16x16x32_bf16 v[124:127], v[76:79], v[156:159], v[124:127]
    s_waitcnt lgkmcnt(14)
    ds_read_b64_tr_b16 v[100:101], v33 offset:6272
    v_mfma_f32_16x16x32_bf16 v[148:151], v[76:79], v[160:163], v[148:151]
    s_waitcnt lgkmcnt(14)
    ds_read_b64_tr_b16 v[102:103], v33 offset:7040
    buffer_store_dwordx4 v[188:191], v203, s[12:15], s50 offen sc1
    s_waitcnt lgkmcnt(14)
    v_mfma_f32_16x16x32_bf16 v[128:131], v[80:83], v[156:159], v[128:131]
    ds_read_b64_tr_b16 v[104:105], v34 offset:6304
    v_mfma_f32_16x16x32_bf16 v[152:155], v[80:83], v[160:163], v[152:155]
    s_waitcnt lgkmcnt(14)
    ds_read_b64_tr_b16 v[106:107], v34 offset:7072
    s_waitcnt lgkmcnt(14)
    buffer_store_dwordx4 v[192:195], v203, s[12:15], s51 offen sc1
    s_waitcnt lgkmcnt(10)
    v_mfma_f32_16x16x32_bf16 v[108:111], v[84:87], v[164:167], v[108:111]
    v_mfma_f32_16x16x32_bf16 v[132:135], v[84:87], v[168:171], v[132:135]
    v_mfma_f32_16x16x32_bf16 v[60:63], v[84:87], v[40:43], v[60:63]
    s_waitcnt lgkmcnt(8)
    v_mfma_f32_16x16x32_bf16 v[112:115], v[88:91], v[164:167], v[112:115]
    v_mfma_f32_16x16x32_bf16 v[136:139], v[88:91], v[168:171], v[136:139]
    v_mfma_f32_16x16x32_bf16 v[44:47], v[40:43], v[164:167], v[44:47]
    v_mfma_f32_16x16x32_bf16 v[52:55], v[164:167], v[164:167], v[52:55]
    s_waitcnt lgkmcnt(6)
    v_mfma_f32_16x16x32_bf16 v[116:119], v[92:95], v[164:167], v[116:119]
    v_mfma_f32_16x16x32_bf16 v[140:143], v[92:95], v[168:171], v[140:143]
    v_mfma_f32_16x16x32_bf16 v[48:51], v[40:43], v[168:171], v[48:51]
    v_mfma_f32_16x16x32_bf16 v[56:59], v[168:171], v[168:171], v[56:59]
    s_waitcnt lgkmcnt(4)
    v_mfma_f32_16x16x32_bf16 v[120:123], v[96:99], v[164:167], v[120:123]
    v_mfma_f32_16x16x32_bf16 v[144:147], v[96:99], v[168:171], v[144:147]
    v_mfma_f32_16x16x32_bf16 v[64:67], v[96:99], v[40:43], v[64:67]
    s_waitcnt lgkmcnt(2)
    v_mfma_f32_16x16x32_bf16 v[124:127], v[100:103], v[164:167], v[124:127]
    v_mfma_f32_16x16x32_bf16 v[148:151], v[100:103], v[168:171], v[148:151]
    s_waitcnt lgkmcnt(0)
    v_mfma_f32_16x16x32_bf16 v[128:131], v[104:107], v[164:167], v[128:131]
    v_mfma_f32_16x16x32_bf16 v[152:155], v[104:107], v[168:171], v[152:155]
    s_cmp_lg_u32 s3, 0
    s_cbranch_scc1 L_fz_1
    v_lshlrev_b32 v197, 2, v1
    v_mov_b32 v196, 0
    s_lshl_b32 s58, s2, 8
    s_add_u32 s58, s58, 0x1f00000
    buffer_store_dword v196, v197, s[12:15], s58 offen sc1
L_fz_1:
    s_nop 15
    v_lshlrev_b32 v76, 4, v4
    v_add_u32 v77, 0x23000, v76
    s_lshl_b32 s27, s40, 6
    v_add_u32 v78, s27, v77
    s_lshl_b32 s27, s43, 6
    v_add_u32 v79, s27, v77
    s_mov_b32 s28, 0x00010001
    s_mov_b32 s29, 0x00010001
    s_mov_b64 exec, s[28:29]
    ds_write_b128 v78, v[60:63]
    ds_write_b128 v79, v[64:67]
    s_mov_b64 exec, -1
    s_mov_b32 s30, 0x100001
    s_mov_b32 s31, 0x10000100
    s_mov_b32 s32, 0x200002
    s_mov_b32 s33, 0x20000200
    s_mov_b32 s34, 0x400004
    s_mov_b32 s35, 0x40000400
    s_mov_b32 s36, 0x800008
    s_mov_b32 s37, 0x80000800
    v_mov_b32 v80, 0
    v_cndmask_b32_e64 v80, v80, v52, s[30:31]
    v_cndmask_b32_e64 v80, v80, v53, s[32:33]
    v_cndmask_b32_e64 v80, v80, v54, s[34:35]
    v_cndmask_b32_e64 v80, v80, v55, s[36:37]
    v_mov_b32 v81, v80
    s_nop 1
    v_permlane16_swap_b32 v80, v81
    s_nop 0
    v_add_f32 v80, v80, v81
    v_mov_b32 v81, v80
    s_nop 1
    v_permlane32_swap_b32 v80, v81
    s_nop 0
    v_add_f32 v80, v80, v81
    v_mul_f32 v44, 0x3b000000, v44
    v_mul_f32 v80, 0x3b000000, v80
    v_fma_f32 v80, -v44, v44, v80
    v_max_f32 v80, 0, v80
    v_add_f32 v47, 0x3727c5ac, v80
    v_rsq_f32 v45, v47
    s_nop 0
    v_mul_f32 v46, 0x3eb8aa3b, v45
    v_mov_b32 v80, 0
    v_cndmask_b32_e64 v80, v80, v56, s[30:31]
    v_cndmask_b32_e64 v80, v80, v57, s[32:33]
    v_cndmask_b32_e64 v80, v80, v58, s[34:35]
    v_cndmask_b32_e64 v80, v80, v59, s[36:37]
    v_mov_b32 v81, v80
    s_nop 1
    v_permlane16_swap_b32 v80, v81
    s_nop 0
    v_add_f32 v80, v80, v81
    v_mov_b32 v81, v80
    s_nop 1
    v_permlane32_swap_b32 v80, v81
    s_nop 0
    v_add_f32 v80, v80, v81
    v_mul_f32 v48, 0x3b000000, v48
    v_mul_f32 v80, 0x3b000000, v80
    v_fma_f32 v80, -v48, v48, v80
    v_max_f32 v80, 0, v80
    v_add_f32 v51, 0x3727c5ac, v80
    v_rsq_f32 v49, v51
    s_nop 0
    v_mul_f32 v50, 0x3eb8aa3b, v49
    s_waitcnt lgkmcnt(0)
    s_barrier
    s_lshl_b32 s27, s40, 6
    v_add_u32 v82, s27, v77
    ds_read_b128 v[84:87], v82
    s_lshl_b32 s27, s41, 6
    v_add_u32 v83, s27, v77
    ds_read_b128 v[92:95], v83
    s_waitcnt lgkmcnt(1)
    s_mul_i32 s26, s21, 6
    s_add_u32 s26, s26, s40
    s_cmp_lt_u32 s26, 32
    s_cselect_b32 s28, -1, 0
    s_mov_b32 s29, s28
    s_lshl_b32 s26, s26, 16
    v_cndmask_b32_e64 v80, v45, v46, s[28:29]
    v_pk_fma_f32 v[108:109], v[44:45], v[84:85], v[108:109] op_sel:[0,0,0] op_sel_hi:[0,1,1] neg_lo:[1,0,0] neg_hi:[1,0,0]
    v_pk_fma_f32 v[110:111], v[44:45], v[86:87], v[110:111] op_sel:[0,0,0] op_sel_hi:[0,1,1] neg_lo:[1,0,0] neg_hi:[1,0,0]
    v_pk_mul_f32 v[108:109], v[108:109], v[80:81] op_sel:[0,0] op_sel_hi:[1,0]
    v_pk_mul_f32 v[110:111], v[110:111], v[80:81] op_sel:[0,0] op_sel_hi:[1,0]
    v_cvt_pk_bf16_f32 v108, v108, v109
    v_cvt_pk_bf16_f32 v109, v110, v111
    v_cndmask_b32_e64 v80, v49, v50, s[28:29]
    v_pk_fma_f32 v[132:133], v[48:49], v[84:85], v[132:133] op_sel:[0,0,0] op_sel_hi:[0,1,1] neg_lo:[1,0,0] neg_hi:[1,0,0]
    v_pk_fma_f32 v[134:135], v[48:49], v[86:87], v[134:135] op_sel:[0,0,0] op_sel_hi:[0,1,1] neg_lo:[1,0,0] neg_hi:[1,0,0]
    v_pk_mul_f32 v[132:133], v[132:133], v[80:81] op_sel:[0,0] op_sel_hi:[1,0]
    v_pk_mul_f32 v[134:135], v[134:135], v[80:81] op_sel:[0,0] op_sel_hi:[1,0]
    v_cvt_pk_bf16_f32 v110, v132, v133
    v_cvt_pk_bf16_f32 v111, v134, v135
    s_nop 1
    v_permlane16_swap_b32 v108, v110
    v_permlane16_swap_b32 v109, v111
    s_nop 0
    buffer_store_dwordx4 v[108:111], v7, s[12:15], s26 offen sc1
    s_lshl_b32 s27, s42, 6
    v_add_u32 v82, s27, v77
    ds_read_b128 v[84:87], v82
    s_waitcnt lgkmcnt(1)
    s_mul_i32 s26, s21, 6
    s_add_u32 s26, s26, s41
    s_cmp_lt_u32 s26, 32
    s_cselect_b32 s28, -1, 0
    s_mov_b32 s29, s28
    s_lshl_b32 s26, s26, 16
    v_cndmask_b32_e64 v80, v45, v46, s[28:29]
    v_pk_fma_f32 v[112:113], v[44:45], v[92:93], v[112:113] op_sel:[0,0,0] op_sel_hi:[0,1,1] neg_lo:[1,0,0] neg_hi:[1,0,0]
    v_pk_fma_f32 v[114:115], v[44:45], v[94:95], v[114:115] op_sel:[0,0,0] op_sel_hi:[0,1,1] neg_lo:[1,0,0] neg_hi:[1,0,0]
    v_pk_mul_f32 v[112:113], v[112:113], v[80:81] op_sel:[0,0] op_sel_hi:[1,0]
    v_pk_mul_f32 v[114:115], v[114:115], v[80:81] op_sel:[0,0] op_sel_hi:[1,0]
    v_cvt_pk_bf16_f32 v112, v112, v113
    v_cvt_pk_bf16_f32 v113, v114, v115
    v_cndmask_b32_e64 v80, v49, v50, s[28:29]
    v_pk_fma_f32 v[136:137], v[48:49], v[92:93], v[136:137] op_sel:[0,0,0] op_sel_hi:[0,1,1] neg_lo:[1,0,0] neg_hi:[1,0,0]
    v_pk_fma_f32 v[138:139], v[48:49], v[94:95], v[138:139] op_sel:[0,0,0] op_sel_hi:[0,1,1] neg_lo:[1,0,0] neg_hi:[1,0,0]
    v_pk_mul_f32 v[136:137], v[136:137], v[80:81] op_sel:[0,0] op_sel_hi:[1,0]
    v_pk_mul_f32 v[138:139], v[138:139], v[80:81] op_sel:[0,0] op_sel_hi:[1,0]
    v_cvt_pk_bf16_f32 v114, v136, v137
    v_cvt_pk_bf16_f32 v115, v138, v139
    s_nop 1
    v_permlane16_swap_b32 v112, v114
    v_permlane16_swap_b32 v113, v115
    s_nop 0
    buffer_store_dwordx4 v[112:115], v7, s[12:15], s26 offen sc1
    s_lshl_b32 s27, s43, 6
    v_add_u32 v83, s27, v77
    ds_read_b128 v[92:95], v83
    s_waitcnt lgkmcnt(1)
    s_mul_i32 s26, s21, 6
    s_add_u32 s26, s26, s42
    s_cmp_lt_u32 s26, 32
    s_cselect_b32 s28, -1, 0
    s_mov_b32 s29, s28
    s_lshl_b32 s26, s26, 16
    v_cndmask_b32_e64 v80, v45, v46, s[28:29]
    v_pk_fma_f32 v[116:117], v[44:45], v[84:85], v[116:117] op_sel:[0,0,0] op_sel_hi:[0,1,1] neg_lo:[1,0,0] neg_hi:[1,0,0]
    v_pk_fma_f32 v[118:119], v[44:45], v[86:87], v[118:119] op_sel:[0,0,0] op_sel_hi:[0,1,1] neg_lo:[1,0,0] neg_hi:[1,0,0]
    v_pk_mul_f32 v[116:117], v[116:117], v[80:81] op_sel:[0,0] op_sel_hi:[1,0]
    v_pk_mul_f32 v[118:119], v[118:119], v[80:81] op_sel:[0,0] op_sel_hi:[1,0]
    v_cvt_pk_bf16_f32 v116, v116, v117
    v_cvt_pk_bf16_f32 v117, v118, v119
    v_cndmask_b32_e64 v80, v49, v50, s[28:29]
    v_pk_fma_f32 v[140:141], v[48:49], v[84:85], v[140:141] op_sel:[0,0,0] op_sel_hi:[0,1,1] neg_lo:[1,0,0] neg_hi:[1,0,0]
    v_pk_fma_f32 v[142:143], v[48:49], v[86:87], v[142:143] op_sel:[0,0,0] op_sel_hi:[0,1,1] neg_lo:[1,0,0] neg_hi:[1,0,0]
    v_pk_mul_f32 v[140:141], v[140:141], v[80:81] op_sel:[0,0] op_sel_hi:[1,0]
    v_pk_mul_f32 v[142:143], v[142:143], v[80:81] op_sel:[0,0] op_sel_hi:[1,0]
    v_cvt_pk_bf16_f32 v118, v140, v141
    v_cvt_pk_bf16_f32 v119, v142, v143
    s_nop 1
    v_permlane16_swap_b32 v116, v118
    v_permlane16_swap_b32 v117, v119
    s_nop 0
    buffer_store_dwordx4 v[116:119], v7, s[12:15], s26 offen sc1
    s_lshl_b32 s27, s44, 6
    v_add_u32 v82, s27, v77
    ds_read_b128 v[84:87], v82
    s_waitcnt lgkmcnt(1)
    s_mul_i32 s26, s21, 6
    s_add_u32 s26, s26, s43
    s_cmp_lt_u32 s26, 32
    s_cselect_b32 s28, -1, 0
    s_mov_b32 s29, s28
    s_lshl_b32 s26, s26, 16
    v_cndmask_b32_e64 v80, v45, v46, s[28:29]
    v_pk_fma_f32 v[120:121], v[44:45], v[92:93], v[120:121] op_sel:[0,0,0] op_sel_hi:[0,1,1] neg_lo:[1,0,0] neg_hi:[1,0,0]
    v_pk_fma_f32 v[122:123], v[44:45], v[94:95], v[122:123] op_sel:[0,0,0] op_sel_hi:[0,1,1] neg_lo:[1,0,0] neg_hi:[1,0,0]
    v_pk_mul_f32 v[120:121], v[120:121], v[80:81] op_sel:[0,0] op_sel_hi:[1,0]
    v_pk_mul_f32 v[122:123], v[122:123], v[80:81] op_sel:[0,0] op_sel_hi:[1,0]
    v_cvt_pk_bf16_f32 v120, v120, v121
    v_cvt_pk_bf16_f32 v121, v122, v123
    v_cndmask_b32_e64 v80, v49, v50, s[28:29]
    v_pk_fma_f32 v[144:145], v[48:49], v[92:93], v[144:145] op_sel:[0,0,0] op_sel_hi:[0,1,1] neg_lo:[1,0,0] neg_hi:[1,0,0]
    v_pk_fma_f32 v[146:147], v[48:49], v[94:95], v[146:147] op_sel:[0,0,0] op_sel_hi:[0,1,1] neg_lo:[1,0,0] neg_hi:[1,0,0]
    v_pk_mul_f32 v[144:145], v[144:145], v[80:81] op_sel:[0,0] op_sel_hi:[1,0]
    v_pk_mul_f32 v[146:147], v[146:147], v[80:81] op_sel:[0,0] op_sel_hi:[1,0]
    v_cvt_pk_bf16_f32 v122, v144, v145
    v_cvt_pk_bf16_f32 v123, v146, v147
    s_nop 1
    v_permlane16_swap_b32 v120, v122
    v_permlane16_swap_b32 v121, v123
    s_nop 0
    buffer_store_dwordx4 v[120:123], v7, s[12:15], s26 offen sc1
    s_lshl_b32 s27, s45, 6
    v_add_u32 v83, s27, v77
    ds_read_b128 v[92:95], v83
    s_waitcnt lgkmcnt(1)
    s_mul_i32 s26, s21, 6
    s_add_u32 s26, s26, s44
    s_cmp_lt_u32 s26, 32
    s_cselect_b32 s28, -1, 0
    s_mov_b32 s29, s28
    s_lshl_b32 s26, s26, 16
    v_cndmask_b32_e64 v80, v45, v46, s[28:29]
    v_pk_fma_f32 v[124:125], v[44:45], v[84:85], v[124:125] op_sel:[0,0,0] op_sel_hi:[0,1,1] neg_lo:[1,0,0] neg_hi:[1,0,0]
    v_pk_fma_f32 v[126:127], v[44:45], v[86:87], v[126:127] op_sel:[0,0,0] op_sel_hi:[0,1,1] neg_lo:[1,0,0] neg_hi:[1,0,0]
    v_pk_mul_f32 v[124:125], v[124:125], v[80:81] op_sel:[0,0] op_sel_hi:[1,0]
    v_pk_mul_f32 v[126:127], v[126:127], v[80:81] op_sel:[0,0] op_sel_hi:[1,0]
    v_cvt_pk_bf16_f32 v124, v124, v125
    v_cvt_pk_bf16_f32 v125, v126, v127
    v_cndmask_b32_e64 v80, v49, v50, s[28:29]
    v_pk_fma_f32 v[148:149], v[48:49], v[84:85], v[148:149] op_sel:[0,0,0] op_sel_hi:[0,1,1] neg_lo:[1,0,0] neg_hi:[1,0,0]
    v_pk_fma_f32 v[150:151], v[48:49], v[86:87], v[150:151] op_sel:[0,0,0] op_sel_hi:[0,1,1] neg_lo:[1,0,0] neg_hi:[1,0,0]
    v_pk_mul_f32 v[148:149], v[148:149], v[80:81] op_sel:[0,0] op_sel_hi:[1,0]
    v_pk_mul_f32 v[150:151], v[150:151], v[80:81] op_sel:[0,0] op_sel_hi:[1,0]
    v_cvt_pk_bf16_f32 v126, v148, v149
    v_cvt_pk_bf16_f32 v127, v150, v151
    s_nop 1
    v_permlane16_swap_b32 v124, v126
    v_permlane16_swap_b32 v125, v127
    s_nop 0
    buffer_store_dwordx4 v[124:127], v7, s[12:15], s26 offen sc1
    s_waitcnt lgkmcnt(0)
    s_mul_i32 s26, s21, 6
    s_add_u32 s26, s26, s45
    s_cmp_lt_u32 s26, 32
    s_cselect_b32 s28, -1, 0
    s_mov_b32 s29, s28
    s_lshl_b32 s26, s26, 16
    v_cndmask_b32_e64 v80, v45, v46, s[28:29]
    v_pk_fma_f32 v[128:129], v[44:45], v[92:93], v[128:129] op_sel:[0,0,0] op_sel_hi:[0,1,1] neg_lo:[1,0,0] neg_hi:[1,0,0]
    v_pk_fma_f32 v[130:131], v[44:45], v[94:95], v[130:131] op_sel:[0,0,0] op_sel_hi:[0,1,1] neg_lo:[1,0,0] neg_hi:[1,0,0]
    v_pk_mul_f32 v[128:129], v[128:129], v[80:81] op_sel:[0,0] op_sel_hi:[1,0]
    v_pk_mul_f32 v[130:131], v[130:131], v[80:81] op_sel:[0,0] op_sel_hi:[1,0]
    v_cvt_pk_bf16_f32 v128, v128, v129
    v_cvt_pk_bf16_f32 v129, v130, v131
    v_cndmask_b32_e64 v80, v49, v50, s[28:29]
    v_pk_fma_f32 v[152:153], v[48:49], v[92:93], v[152:153] op_sel:[0,0,0] op_sel_hi:[0,1,1] neg_lo:[1,0,0] neg_hi:[1,0,0]
    v_pk_fma_f32 v[154:155], v[48:49], v[94:95], v[154:155] op_sel:[0,0,0] op_sel_hi:[0,1,1] neg_lo:[1,0,0] neg_hi:[1,0,0]
    v_pk_mul_f32 v[152:153], v[152:153], v[80:81] op_sel:[0,0] op_sel_hi:[1,0]
    v_pk_mul_f32 v[154:155], v[154:155], v[80:81] op_sel:[0,0] op_sel_hi:[1,0]
    v_cvt_pk_bf16_f32 v130, v152, v153
    v_cvt_pk_bf16_f32 v131, v154, v155
    s_nop 1
    v_permlane16_swap_b32 v128, v130
    v_permlane16_swap_b32 v129, v131
    s_nop 0
    buffer_store_dwordx4 v[128:131], v7, s[12:15], s26 offen sc1
L_end_k1_qkv_kernel:
    s_endpgm
.globl k2_mega_kernel
.p2align 8
.type k2_mega_kernel,@function
k2_mega_kernel:
    s_cmp_ge_u32 s2, 256
    s_cbranch_scc1 L_end_k2_mega_kernel
    s_load_dwordx16 s[64:79], s[0:1], 0
    s_load_dwordx4 s[80:83], s[0:1], 64
    v_and_b32 v1, 63, v0
    v_lshrrev_b32 v2, 6, v0
    s_nop 0
    v_readfirstlane_b32 s3, v2
    s_and_b32 s24, s2, 7
    s_lshr_b32 s25, s2, 3
    s_and_b32 s26, s25, 1
    s_lshl_b32 s27, s24, 1
    s_add_u32 s16, s27, s26
    s_lshr_b32 s17, s25, 1
    s_lshr_b32 s26, s25, 4
    s_add_u32 s18, s27, s26
    s_bfe_u32 s19, s25, 0x10003
    s_and_b32 s20, s25, 7
    s_and_b32 s26, s2, 3
    s_lshl_b32 s26, s26, 2
    s_and_b32 s27, s25, 3
    s_add_u32 s21, s26, s27
    s_bfe_u32 s26, s2, 0x10002
    s_lshl_b32 s26, s26, 3
    s_lshr_b32 s27, s25, 2
    s_add_u32 s22, s26, s27
    s_and_b32 s24, s3, 1
    s_lshr_b32 s25, s3, 1
    s_lshl_b32 s26, s16, 1
    s_add_u32 s26, s26, s24
    s_lshl_b32 s26, s26, 16
    s_lshl_b32 s27, s17, 12
    s_add_u32 s26, s26, s27
    s_lshl_b32 s27, s25, 10
    s_add_u32 s27, s26, s27
    s_add_u32 s28, s27, 0x1fe000
    s_mul_i32 s29, s25, 6144
    s_add_u32 s30, s26, s29
    s_add_u32 s30, s30, 0x3fe000
    s_mul_i32 s31, s24, 12288
    s_add_u32 s29, s29, s31
    v_lshlrev_b32 v2, 4, v1
    v_and_b32 v3, 31, v1
    v_lshrrev_b32 v4, 5, v1
    v_lshlrev_b32 v13, 5, v3
    v_lshl_add_u32 v13, v4, 4, v13
    s_mov_b32 s36, s27
    s_mov_b32 s37, s28
    s_cmp_ge_u32 s21, 14
    s_cselect_b32 s32, 2, 0
    s_sub_u32 s32, s21, s32
    s_lshl_b32 s32, s32, 2
    s_add_u32 s32, s32, s3
    s_lshl_b32 s32, s32, 16
    s_add_u32 s23, s32, 0x1900000
    v_and_b32 v6, 15, v1
    v_lshlrev_b32 v6, 10, v6
    v_lshrrev_b32 v7, 4, v1
    v_lshl_add_u32 v6, v7, 3, v6
    s_lshl_b32 s32, s18, 3
    s_lshl_b32 s33, s25, 1
    s_add_u32 s32, s32, s33
    s_add_u32 s32, s32, s19
    s_lshl_b32 s32, s32, 14
    s_lshl_b32 s33, s20, 7
    s_add_u32 s32, s32, s33
    s_lshl_b32 s33, s24, 6
    s_add_u32 s32, s32, s33
    s_add_u32 s33, s32, 65536
    s_waitcnt lgkmcnt(0)
    s_mov_b32 s4, s82
    s_mov_b32 s5, s83
    s_mov_b32 s6, 0x2000000
    s_mov_b32 s7, 0x00020000
    buffer_load_dwordx4 v[24:27], v13, s[4:7], s36 offen
    buffer_load_dwordx4 v[128:131], v13, s[4:7], s37 offen offset:0
    buffer_load_dwordx4 v[132:135], v13, s[4:7], s37 offen offset:1024
    buffer_load_dwordx4 v[28:31], v13, s[4:7], s36 offen offset:2048
    buffer_load_dwordx4 v[136:139], v13, s[4:7], s37 offen offset:2048
    buffer_load_dwordx4 v[140:143], v13, s[4:7], s37 offen offset:3072
    s_add_u32 s38, s37, 4096
    buffer_load_dwordx4 v[144:147], v13, s[4:7], s38 offen offset:0
    buffer_load_dwordx4 v[148:151], v13, s[4:7], s38 offen offset:1024
    buffer_load_dwordx4 v[152:155], v13, s[4:7], s38 offen offset:2048
    buffer_load_dwordx4 v[156:159], v13, s[4:7], s38 offen offset:3072
    s_add_u32 s38, s37, 8192
    buffer_load_dwordx4 v[160:163], v13, s[4:7], s38 offen offset:0
    buffer_load_dwordx4 v[164:167], v13, s[4:7], s38 offen offset:1024
    buffer_load_dwordx4 v[168:171], v13, s[4:7], s38 offen offset:2048
    s_add_u32 m0, s29, 0
    s_nop 0
    buffer_load_dwordx4 v2, s[4:7], s30 offen lds
    s_add_u32 m0, s29, 1024
    s_add_u32 s30, s30, 1024
    buffer_load_dwordx4 v2, s[4:7], s30 offen lds
    s_add_u32 m0, s29, 2048
    s_add_u32 s30, s30, 1024
    buffer_load_dwordx4 v2, s[4:7], s30 offen lds
    s_add_u32 m0, s29, 3072
    s_add_u32 s30, s30, 1024
    buffer_load_dwordx4 v2, s[4:7], s30 offen lds
    s_add_u32 m0, s29, 4096
    s_add_u32 s30, s30, 1024
    buffer_load_dwordx4 v2, s[4:7], s30 offen lds
    s_add_u32 m0, s29, 5120
    s_add_u32 s30, s30, 1024
    buffer_load_dwordx4 v2, s[4:7], s30 offen lds
    s_mov_b32 s8, s64
    s_mov_b32 s9, s65
    s_mov_b32 s10, 0x200000
    s_mov_b32 s11, 0x00020000
    s_mov_b32 s12, s78
    s_mov_b32 s13, s79
    s_mov_b32 s14, 0x200000
    s_mov_b32 s15, 0x00020000
    buffer_load_dwordx2 v[16:17], v6, s[8:11], s32 offen offset:0
    buffer_load_dwordx2 v[18:19], v6, s[8:11], s32 offen offset:32
    buffer_load_dwordx2 v[20:21], v6, s[8:11], s33 offen offset:0
    buffer_load_dwordx2 v[22:23], v6, s[8:11], s33 offen offset:32
    v_mov_b32 v172, 0x3f803f80
    v_mov_b32 v173, 0x3f803f80
    v_mov_b32 v174, 0x3f803f80
    v_mov_b32 v175, 0x3f803f80
    s_mul_i32 s32, s3, 3072
    v_add_u32 v6, s32, v2
    ds_write_b128 v6, v[172:175] offset:24576
    ds_write_b128 v6, v[172:175] offset:25600
    ds_write_b128 v6, v[172:175] offset:26624
    v_and_b32 v6, 31, v1
    v_lshrrev_b32 v7, 5, v1
    v_lshlrev_b32 v7, 2, v7
    v_sub_u32 v6, v6, v7
    v_mov_b32 v7, 0xff7fffff
    v_cmp_gt_i32 vcc, 0, v6
    s_nop 1
    v_cndmask_b32 v80, 0, v7, vcc
    v_cmp_gt_i32 vcc, 1, v6
    s_nop 1
    v_cndmask_b32 v81, 0, v7, vcc
    v_cmp_gt_i32 vcc, 2, v6
    s_nop 1
    v_cndmask_b32 v82, 0, v7, vcc
    v_cmp_gt_i32 vcc, 3, v6
    s_nop 1
    v_cndmask_b32 v83, 0, v7, vcc
    v_cmp_gt_i32 vcc, 8, v6
    s_nop 1
    v_cndmask_b32 v84, 0, v7, vcc
    v_cmp_gt_i32 vcc, 9, v6
    s_nop 1
    v_cndmask_b32 v85, 0, v7, vcc
    v_cmp_gt_i32 vcc, 10, v6
    s_nop 1
    v_cndmask_b32 v86, 0, v7, vcc
    v_cmp_gt_i32 vcc, 11, v6
    s_nop 1
    v_cndmask_b32 v87, 0, v7, vcc
    v_cmp_gt_i32 vcc, 16, v6
    s_nop 1
    v_cndmask_b32 v88, 0, v7, vcc
    v_cmp_gt_i32 vcc, 17, v6
    s_nop 1
    v_cndmask_b32 v89, 0, v7, vcc
    v_cmp_gt_i32 vcc, 18, v6
    s_nop 1
    v_cndmask_b32 v90, 0, v7, vcc
    v_cmp_gt_i32 vcc, 19, v6
    s_nop 1
    v_cndmask_b32 v91, 0, v7, vcc
    v_cmp_gt_i32 vcc, 24, v6
    s_nop 1
    v_cndmask_b32 v92, 0, v7, vcc
    v_cmp_gt_i32 vcc, 25, v6
    s_nop 1
    v_cndmask_b32 v93, 0, v7, vcc
    v_cmp_gt_i32 vcc, 26, v6
    s_nop 1
    v_cndmask_b32 v94, 0, v7, vcc
    v_cmp_gt_i32 vcc, 27, v6
    s_nop 1
    v_cndmask_b32 v95, 0, v7, vcc
    s_mov_b32 s32, 0x05040100
    v_perm_b32 v32, v81, v80, s32
    v_perm_b32 v33, v83, v82, s32
    v_perm_b32 v34, v85, v84, s32
    v_perm_b32 v35, v87, v86, s32
    v_perm_b32 v36, v89, v88, s32
    v_perm_b32 v37, v91, v90, s32
    v_perm_b32 v38, v93, v92, s32
    v_perm_b32 v39, v95, v94, s32
    v_mov_b64 v[64:65], 0
    v_mov_b64 v[66:67], 0
    v_mov_b64 v[68:69], 0
    v_mov_b64 v[70:71], 0
    v_mov_b64 v[72:73], 0
    v_mov_b64 v[74:75], 0
    v_mov_b64 v[76:77], 0
    v_mov_b64 v[78:79], 0
    v_mov_b64 v[80:81], 0
    v_mov_b64 v[82:83], 0
    v_mov_b64 v[84:85], 0
    v_mov_b64 v[86:87], 0
    v_mov_b64 v[88:89], 0
    v_mov_b64 v[90:91], 0
    v_mov_b64 v[92:93], 0
    v_mov_b64 v[94:95], 0
    s_mov_b32 s69, 0
    v_bfe_u32 v6, v1, 2, 2
    v_lshl_add_u32 v6, v4, 2, v6
    v_lshlrev_b32 v6, 5, v6
    v_and_b32 v7, 3, v1
    v_lshl_add_u32 v6, v7, 3, v6
    s_lshl_b32 s32, s25, 10
    s_add_u32 s32, s32, s31
    v_add_u32 v6, s32, v6
    v_lshlrev_b32 v7, 7, v4
    v_sub_u32 v7, 0x6080, v7
    v_bfe_u32 v8, v1, 4, 1
    v_cmp_eq_u32 vcc, 1, v8
    s_nop 1
    v_cndmask_b32 v6, v6, v7, vcc
    v_bfe_u32 v7, v3, 4, 1
    v_lshlrev_b32 v7, 14, v7
    v_and_b32 v8, 15, v3
    v_lshl_add_u32 v7, v8, 4, v7
    v_lshl_add_u32 v7, v4, 8, v7
    s_lshl_b32 s40, s17, 17
    s_lshl_b32 s32, s25, 15
    s_add_u32 s40, s40, s32
    s_lshl_b32 s32, s16, 10
    s_add_u32 s40, s40, s32
    s_lshl_b32 s32, s24, 9
    s_add_u32 s40, s40, s32
    s_add_u32 s40, s40, 0x600000
    s_add_u32 s41, s40, 65536
    s_lshl_b32 s42, s17, 10
    s_lshr_b32 s32, s16, 2
    s_lshl_b32 s32, s32, 8
    s_add_u32 s42, s42, s32
    s_and_b32 s32, s16, 3
    s_lshl_b32 s32, s32, 2
    s_add_u32 s32, s32, s3
    s_lshl_b32 s32, s32, 2
    s_add_u32 s42, s42, s32
    s_add_u32 s42, s42, 0x1f00000
    s_lshl_b32 s32, s24, 11
    v_add_u32 v3, s32, v2
    v_xor_b32 v4, 0x800, v3
    s_lshl_b32 s35, s20, 16
    s_lshl_b32 s33, s3, 14
    s_add_u32 s35, s35, s33
    s_add_u32 s35, s35, 0x1c80000
    v_and_b32 v5, 15, v1
    v_lshlrev_b32 v5, 2, v5
    s_lshl_b32 s43, s18, 2
    s_add_u32 s43, s43, s3
    s_lshl_b32 s43, s43, 8
    s_add_u32 s43, s43, 0x1f00000
    s_lshl_b32 s26, s18, 3
    s_add_u32 s26, s26, s19
    s_lshl_b32 s27, s25, 1
    s_add_u32 s27, s26, s27
    s_xor_b32 s28, s27, 2
    s_lshl_b32 s33, s3, 12
    s_lshl_b32 s44, s27, 14
    s_add_u32 s46, s44, 0x800000
    s_add_u32 s44, s44, s33
    s_add_u32 s44, s44, 0x600000
    s_lshl_b32 s45, s28, 14
    s_add_u32 s45, s45, s33
    s_add_u32 s45, s45, 0x600000
    s_add_u32 s72, s44, 65536
    s_add_u32 s73, s45, 65536
    s_lshl_b32 s33, s20, 1
    s_add_u32 s33, s33, s24
    s_lshl_b32 s34, s33, 10
    s_add_u32 s46, s46, s34
    s_lshl_b32 s47, s18, 14
    s_lshr_b32 s34, s33, 2
    s_lshl_b32 s34, s34, 12
    s_add_u32 s47, s47, s34
    s_and_b32 s34, s27, 7
    s_lshl_b32 s34, s34, 9
    s_add_u32 s47, s47, s34
    s_and_b32 s34, s33, 3
    s_lshl_b32 s34, s34, 7
    s_add_u32 s47, s47, s34
    s_add_u32 s47, s47, 0xa00000
    v_mov_b32 v96, -1
    v_mov_b32 v97, -1
    v_mov_b32 v98, -1
    v_mov_b32 v99, -1
    v_lshrrev_b32 v15, 5, v1
    v_lshl_add_u32 v15, v15, 6, v5
    buffer_store_dwordx4 v[96:99], v7, s[4:7], s40 offen sc1
    buffer_store_dwordx4 v[96:99], v7, s[4:7], s41 offen sc1
    buffer_store_dwordx4 v[96:99], v2, s[4:7], s46 offen sc1
    buffer_store_dword v96, v15, s[4:7], s47 offen sc1
    s_lshl_b32 s48, s18, 2
    s_lshr_b32 s34, s20, 1
    s_add_u32 s48, s48, s34
    s_lshl_b32 s48, s48, 8
    s_and_b32 s34, s20, 1
    s_lshl_b32 s34, s34, 1
    s_add_u32 s34, s34, s19
    s_lshl_b32 s34, s34, 2
    s_add_u32 s34, s34, s3
    s_lshl_b32 s34, s34, 2
    s_add_u32 s48, s48, s34
    s_add_u32 s48, s48, 0x1f04000
    s_lshl_b32 s32, s22, 2
    s_add_u32 s32, s32, s3
    s_lshl_b32 s49, s32, 8
    s_add_u32 s49, s49, 0x1f04000
    s_lshl_b32 s52, s32, 12
    s_add_u32 s52, s52, 0xa00000
    s_lshl_b32 s51, s3, 12
    s_lshl_b32 s50, s22, 17
    s_add_u32 s50, s50, s51
    s_add_u32 s50, s50, 0x800000
    s_lshl_b32 s32, s21, 2
    s_add_u32 s32, s32, s3
    s_mul_i32 s33, s32, 147
    s_lshr_b32 s33, s33, 11
    s_mul_i32 s34, s33, 14
    s_sub_u32 s34, s32, s34
    s_lshl_b32 s54, s22, 3
    s_add_u32 s54, s54, s33
    s_lshl_b32 s54, s54, 8
    s_lshl_b32 s34, s34, 2
    s_add_u32 s54, s54, s34
    s_add_u32 s54, s54, 0x1f08000
    s_mul_i32 s53, s22, 458752
    s_lshl_b32 s34, s32, 10
    s_add_u32 s53, s53, s34
    s_cmp_ge_u32 s21, 14
    s_cselect_b32 s34, 0x6fe000, 0
    s_add_u32 s53, s53, s34
    s_add_u32 s53, s53, 0xb00000
    s_mul_i32 s56, s20, 229376
    s_mul_i32 s34, s3, 57344
    s_add_u32 s56, s56, s34
    s_add_u32 s56, s56, 0x1d00000
    s_lshl_b32 s57, s18, 3
    s_add_u32 s58, s57, s19
    s_add_u32 s57, s57, s3
    s_lshl_b32 s57, s57, 8
    s_add_u32 s57, s57, 0x1f08000
    s_mul_i32 s58, s58, 57344
    s_mul_i32 s34, s3, 14336
    s_add_u32 s58, s58, s34
    s_add_u32 s58, s58, 0xb00000
    v_mov_b32 v220, 0x3f803f80
    v_mov_b32 v221, 0x3f803f80
    v_mov_b32 v222, 0x3f803f80
    v_mov_b32 v223, 0x3f803f80
    s_add_u32 s38, s23, 0
    buffer_load_dwordx4 a[0:3], v2, s[4:7], s38 offen offset:0
    s_add_u32 s38, s23, 0
    buffer_load_dwordx4 a[4:7], v2, s[4:7], s38 offen offset:1024
    s_add_u32 s38, s23, 0
    buffer_load_dwordx4 a[8:11], v2, s[4:7], s38 offen offset:2048
    s_add_u32 s38, s23, 0
    buffer_load_dwordx4 a[12:15], v2, s[4:7], s38 offen offset:3072
    s_lshl_b32 s32, s17, 2
    s_add_u32 s32, s32, s25
    s_cmp_eq_u32 s32, 0
    s_cbranch_scc1 L_var_2
    s_cmp_eq_u32 s32, 1
    s_cbranch_scc1 L_var_3
    s_cmp_eq_u32 s32, 4
    s_cbranch_scc1 L_var_4
    s_cmp_eq_u32 s32, 5
    s_cbranch_scc1 L_var_5
    s_waitcnt vmcnt(12)
    s_waitcnt lgkmcnt(0)
    s_barrier
L_top_7:
    v_mfma_f32_32x32x16_bf16 v[172:187], v[128:131], v[24:27], v[64:79]
    ds_read_b64_tr_b16 v[48:49], v6 offset:0
    ds_read_b64_tr_b16 v[50:51], v6 offset:256
    ds_read_b64_tr_b16 v[52:53], v6 offset:512
    ds_read_b64_tr_b16 v[54:55], v6 offset:768
    v_mfma_f32_32x32x16_bf16 v[188:203], v[132:135], v[24:27], v[64:79]
    s_nop 6
    v_exp_f32 v172, v172
    v_exp_f32 v173, v173
    v_exp_f32 v174, v174
    v_exp_f32 v175, v175
    v_exp_f32 v176, v176
    v_exp_f32 v177, v177
    v_exp_f32 v178, v178
    v_exp_f32 v179, v179
    ds_read_b64_tr_b16 v[56:57], v6 offset:1024
    ds_read_b64_tr_b16 v[58:59], v6 offset:1280
    ds_read_b64_tr_b16 v[60:61], v6 offset:1536
    ds_read_b64_tr_b16 v[62:63], v6 offset:1792
    v_exp_f32 v180, v180
    v_exp_f32 v181, v181
    v_exp_f32 v182, v182
    v_exp_f32 v183, v183
    s_add_u32 s38, s23, 4096
    buffer_load_dwordx4 a[16:19], v2, s[4:7], s38 offen offset:0
    s_add_u32 s38, s23, 4096
    buffer_load_dwordx4 a[20:23], v2, s[4:7], s38 offen offset:1024
    s_add_u32 s38, s23, 4096
    buffer_load_dwordx4 a[24:27], v2, s[4:7], s38 offen offset:2048
    v_exp_f32 v184, v184
    v_exp_f32 v185, v185
    v_exp_f32 v186, v186
    v_exp_f32 v187, v187
    v_cvt_pk_bf16_f32 v40, v172, v173
    v_cvt_pk_bf16_f32 v41, v174, v175
    v_cvt_pk_bf16_f32 v42, v176, v177
    v_cvt_pk_bf16_f32 v43, v178, v179
    v_cvt_pk_bf16_f32 v44, v180, v181
    v_cvt_pk_bf16_f32 v45, v182, v183
    v_cvt_pk_bf16_f32 v46, v184, v185
    v_cvt_pk_bf16_f32 v47, v186, v187
    v_and_b32 v40, v32, v40
    v_and_b32 v41, v33, v41
    v_and_b32 v42, v34, v42
    v_and_b32 v43, v35, v43
    v_and_b32 v44, v36, v44
    v_and_b32 v45, v37, v45
    v_and_b32 v46, v38, v46
    v_and_b32 v47, v39, v47
    v_mfma_f32_32x32x16_bf16 v[172:187], v[136:139], v[24:27], v[64:79]
    v_exp_f32 v188, v188
    v_exp_f32 v189, v189
    v_exp_f32 v190, v190
    v_exp_f32 v191, v191
    s_waitcnt lgkmcnt(4)
    v_mfma_f32_32x32x16_bf16 v[96:111], v[48:51], v[40:43], 0
    v_exp_f32 v192, v192
    v_exp_f32 v193, v193
    v_exp_f32 v194, v194
    v_exp_f32 v195, v195
    v_mfma_f32_32x32x16_bf16 v[96:111], v[52:55], v[44:47], v[96:111]
    ds_read_b64_tr_b16 v[48:49], v6 offset:2048
    ds_read_b64_tr_b16 v[50:51], v6 offset:2304
    ds_read_b64_tr_b16 v[52:53], v6 offset:2560
    ds_read_b64_tr_b16 v[54:55], v6 offset:2816
    v_exp_f32 v196, v196
    v_exp_f32 v197, v197
    v_exp_f32 v198, v198
    v_exp_f32 v199, v199
    s_add_u32 s38, s23, 4096
    buffer_load_dwordx4 a[28:31], v2, s[4:7], s38 offen offset:3072
    s_add_u32 s38, s23, 8192
    buffer_load_dwordx4 a[32:35], v2, s[4:7], s38 offen offset:0
    s_add_u32 s38, s23, 8192
    buffer_load_dwordx4 a[36:39], v2, s[4:7], s38 offen offset:1024
    v_exp_f32 v200, v200
    v_exp_f32 v201, v201
    v_exp_f32 v202, v202
    v_exp_f32 v203, v203
    v_cvt_pk_bf16_f32 v40, v188, v189
    v_cvt_pk_bf16_f32 v41, v190, v191
    v_cvt_pk_bf16_f32 v42, v192, v193
    v_cvt_pk_bf16_f32 v43, v194, v195
    v_cvt_pk_bf16_f32 v44, v196, v197
    v_cvt_pk_bf16_f32 v45, v198, v199
    v_cvt_pk_bf16_f32 v46, v200, v201
    v_cvt_pk_bf16_f32 v47, v202, v203
    v_mfma_f32_32x32x16_bf16 v[188:203], v[140:143], v[24:27], v[64:79]
    v_exp_f32 v172, v172
    v_exp_f32 v173, v173
    v_exp_f32 v174, v174
    v_exp_f32 v175, v175
    s_waitcnt lgkmcnt(4)
    v_mfma_f32_32x32x16_bf16 v[96:111], v[56:59], v[40:43], v[96:111]
    v_exp_f32 v176, v176
    v_exp_f32 v177, v177
    v_exp_f32 v178, v178
    v_exp_f32 v179, v179
    v_mfma_f32_32x32x16_bf16 v[96:111], v[60:63], v[44:47], v[96:111]
    ds_read_b64_tr_b16 v[56:57], v6 offset:3072
    ds_read_b64_tr_b16 v[58:59], v6 offset:3328
    ds_read_b64_tr_b16 v[60:61], v6 offset:3584
    ds_read_b64_tr_b16 v[62:63], v6 offset:3840
    v_exp_f32 v180, v180
    v_exp_f32 v181, v181
    v_exp_f32 v182, v182
    v_exp_f32 v183, v183
    s_add_u32 s38, s23, 8192
    buffer_load_dwordx4 a[40:43], v2, s[4:7], s38 offen offset:2048
    s_add_u32 s38, s23, 8192
    buffer_load_dwordx4 a[44:47], v2, s[4:7], s38 offen offset:3072
    s_add_u32 s38, s23, 12288
    buffer_load_dwordx4 a[48:51], v2, s[4:7], s38 offen offset:0
    v_exp_f32 v184, v184
    v_exp_f32 v185, v185
    v_exp_f32 v186, v186
    v_exp_f32 v187, v187
    v_cvt_pk_bf16_f32 v40, v172, v173
    v_cvt_pk_bf16_f32 v41, v174, v175
    v_cvt_pk_bf16_f32 v42, v176, v177
    v_cvt_pk_bf16_f32 v43, v178, v179
    v_cvt_pk_bf16_f32 v44, v180, v181
    v_cvt_pk_bf16_f32 v45, v182, v183
    v_cvt_pk_bf16_f32 v46, v184, v185
    v_cvt_pk_bf16_f32 v47, v186, v187
    v_mfma_f32_32x32x16_bf16 v[172:187], v[144:147], v[24:27], v[64:79]
    v_exp_f32 v188, v188
    v_exp_f32 v189, v189
    v_exp_f32 v190, v190
    v_exp_f32 v191, v191
    s_waitcnt lgkmcnt(4)
    v_mfma_f32_32x32x16_bf16 v[96:111], v[48:51], v[40:43], v[96:111]
    v_exp_f32 v192, v192
    v_exp_f32 v193, v193
    v_exp_f32 v194, v194
    v_exp_f32 v195, v195
    v_mfma_f32_32x32x16_bf16 v[96:111], v[52:55], v[44:47], v[96:111]
    ds_read_b64_tr_b16 v[48:49], v6 offset:4096
    ds_read_b64_tr_b16 v[50:51], v6 offset:4352
    ds_read_b64_tr_b16 v[52:53], v6 offset:4608
    ds_read_b64_tr_b16 v[54:55], v6 offset:4864
    v_exp_f32 v196, v196
    v_exp_f32 v197, v197
    v_exp_f32 v198, v198
    v_exp_f32 v199, v199
    s_add_u32 s38, s23, 12288
    buffer_load_dwordx4 a[52:55], v2, s[4:7], s38 offen offset:1024
    s_add_u32 s38, s23, 12288
    buffer_load_dwordx4 a[56:59], v2, s[4:7], s38 offen offset:2048
    s_add_u32 s38, s23, 12288
    buffer_load_dwordx4 a[60:63], v2, s[4:7], s38 offen offset:3072
    v_exp_f32 v200, v200
    v_exp_f32 v201, v201
    v_exp_f32 v202, v202
    v_exp_f32 v203, v203
    v_cvt_pk_bf16_f32 v40, v188, v189
    v_cvt_pk_bf16_f32 v41, v190, v191
    v_cvt_pk_bf16_f32 v42, v192, v193
    v_cvt_pk_bf16_f32 v43, v194, v195
    v_cvt_pk_bf16_f32 v44, v196, v197
    v_cvt_pk_bf16_f32 v45, v198, v199
    v_cvt_pk_bf16_f32 v46, v200, v201
    v_cvt_pk_bf16_f32 v47, v202, v203
    v_mfma_f32_32x32x16_bf16 v[188:203], v[148:151], v[24:27], v[64:79]
    v_exp_f32 v172, v172
    v_exp_f32 v173, v173
    v_exp_f32 v174, v174
    v_exp_f32 v175, v175
    s_waitcnt lgkmcnt(4)
    v_mfma_f32_32x32x16_bf16 v[96:111], v[56:59], v[40:43], v[96:111]
    v_exp_f32 v176, v176
    v_exp_f32 v177, v177
    v_exp_f32 v178, v178
    v_exp_f32 v179, v179
    v_mfma_f32_32x32x16_bf16 v[96:111], v[60:63], v[44:47], v[96:111]
    ds_read_b64_tr_b16 v[56:57], v6 offset:5120
    ds_read_b64_tr_b16 v[58:59], v6 offset:5376
    ds_read_b64_tr_b16 v[60:61], v6 offset:5632
    ds_read_b64_tr_b16 v[62:63], v6 offset:5888
    v_exp_f32 v180, v180
    v_exp_f32 v181, v181
    v_exp_f32 v182, v182
    v_exp_f32 v183, v183
    s_add_u32 s38, s23, 16384
    buffer_load_dwordx4 a[64:67], v2, s[4:7], s38 offen offset:0
    s_add_u32 s38, s23, 16384
    buffer_load_dwordx4 a[68:71], v2, s[4:7], s38 offen offset:1024
    s_add_u32 s38, s23, 16384
    buffer_load_dwordx4 a[72:75], v2, s[4:7], s38 offen offset:2048
    v_exp_f32 v184, v184
    v_exp_f32 v185, v185
    v_exp_f32 v186, v186
    v_exp_f32 v187, v187
    v_cvt_pk_bf16_f32 v40, v172, v173
    v_cvt_pk_bf16_f32 v41, v174, v175
    v_cvt_pk_bf16_f32 v42, v176, v177
    v_cvt_pk_bf16_f32 v43, v178, v179
    v_cvt_pk_bf16_f32 v44, v180, v181
    v_cvt_pk_bf16_f32 v45, v182, v183
    v_cvt_pk_bf16_f32 v46, v184, v185
    v_cvt_pk_bf16_f32 v47, v186, v187
    v_mfma_f32_32x32x16_bf16 v[172:187], v[152:155], v[24:27], v[64:79]
    v_exp_f32 v188, v188
    v_exp_f32 v189, v189
    v_exp_f32 v190, v190
    v_exp_f32 v191, v191
    s_waitcnt lgkmcnt(4)
    v_mfma_f32_32x32x16_bf16 v[96:111], v[48:51], v[40:43], v[96:111]
    v_exp_f32 v192, v192
    v_exp_f32 v193, v193
    v_exp_f32 v194, v194
    v_exp_f32 v195, v195
    v_mfma_f32_32x32x16_bf16 v[96:111], v[52:55], v[44:47], v[96:111]
    ds_read_b64_tr_b16 v[48:49], v6 offset:6144
    ds_read_b64_tr_b16 v[50:51], v6 offset:6400
    ds_read_b64_tr_b16 v[52:53], v6 offset:6656
    ds_read_b64_tr_b16 v[54:55], v6 offset:6912
    v_exp_f32 v196, v196
    v_exp_f32 v197, v197
    v_exp_f32 v198, v198
    v_exp_f32 v199, v199
    s_add_u32 s38, s23, 16384
    buffer_load_dwordx4 a[76:79], v2, s[4:7], s38 offen offset:3072
    s_add_u32 s38, s23, 20480
    buffer_load_dwordx4 a[80:83], v2, s[4:7], s38 offen offset:0
    s_add_u32 s38, s23, 20480
    buffer_load_dwordx4 a[84:87], v2, s[4:7], s38 offen offset:1024
    v_exp_f32 v200, v200
    v_exp_f32 v201, v201
    v_exp_f32 v202, v202
    v_exp_f32 v203, v203
    v_cvt_pk_bf16_f32 v40, v188, v189
    v_cvt_pk_bf16_f32 v41, v190, v191
    v_cvt_pk_bf16_f32 v42, v192, v193
    v_cvt_pk_bf16_f32 v43, v194, v195
    v_cvt_pk_bf16_f32 v44, v196, v197
    v_cvt_pk_bf16_f32 v45, v198, v199
    v_cvt_pk_bf16_f32 v46, v200, v201
    v_cvt_pk_bf16_f32 v47, v202, v203
    v_mfma_f32_32x32x16_bf16 v[188:203], v[156:159], v[24:27], v[64:79]
    v_exp_f32 v172, v172
    v_exp_f32 v173, v173
    v_exp_f32 v174, v174
    v_exp_f32 v175, v175
    s_waitcnt lgkmcnt(4)
    v_mfma_f32_32x32x16_bf16 v[96:111], v[56:59], v[40:43], v[96:111]
    v_exp_f32 v176, v176
    v_exp_f32 v177, v177
    v_exp_f32 v178, v178
    v_exp_f32 v179, v179
    v_mfma_f32_32x32x16_bf16 v[96:111], v[60:63], v[44:47], v[96:111]
    ds_read_b64_tr_b16 v[56:57], v6 offset:7168
    ds_read_b64_tr_b16 v[58:59], v6 offset:7424
    ds_read_b64_tr_b16 v[60:61], v6 offset:7680
    ds_read_b64_tr_b16 v[62:63], v6 offset:7936
    v_exp_f32 v180, v180
    v_exp_f32 v181, v181
    v_exp_f32 v182, v182
    v_exp_f32 v183, v183
    s_add_u32 s38, s23, 20480
    buffer_load_dwordx4 a[88:91], v2, s[4:7], s38 offen offset:2048
    s_add_u32 s38, s23, 20480
    buffer_load_dwordx4 a[92:95], v2, s[4:7], s38 offen offset:3072
    s_add_u32 s38, s23, 24576
    buffer_load_dwordx4 a[96:99], v2, s[4:7], s38 offen offset:0
    v_exp_f32 v184, v184
    v_exp_f32 v185, v185
    v_exp_f32 v186, v186
    v_exp_f32 v187, v187
    v_cvt_pk_bf16_f32 v40, v172, v173
    v_cvt_pk_bf16_f32 v41, v174, v175
    v_cvt_pk_bf16_f32 v42, v176, v177
    v_cvt_pk_bf16_f32 v43, v178, v179
    v_cvt_pk_bf16_f32 v44, v180, v181
    v_cvt_pk_bf16_f32 v45, v182, v183
    v_cvt_pk_bf16_f32 v46, v184, v185
    v_cvt_pk_bf16_f32 v47, v186, v187
    v_mfma_f32_32x32x16_bf16 v[172:187], v[160:163], v[24:27], v[64:79]
    v_exp_f32 v188, v188
    v_exp_f32 v189, v189
    v_exp_f32 v190, v190
    v_exp_f32 v191, v191
    s_waitcnt lgkmcnt(4)
    v_mfma_f32_32x32x16_bf16 v[96:111], v[48:51], v[40:43], v[96:111]
    v_exp_f32 v192, v192
    v_exp_f32 v193, v193
    v_exp_f32 v194, v194
    v_exp_f32 v195, v195
    v_mfma_f32_32x32x16_bf16 v[96:111], v[52:55], v[44:47], v[96:111]
    ds_read_b64_tr_b16 v[48:49], v6 offset:8192
    ds_read_b64_tr_b16 v[50:51], v6 offset:8448
    ds_read_b64_tr_b16 v[52:53], v6 offset:8704
    ds_read_b64_tr_b16 v[54:55], v6 offset:8960
    v_exp_f32 v196, v196
    v_exp_f32 v197, v197
    v_exp_f32 v198, v198
    v_exp_f32 v199, v199
    s_add_u32 s38, s23, 24576
    buffer_load_dwordx4 a[100:103], v2, s[4:7], s38 offen offset:1024
    s_add_u32 s38, s23, 24576
    buffer_load_dwordx4 a[104:107], v2, s[4:7], s38 offen offset:2048
    s_add_u32 s38, s23, 24576
    buffer_load_dwordx4 a[108:111], v2, s[4:7], s38 offen offset:3072
    s_add_u32 s38, s35, 0
    buffer_load_dwordx4 v[204:207], v3, s[4:7], s38 offen offset:0
    s_add_u32 s38, s35, 0
    buffer_load_dwordx4 v[208:211], v3, s[4:7], s38 offen offset:1024
    v_exp_f32 v200, v200
    v_exp_f32 v201, v201
    v_exp_f32 v202, v202
    v_exp_f32 v203, v203
    v_cvt_pk_bf16_f32 v40, v188, v189
    v_cvt_pk_bf16_f32 v41, v190, v191
    v_cvt_pk_bf16_f32 v42, v192, v193
    v_cvt_pk_bf16_f32 v43, v194, v195
    v_cvt_pk_bf16_f32 v44, v196, v197
    v_cvt_pk_bf16_f32 v45, v198, v199
    v_cvt_pk_bf16_f32 v46, v200, v201
    v_cvt_pk_bf16_f32 v47, v202, v203
    v_mfma_f32_32x32x16_bf16 v[188:203], v[136:139], v[28:31], v[80:95]
    v_exp_f32 v172, v172
    v_exp_f32 v173, v173
    v_exp_f32 v174, v174
    v_exp_f32 v175, v175
    s_waitcnt lgkmcnt(4)
    v_mfma_f32_32x32x16_bf16 v[96:111], v[56:59], v[40:43], v[96:111]
    v_exp_f32 v176, v176
    v_exp_f32 v177, v177
    v_exp_f32 v178, v178
    v_exp_f32 v179, v179
    v_mfma_f32_32x32x16_bf16 v[96:111], v[60:63], v[44:47], v[96:111]
    ds_read_b64_tr_b16 v[56:57], v6 offset:2048
    ds_read_b64_tr_b16 v[58:59], v6 offset:2304
    ds_read_b64_tr_b16 v[60:61], v6 offset:2560
    ds_read_b64_tr_b16 v[62:63], v6 offset:2816
    v_exp_f32 v180, v180
    v_exp_f32 v181, v181
    v_exp_f32 v182, v182
    v_exp_f32 v183, v183
    s_add_u32 s38, s23, 28672
    buffer_load_dwordx4 a[112:115], v2, s[4:7], s38 offen offset:0
    s_add_u32 s38, s23, 28672
    buffer_load_dwordx4 a[116:119], v2, s[4:7], s38 offen offset:1024
    s_add_u32 s38, s23, 28672
    buffer_load_dwordx4 a[120:123], v2, s[4:7], s38 offen offset:2048
    s_add_u32 s38, s35, 0
    buffer_load_dwordx4 v[212:215], v4, s[4:7], s38 offen offset:0
    s_add_u32 s38, s35, 0
    buffer_load_dwordx4 v[216:219], v4, s[4:7], s38 offen offset:1024
    v_exp_f32 v184, v184
    v_exp_f32 v185, v185
    v_exp_f32 v186, v186
    v_exp_f32 v187, v187
    v_cvt_pk_bf16_f32 v40, v172, v173
    v_cvt_pk_bf16_f32 v41, v174, v175
    v_cvt_pk_bf16_f32 v42, v176, v177
    v_cvt_pk_bf16_f32 v43, v178, v179
    v_cvt_pk_bf16_f32 v44, v180, v181
    v_cvt_pk_bf16_f32 v45, v182, v183
    v_cvt_pk_bf16_f32 v46, v184, v185
    v_cvt_pk_bf16_f32 v47, v186, v187
    v_bfi_b32 v40, v32, 0, v40
    v_bfi_b32 v41, v33, 0, v41
    v_bfi_b32 v42, v34, 0, v42
    v_bfi_b32 v43, v35, 0, v43
    v_bfi_b32 v44, v36, 0, v44
    v_bfi_b32 v45, v37, 0, v45
    v_bfi_b32 v46, v38, 0, v46
    v_bfi_b32 v47, v39, 0, v47
    v_mfma_f32_32x32x16_bf16 v[172:187], v[140:143], v[28:31], v[80:95]
    v_exp_f32 v188, v188
    v_exp_f32 v189, v189
    v_exp_f32 v190, v190
    v_exp_f32 v191, v191
    s_waitcnt lgkmcnt(4)
    v_mfma_f32_32x32x16_bf16 v[96:111], v[48:51], v[40:43], v[96:111]
    v_exp_f32 v192, v192
    v_exp_f32 v193, v193
    v_exp_f32 v194, v194
    v_exp_f32 v195, v195
    v_mfma_f32_32x32x16_bf16 v[96:111], v[52:55], v[44:47], v[96:111]
    ds_read_b64_tr_b16 v[48:49], v6 offset:3072
    ds_read_b64_tr_b16 v[50:51], v6 offset:3328
    ds_read_b64_tr_b16 v[52:53], v6 offset:3584
    ds_read_b64_tr_b16 v[54:55], v6 offset:3840
    v_exp_f32 v196, v196
    v_exp_f32 v197, v197
    v_exp_f32 v198, v198
    v_exp_f32 v199, v199
    s_add_u32 s38, s23, 28672
    buffer_load_dwordx4 a[124:127], v2, s[4:7], s38 offen offset:3072
    s_add_u32 s38, s35, 4096
    buffer_load_dwordx4 v[64:67], v3, s[4:7], s38 offen offset:0
    s_add_u32 s38, s35, 4096
    buffer_load_dwordx4 v[68:71], v3, s[4:7], s38 offen offset:1024
    v_exp_f32 v200, v200
    v_exp_f32 v201, v201
    v_exp_f32 v202, v202
    v_exp_f32 v203, v203
    v_subrev_u32 v12, 0x21800000, v104
    v_cmp_gt_u32 vcc, 0x3c000000, v12
    s_cmp_eq_u64 vcc, -1
    s_nop 3
    s_cbranch_scc0 L_fbs_9
L_fbc_10:
    s_waitcnt vmcnt(38)
    v_rcp_f32 v104, v104
    s_nop 0
    v_mul_f32 v96, v96, v104
    v_mul_f32 v97, v97, v104
    v_mul_f32 v98, v98, v104
    v_mul_f32 v99, v99, v104
    v_mul_f32 v100, v100, v104
    v_mul_f32 v101, v101, v104
    v_mul_f32 v102, v102, v104
    v_mul_f32 v103, v103, v104
    v_cvt_pk_bf16_f32 v108, v96, v97
    v_cvt_pk_bf16_f32 v109, v98, v99
    v_cvt_pk_bf16_f32 v110, v100, v101
    v_cvt_pk_bf16_f32 v111, v102, v103
    buffer_store_dwordx4 v[108:111], v7, s[4:7], s40 offen sc1
    v_mov_b32 v12, 1
    s_mov_b64 exec, 1
    buffer_store_dword v12, off, s[4:7], s42 offset:0 sc1
    s_mov_b64 exec, -1
    v_cvt_pk_bf16_f32 v40, v188, v189
    v_cvt_pk_bf16_f32 v41, v190, v191
    v_cvt_pk_bf16_f32 v42, v192, v193
    v_cvt_pk_bf16_f32 v43, v194, v195
    v_cvt_pk_bf16_f32 v44, v196, v197
    v_cvt_pk_bf16_f32 v45, v198, v199
    v_cvt_pk_bf16_f32 v46, v200, v201
    v_cvt_pk_bf16_f32 v47, v202, v203
    v_and_b32 v40, v32, v40
    v_and_b32 v41, v33, v41
    v_and_b32 v42, v34, v42
    v_and_b32 v43, v35, v43
    v_and_b32 v44, v36, v44
    v_and_b32 v45, v37, v45
    v_and_b32 v46, v38, v46
    v_and_b32 v47, v39, v47
    v_mfma_f32_32x32x16_bf16 v[188:203], v[144:147], v[28:31], v[80:95]
    v_exp_f32 v172, v172
    v_exp_f32 v173, v173
    v_exp_f32 v174, v174
    v_exp_f32 v175, v175
    s_waitcnt lgkmcnt(4)
    v_mfma_f32_32x32x16_bf16 v[112:127], v[56:59], v[40:43], 0
    v_exp_f32 v176, v176
    v_exp_f32 v177, v177
    v_exp_f32 v178, v178
    v_exp_f32 v179, v179
    v_mfma_f32_32x32x16_bf16 v[112:127], v[60:63], v[44:47], v[112:127]
    ds_read_b64_tr_b16 v[56:57], v6 offset:4096
    ds_read_b64_tr_b16 v[58:59], v6 offset:4352
    ds_read_b64_tr_b16 v[60:61], v6 offset:4608
    ds_read_b64_tr_b16 v[62:63], v6 offset:4864
    s_waitcnt vmcnt(39)
    v_mfma_f32_16x16x32_bf16 v[96:99], a[0:3], v[220:223], 0
    v_exp_f32 v180, v180
    v_exp_f32 v181, v181
    s_waitcnt vmcnt(38)
    v_mfma_f32_16x16x32_bf16 v[100:103], a[4:7], v[220:223], 0
    v_exp_f32 v182, v182
    v_exp_f32 v183, v183
    s_waitcnt vmcnt(37)
    v_mfma_f32_16x16x32_bf16 v[104:107], a[8:11], v[220:223], 0
    s_add_u32 s38, s35, 4096
    buffer_load_dwordx4 v[72:75], v4, s[4:7], s38 offen offset:0
    s_add_u32 s38, s35, 4096
    buffer_load_dwordx4 v[76:79], v4, s[4:7], s38 offen offset:1024
    v_exp_f32 v184, v184
    v_exp_f32 v185, v185
    s_waitcnt vmcnt(38)
    v_mfma_f32_16x16x32_bf16 v[108:111], a[12:15], v[220:223], 0
    v_exp_f32 v186, v186
    v_exp_f32 v187, v187
    s_waitcnt vmcnt(37)
    v_mfma_f32_16x16x32_bf16 v[96:99], a[16:19], v[220:223], v[96:99]
    v_cvt_pk_bf16_f32 v40, v172, v173
    v_cvt_pk_bf16_f32 v41, v174, v175
    v_cvt_pk_bf16_f32 v42, v176, v177
    v_cvt_pk_bf16_f32 v43, v178, v179
    v_cvt_pk_bf16_f32 v44, v180, v181
    v_cvt_pk_bf16_f32 v45, v182, v183
    v_cvt_pk_bf16_f32 v46, v184, v185
    v_cvt_pk_bf16_f32 v47, v186, v187
    v_mfma_f32_32x32x16_bf16 v[172:187], v[148:151], v[28:31], v[80:95]
    v_exp_f32 v188, v188
    v_exp_f32 v189, v189
    v_exp_f32 v190, v190
    v_exp_f32 v191, v191
    s_waitcnt lgkmcnt(4)
    v_mfma_f32_32x32x16_bf16 v[112:127], v[48:51], v[40:43], v[112:127]
    v_exp_f32 v192, v192
    v_exp_f32 v193, v193
    v_exp_f32 v194, v194
    v_exp_f32 v195, v195
    v_mfma_f32_32x32x16_bf16 v[112:127], v[52:55], v[44:47], v[112:127]
    ds_read_b64_tr_b16 v[48:49], v6 offset:5120
    ds_read_b64_tr_b16 v[50:51], v6 offset:5376
    ds_read_b64_tr_b16 v[52:53], v6 offset:5632
    ds_read_b64_tr_b16 v[54:55], v6 offset:5888
    s_waitcnt vmcnt(36)
    v_mfma_f32_16x16x32_bf16 v[100:103], a[20:23], v[220:223], v[100:103]
    v_exp_f32 v196, v196
    v_exp_f32 v197, v197
    s_waitcnt vmcnt(35)
    v_mfma_f32_16x16x32_bf16 v[104:107], a[24:27], v[220:223], v[104:107]
    v_exp_f32 v198, v198
    v_exp_f32 v199, v199
    s_waitcnt vmcnt(34)
    v_mfma_f32_16x16x32_bf16 v[108:111], a[28:31], v[220:223], v[108:111]
    s_add_u32 s38, s35, 8192
    buffer_load_dwordx4 v[128:131], v3, s[4:7], s38 offen offset:0
    s_add_u32 s38, s35, 8192
    buffer_load_dwordx4 v[132:135], v3, s[4:7], s38 offen offset:1024
    v_exp_f32 v200, v200
    v_exp_f32 v201, v201
    s_waitcnt vmcnt(35)
    v_mfma_f32_16x16x32_bf16 v[96:99], a[32:35], v[220:223], v[96:99]
    v_exp_f32 v202, v202
    v_exp_f32 v203, v203
    s_waitcnt vmcnt(34)
    v_mfma_f32_16x16x32_bf16 v[100:103], a[36:39], v[220:223], v[100:103]
    v_cvt_pk_bf16_f32 v40, v188, v189
    v_cvt_pk_bf16_f32 v41, v190, v191
    v_cvt_pk_bf16_f32 v42, v192, v193
    v_cvt_pk_bf16_f32 v43, v194, v195
    v_cvt_pk_bf16_f32 v44, v196, v197
    v_cvt_pk_bf16_f32 v45, v198, v199
    v_cvt_pk_bf16_f32 v46, v200, v201
    v_cvt_pk_bf16_f32 v47, v202, v203
    v_mfma_f32_32x32x16_bf16 v[188:203], v[152:155], v[28:31], v[80:95]
    v_exp_f32 v172, v172
    v_exp_f32 v173, v173
    v_exp_f32 v174, v174
    v_exp_f32 v175, v175
    s_waitcnt lgkmcnt(4)
    v_mfma_f32_32x32x16_bf16 v[112:127], v[56:59], v[40:43], v[112:127]
    v_exp_f32 v176, v176
    v_exp_f32 v177, v177
    v_exp_f32 v178, v178
    v_exp_f32 v179, v179
    v_mfma_f32_32x32x16_bf16 v[112:127], v[60:63], v[44:47], v[112:127]
    ds_read_b64_tr_b16 v[56:57], v6 offset:6144
    ds_read_b64_tr_b16 v[58:59], v6 offset:6400
    ds_read_b64_tr_b16 v[60:61], v6 offset:6656
    ds_read_b64_tr_b16 v[62:63], v6 offset:6912
    s_waitcnt vmcnt(33)
    v_mfma_f32_16x16x32_bf16 v[104:107], a[40:43], v[220:223], v[104:107]
    v_exp_f32 v180, v180
    v_exp_f32 v181, v181
    s_waitcnt vmcnt(32)
    v_mfma_f32_16x16x32_bf16 v[108:111], a[44:47], v[220:223], v[108:111]
    v_exp_f32 v182, v182
    v_exp_f32 v183, v183
    s_waitcnt vmcnt(31)
    v_mfma_f32_16x16x32_bf16 v[96:99], a[48:51], v[220:223], v[96:99]
    s_add_u32 s38, s35, 8192
    buffer_load_dwordx4 v[136:139], v4, s[4:7], s38 offen offset:0
    s_add_u32 s38, s35, 8192
    buffer_load_dwordx4 v[140:143], v4, s[4:7], s38 offen offset:1024
    v_exp_f32 v184, v184
    v_exp_f32 v185, v185
    s_waitcnt vmcnt(32)
    v_mfma_f32_16x16x32_bf16 v[100:103], a[52:55], v[220:223], v[100:103]
    v_exp_f32 v186, v186
    v_exp_f32 v187, v187
    s_waitcnt vmcnt(31)
    v_mfma_f32_16x16x32_bf16 v[104:107], a[56:59], v[220:223], v[104:107]
    v_cvt_pk_bf16_f32 v40, v172, v173
    v_cvt_pk_bf16_f32 v41, v174, v175
    v_cvt_pk_bf16_f32 v42, v176, v177
    v_cvt_pk_bf16_f32 v43, v178, v179
    v_cvt_pk_bf16_f32 v44, v180, v181
    v_cvt_pk_bf16_f32 v45, v182, v183
    v_cvt_pk_bf16_f32 v46, v184, v185
    v_cvt_pk_bf16_f32 v47, v186, v187
    v_mfma_f32_32x32x16_bf16 v[172:187], v[156:159], v[28:31], v[80:95]
    v_exp_f32 v188, v188
    v_exp_f32 v189, v189
    v_exp_f32 v190, v190
    v_exp_f32 v191, v191
    s_waitcnt lgkmcnt(4)
    v_mfma_f32_32x32x16_bf16 v[112:127], v[48:51], v[40:43], v[112:127]
    v_exp_f32 v192, v192
    v_exp_f32 v193, v193
    v_exp_f32 v194, v194
    v_exp_f32 v195, v195
    v_mfma_f32_32x32x16_bf16 v[112:127], v[52:55], v[44:47], v[112:127]
    ds_read_b64_tr_b16 v[48:49], v6 offset:7168
    ds_read_b64_tr_b16 v[50:51], v6 offset:7424
    ds_read_b64_tr_b16 v[52:53], v6 offset:7680
    ds_read_b64_tr_b16 v[54:55], v6 offset:7936
    s_waitcnt vmcnt(30)
    v_mfma_f32_16x16x32_bf16 v[108:111], a[60:63], v[220:223], v[108:111]
    v_exp_f32 v196, v196
    v_exp_f32 v197, v197
    s_waitcnt vmcnt(29)
    v_mfma_f32_16x16x32_bf16 v[96:99], a[64:67], v[220:223], v[96:99]
    v_exp_f32 v198, v198
    v_exp_f32 v199, v199
    s_waitcnt vmcnt(28)
    v_mfma_f32_16x16x32_bf16 v[100:103], a[68:71], v[220:223], v[100:103]
    s_add_u32 s38, s35, 12288
    buffer_load_dwordx4 v[144:147], v3, s[4:7], s38 offen offset:0
    s_add_u32 s38, s35, 12288
    buffer_load_dwordx4 v[148:151], v3, s[4:7], s38 offen offset:1024
    buffer_load_dword v14, v5, s[4:7], s43 offen offset:0 sc1
    v_exp_f32 v200, v200
    v_exp_f32 v201, v201
    s_waitcnt vmcnt(30)
    v_mfma_f32_16x16x32_bf16 v[104:107], a[72:75], v[220:223], v[104:107]
    v_exp_f32 v202, v202
    v_exp_f32 v203, v203
    s_waitcnt vmcnt(29)
    v_mfma_f32_16x16x32_bf16 v[108:111], a[76:79], v[220:223], v[108:111]
    v_cvt_pk_bf16_f32 v40, v188, v189
    v_cvt_pk_bf16_f32 v41, v190, v191
    v_cvt_pk_bf16_f32 v42, v192, v193
    v_cvt_pk_bf16_f32 v43, v194, v195
    v_cvt_pk_bf16_f32 v44, v196, v197
    v_cvt_pk_bf16_f32 v45, v198, v199
    v_cvt_pk_bf16_f32 v46, v200, v201
    v_cvt_pk_bf16_f32 v47, v202, v203
    v_mfma_f32_32x32x16_bf16 v[188:203], v[160:163], v[28:31], v[80:95]
    v_exp_f32 v172, v172
    v_exp_f32 v173, v173
    v_exp_f32 v174, v174
    v_exp_f32 v175, v175
    s_waitcnt lgkmcnt(4)
    v_mfma_f32_32x32x16_bf16 v[112:127], v[56:59], v[40:43], v[112:127]
    v_exp_f32 v176, v176
    v_exp_f32 v177, v177
    v_exp_f32 v178, v178
    v_exp_f32 v179, v179
    v_mfma_f32_32x32x16_bf16 v[112:127], v[60:63], v[44:47], v[112:127]
    ds_read_b64_tr_b16 v[56:57], v6 offset:8192
    ds_read_b64_tr_b16 v[58:59], v6 offset:8448
    ds_read_b64_tr_b16 v[60:61], v6 offset:8704
    ds_read_b64_tr_b16 v[62:63], v6 offset:8960
    s_waitcnt vmcnt(28)
    v_mfma_f32_16x16x32_bf16 v[96:99], a[80:83], v[220:223], v[96:99]
    v_exp_f32 v180, v180
    v_exp_f32 v181, v181
    s_waitcnt vmcnt(27)
    v_mfma_f32_16x16x32_bf16 v[100:103], a[84:87], v[220:223], v[100:103]
    v_exp_f32 v182, v182
    v_exp_f32 v183, v183
    s_waitcnt vmcnt(26)
    v_mfma_f32_16x16x32_bf16 v[104:107], a[88:91], v[220:223], v[104:107]
    s_add_u32 s38, s35, 12288
    buffer_load_dwordx4 v[152:155], v4, s[4:7], s38 offen offset:0
    s_add_u32 s38, s35, 12288
    buffer_load_dwordx4 v[156:159], v4, s[4:7], s38 offen offset:1024
    v_exp_f32 v184, v184
    v_exp_f32 v185, v185
    s_waitcnt vmcnt(27)
    v_mfma_f32_16x16x32_bf16 v[108:111], a[92:95], v[220:223], v[108:111]
    v_exp_f32 v186, v186
    v_exp_f32 v187, v187
    s_waitcnt vmcnt(26)
    v_mfma_f32_16x16x32_bf16 v[96:99], a[96:99], v[220:223], v[96:99]
    v_cvt_pk_bf16_f32 v40, v172, v173
    v_cvt_pk_bf16_f32 v41, v174, v175
    v_cvt_pk_bf16_f32 v42, v176, v177
    v_cvt_pk_bf16_f32 v43, v178, v179
    v_cvt_pk_bf16_f32 v44, v180, v181
    v_cvt_pk_bf16_f32 v45, v182, v183
    v_cvt_pk_bf16_f32 v46, v184, v185
    v_cvt_pk_bf16_f32 v47, v186, v187
    v_mfma_f32_32x32x16_bf16 v[172:187], v[164:167], v[28:31], v[80:95]
    v_exp_f32 v188, v188
    v_exp_f32 v189, v189
    v_exp_f32 v190, v190
    v_exp_f32 v191, v191
    s_waitcnt lgkmcnt(4)
    v_mfma_f32_32x32x16_bf16 v[112:127], v[48:51], v[40:43], v[112:127]
    v_exp_f32 v192, v192
    v_exp_f32 v193, v193
    v_exp_f32 v194, v194
    v_exp_f32 v195, v195
    v_mfma_f32_32x32x16_bf16 v[112:127], v[52:55], v[44:47], v[112:127]
    ds_read_b64_tr_b16 v[48:49], v6 offset:9216
    ds_read_b64_tr_b16 v[50:51], v6 offset:9472
    ds_read_b64_tr_b16 v[52:53], v6 offset:9728
    ds_read_b64_tr_b16 v[54:55], v6 offset:9984
    s_waitcnt vmcnt(25)
    v_mfma_f32_16x16x32_bf16 v[100:103], a[100:103], v[220:223], v[100:103]
    v_exp_f32 v196, v196
    v_exp_f32 v197, v197
    s_waitcnt vmcnt(24)
    v_mfma_f32_16x16x32_bf16 v[104:107], a[104:107], v[220:223], v[104:107]
    v_exp_f32 v198, v198
    v_exp_f32 v199, v199
    s_waitcnt vmcnt(23)
    v_mfma_f32_16x16x32_bf16 v[108:111], a[108:111], v[220:223], v[108:111]
    v_exp_f32 v200, v200
    v_exp_f32 v201, v201
    s_waitcnt vmcnt(20)
    v_mfma_f32_16x16x32_bf16 v[96:99], a[112:115], v[220:223], v[96:99]
    v_exp_f32 v202, v202
    v_exp_f32 v203, v203
    s_waitcnt vmcnt(19)
    v_mfma_f32_16x16x32_bf16 v[100:103], a[116:119], v[220:223], v[100:103]
    v_cvt_pk_bf16_f32 v40, v188, v189
    v_cvt_pk_bf16_f32 v41, v190, v191
    v_cvt_pk_bf16_f32 v42, v192, v193
    v_cvt_pk_bf16_f32 v43, v194, v195
    v_cvt_pk_bf16_f32 v44, v196, v197
    v_cvt_pk_bf16_f32 v45, v198, v199
    v_cvt_pk_bf16_f32 v46, v200, v201
    v_cvt_pk_bf16_f32 v47, v202, v203
    v_mfma_f32_32x32x16_bf16 v[188:203], v[168:171], v[28:31], v[80:95]
    v_exp_f32 v172, v172
    v_exp_f32 v173, v173
    v_exp_f32 v174, v174
    v_exp_f32 v175, v175
    s_waitcnt lgkmcnt(4)
    v_mfma_f32_32x32x16_bf16 v[112:127], v[56:59], v[40:43], v[112:127]
    v_exp_f32 v176, v176
    v_exp_f32 v177, v177
    v_exp_f32 v178, v178
    v_exp_f32 v179, v179
    v_mfma_f32_32x32x16_bf16 v[112:127], v[60:63], v[44:47], v[112:127]
    ds_read_b64_tr_b16 v[56:57], v6 offset:10240
    ds_read_b64_tr_b16 v[58:59], v6 offset:10496
    ds_read_b64_tr_b16 v[60:61], v6 offset:10752
    ds_read_b64_tr_b16 v[62:63], v6 offset:11008
    s_waitcnt vmcnt(18)
    v_mfma_f32_16x16x32_bf16 v[104:107], a[120:123], v[220:223], v[104:107]
    v_exp_f32 v180, v180
    v_exp_f32 v181, v181
    s_waitcnt vmcnt(15)
    v_mfma_f32_16x16x32_bf16 v[108:111], a[124:127], v[220:223], v[108:111]
    v_exp_f32 v182, v182
    v_exp_f32 v183, v183
    s_waitcnt vmcnt(2)
    v_cmp_gt_u32 vcc, 1, v14
    s_cmp_eq_u64 vcc, 0
    s_cselect_b64 s[70:71], -1, 0
    s_mov_b64 exec, s[70:71]
    buffer_load_dwordx4 v[240:243], v2, s[4:7], s45 offen offset:0
    buffer_load_dwordx4 v[244:247], v2, s[4:7], s45 offen offset:1024
    buffer_load_dwordx4 v[248:251], v2, s[4:7], s45 offen offset:2048
    buffer_load_dwordx4 v[252:255], v2, s[4:7], s45 offen offset:3072
    buffer_load_dwordx4 v[224:227], v2, s[4:7], s44 offen offset:0
    buffer_load_dwordx4 v[228:231], v2, s[4:7], s44 offen offset:1024
    buffer_load_dwordx4 v[232:235], v2, s[4:7], s44 offen offset:2048
    buffer_load_dwordx4 v[236:239], v2, s[4:7], s44 offen offset:3072
    s_mov_b64 exec, -1
    v_exp_f32 v184, v184
    v_exp_f32 v185, v185
    v_exp_f32 v186, v186
    v_exp_f32 v187, v187
    v_cvt_pk_bf16_f32 v40, v172, v173
    v_cvt_pk_bf16_f32 v41, v174, v175
    v_cvt_pk_bf16_f32 v42, v176, v177
    v_cvt_pk_bf16_f32 v43, v178, v179
    v_cvt_pk_bf16_f32 v44, v180, v181
    v_cvt_pk_bf16_f32 v45, v182, v183
    v_cvt_pk_bf16_f32 v46, v184, v185
    v_cvt_pk_bf16_f32 v47, v186, v187
    v_exp_f32 v188, v188
    v_exp_f32 v189, v189
    v_exp_f32 v190, v190
    v_exp_f32 v191, v191
    s_waitcnt lgkmcnt(4)
    v_mfma_f32_32x32x16_bf16 v[112:127], v[48:51], v[40:43], v[112:127]
    v_exp_f32 v192, v192
    v_exp_f32 v193, v193
    v_exp_f32 v194, v194
    v_exp_f32 v195, v195
    v_mfma_f32_32x32x16_bf16 v[112:127], v[52:55], v[44:47], v[112:127]
    v_exp_f32 v196, v196
    v_exp_f32 v197, v197
    v_exp_f32 v198, v198
    v_exp_f32 v199, v199
    v_exp_f32 v200, v200
    v_exp_f32 v201, v201
    v_exp_f32 v202, v202
    v_exp_f32 v203, v203
    v_cvt_pk_bf16_f32 v40, v188, v189
    v_cvt_pk_bf16_f32 v41, v190, v191
    v_cvt_pk_bf16_f32 v42, v192, v193
    v_cvt_pk_bf16_f32 v43, v194, v195
    v_cvt_pk_bf16_f32 v44, v196, v197
    v_cvt_pk_bf16_f32 v45, v198, v199
    v_cvt_pk_bf16_f32 v46, v200, v201
    v_cvt_pk_bf16_f32 v47, v202, v203
    v_bfi_b32 v40, v32, 0, v40
    v_bfi_b32 v41, v33, 0, v41
    v_bfi_b32 v42, v34, 0, v42
    v_bfi_b32 v43, v35, 0, v43
    v_bfi_b32 v44, v36, 0, v44
    v_bfi_b32 v45, v37, 0, v45
    v_bfi_b32 v46, v38, 0, v46
    v_bfi_b32 v47, v39, 0, v47
    s_waitcnt lgkmcnt(0)
    v_mfma_f32_32x32x16_bf16 v[112:127], v[56:59], v[40:43], v[112:127]
    v_mfma_f32_32x32x16_bf16 v[112:127], v[60:63], v[44:47], v[112:127]
    s_nop 11
    v_subrev_u32 v12, 0x21800000, v120
    v_cmp_gt_u32 vcc, 0x3c000000, v12
    s_cmp_eq_u64 vcc, -1
    s_nop 3
    s_cbranch_scc0 L_fbs_11
L_fbc_12:
    v_rcp_f32 v120, v120
    s_nop 0
    v_pk_mul_f32 v[112:113], v[112:113], v[120:121] op_sel:[0,0] op_sel_hi:[1,0]
    v_pk_mul_f32 v[114:115], v[114:115], v[120:121] op_sel:[0,0] op_sel_hi:[1,0]
    v_pk_mul_f32 v[116:117], v[116:117], v[120:121] op_sel:[0,0] op_sel_hi:[1,0]
    v_pk_mul_f32 v[118:119], v[118:119], v[120:121] op_sel:[0,0] op_sel_hi:[1,0]
    v_cvt_pk_bf16_f32 v124, v112, v113
    v_cvt_pk_bf16_f32 v125, v114, v115
    v_cvt_pk_bf16_f32 v126, v116, v117
    v_cvt_pk_bf16_f32 v127, v118, v119
    buffer_store_dwordx4 v[124:127], v7, s[4:7], s41 offen sc1
    s_nop 1
    s_branch L_join_6
L_var_2:
    s_waitcnt vmcnt(12)
    s_waitcnt lgkmcnt(0)
    s_barrier
L_top_13:
    v_mfma_f32_32x32x16_bf16 v[172:187], v[160:163], v[24:27], v[64:79]
    ds_read_b64_tr_b16 v[48:49], v6 offset:8192
    ds_read_b64_tr_b16 v[50:51], v6 offset:8448
    ds_read_b64_tr_b16 v[52:53], v6 offset:8704
    ds_read_b64_tr_b16 v[54:55], v6 offset:8960
    v_mfma_f32_32x32x16_bf16 v[188:203], v[160:163], v[28:31], v[80:95]
    s_nop 6
    v_exp_f32 v172, v172
    v_exp_f32 v173, v173
    v_exp_f32 v174, v174
    v_exp_f32 v175, v175
    v_exp_f32 v176, v176
    v_exp_f32 v177, v177
    v_exp_f32 v178, v178
    v_exp_f32 v179, v179
    ds_read_b64_tr_b16 v[56:57], v6 offset:8192
    ds_read_b64_tr_b16 v[58:59], v6 offset:8448
    ds_read_b64_tr_b16 v[60:61], v6 offset:8704
    ds_read_b64_tr_b16 v[62:63], v6 offset:8960
    v_exp_f32 v180, v180
    v_exp_f32 v181, v181
    v_exp_f32 v182, v182
    v_exp_f32 v183, v183
    s_add_u32 s38, s23, 4096
    buffer_load_dwordx4 a[16:19], v2, s[4:7], s38 offen offset:0
    s_add_u32 s38, s23, 4096
    buffer_load_dwordx4 a[20:23], v2, s[4:7], s38 offen offset:1024
    s_add_u32 s38, s23, 4096
    buffer_load_dwordx4 a[24:27], v2, s[4:7], s38 offen offset:2048
    s_add_u32 s38, s35, 0
    buffer_load_dwordx4 v[204:207], v3, s[4:7], s38 offen offset:0
    s_add_u32 s38, s35, 0
    buffer_load_dwordx4 v[208:211], v3, s[4:7], s38 offen offset:1024
    s_add_u32 s38, s35, 0
    buffer_load_dwordx4 v[212:215], v4, s[4:7], s38 offen offset:0
    s_add_u32 s38, s35, 0
    buffer_load_dwordx4 v[216:219], v4, s[4:7], s38 offen offset:1024
    s_add_u32 s38, s35, 4096
    buffer_load_dwordx4 v[64:67], v3, s[4:7], s38 offen offset:0
    s_add_u32 s38, s35, 4096
    buffer_load_dwordx4 v[68:71], v3, s[4:7], s38 offen offset:1024
    s_add_u32 s38, s35, 4096
    buffer_load_dwordx4 v[72:75], v4, s[4:7], s38 offen offset:0
    s_add_u32 s38, s35, 4096
    buffer_load_dwordx4 v[76:79], v4, s[4:7], s38 offen offset:1024
    s_add_u32 s38, s35, 8192
    buffer_load_dwordx4 v[128:131], v3, s[4:7], s38 offen offset:0
    s_add_u32 s38, s35, 8192
    buffer_load_dwordx4 v[132:135], v3, s[4:7], s38 offen offset:1024
    s_add_u32 s38, s35, 8192
    buffer_load_dwordx4 v[136:139], v4, s[4:7], s38 offen offset:0
    s_add_u32 s38, s35, 8192
    buffer_load_dwordx4 v[140:143], v4, s[4:7], s38 offen offset:1024
    s_add_u32 s38, s35, 12288
    buffer_load_dwordx4 v[144:147], v3, s[4:7], s38 offen offset:0
    s_add_u32 s38, s35, 12288
    buffer_load_dwordx4 v[148:151], v3, s[4:7], s38 offen offset:1024
    s_add_u32 s38, s35, 12288
    buffer_load_dwordx4 v[152:155], v4, s[4:7], s38 offen offset:0
    s_add_u32 s38, s35, 12288
    buffer_load_dwordx4 v[156:159], v4, s[4:7], s38 offen offset:1024
    v_exp_f32 v184, v184
    v_exp_f32 v185, v185
    v_exp_f32 v186, v186
    v_exp_f32 v187, v187
    v_cvt_pk_bf16_f32 v40, v172, v173
    v_cvt_pk_bf16_f32 v41, v174, v175
    v_cvt_pk_bf16_f32 v42, v176, v177
    v_cvt_pk_bf16_f32 v43, v178, v179
    v_cvt_pk_bf16_f32 v44, v180, v181
    v_cvt_pk_bf16_f32 v45, v182, v183
    v_cvt_pk_bf16_f32 v46, v184, v185
    v_cvt_pk_bf16_f32 v47, v186, v187
    v_bfi_b32 v40, v32, 0, v40
    v_bfi_b32 v41, v33, 0, v41
    v_bfi_b32 v42, v34, 0, v42
    v_bfi_b32 v43, v35, 0, v43
    v_bfi_b32 v44, v36, 0, v44
    v_bfi_b32 v45, v37, 0, v45
    v_bfi_b32 v46, v38, 0, v46
    v_bfi_b32 v47, v39, 0, v47
    v_mfma_f32_32x32x16_bf16 v[172:187], v[164:167], v[28:31], v[80:95]
    v_exp_f32 v188, v188
    v_exp_f32 v189, v189
    v_exp_f32 v190, v190
    v_exp_f32 v191, v191
    s_waitcnt lgkmcnt(4)
    v_mfma_f32_32x32x16_bf16 v[96:111], v[48:51], v[40:43], 0
    v_exp_f32 v192, v192
    v_exp_f32 v193, v193
    v_exp_f32 v194, v194
    v_exp_f32 v195, v195
    v_mfma_f32_32x32x16_bf16 v[96:111], v[52:55], v[44:47], v[96:111]
    ds_read_b64_tr_b16 v[48:49], v6 offset:9216
    ds_read_b64_tr_b16 v[50:51], v6 offset:9472
    ds_read_b64_tr_b16 v[52:53], v6 offset:9728
    ds_read_b64_tr_b16 v[54:55], v6 offset:9984
    v_exp_f32 v196, v196
    v_exp_f32 v197, v197
    v_exp_f32 v198, v198
    v_exp_f32 v199, v199
    s_add_u32 s38, s23, 4096
    buffer_load_dwordx4 a[28:31], v2, s[4:7], s38 offen offset:3072
    s_add_u32 s38, s23, 8192
    buffer_load_dwordx4 a[32:35], v2, s[4:7], s38 offen offset:0
    s_add_u32 s38, s23, 8192
    buffer_load_dwordx4 a[36:39], v2, s[4:7], s38 offen offset:1024
    v_exp_f32 v200, v200
    v_exp_f32 v201, v201
    v_exp_f32 v202, v202
    v_exp_f32 v203, v203
    v_subrev_u32 v12, 0x21800000, v104
    v_cmp_gt_u32 vcc, 0x3c000000, v12
    s_cmp_eq_u64 vcc, -1
    s_nop 3
    s_cbranch_scc0 L_fbs_15
L_fbc_16:
    s_waitcnt vmcnt(26)
    v_rcp_f32 v104, v104
    s_nop 0
    v_mul_f32 v96, v96, v104
    v_mul_f32 v97, v97, v104
    v_mul_f32 v98, v98, v104
    v_mul_f32 v99, v99, v104
    v_mul_f32 v100, v100, v104
    v_mul_f32 v101, v101, v104
    v_mul_f32 v102, v102, v104
    v_mul_f32 v103, v103, v104
    v_cvt_pk_bf16_f32 v108, v96, v97
    v_cvt_pk_bf16_f32 v109, v98, v99
    v_cvt_pk_bf16_f32 v110, v100, v101
    v_cvt_pk_bf16_f32 v111, v102, v103
    buffer_store_dwordx4 v[108:111], v7, s[4:7], s40 offen sc1
    v_mov_b32 v12, 1
    s_mov_b64 exec, 1
    buffer_store_dword v12, off, s[4:7], s42 offset:0 sc1
    s_mov_b64 exec, -1
    v_cvt_pk_bf16_f32 v40, v188, v189
    v_cvt_pk_bf16_f32 v41, v190, v191
    v_cvt_pk_bf16_f32 v42, v192, v193
    v_cvt_pk_bf16_f32 v43, v194, v195
    v_cvt_pk_bf16_f32 v44, v196, v197
    v_cvt_pk_bf16_f32 v45, v198, v199
    v_cvt_pk_bf16_f32 v46, v200, v201
    v_cvt_pk_bf16_f32 v47, v202, v203
    v_mfma_f32_32x32x16_bf16 v[188:203], v[168:171], v[28:31], v[80:95]
    v_exp_f32 v172, v172
    v_exp_f32 v173, v173
    v_exp_f32 v174, v174
    v_exp_f32 v175, v175
    s_waitcnt lgkmcnt(4)
    v_mfma_f32_32x32x16_bf16 v[112:127], v[56:59], v[40:43], 0
    v_exp_f32 v176, v176
    v_exp_f32 v177, v177
    v_exp_f32 v178, v178
    v_exp_f32 v179, v179
    v_mfma_f32_32x32x16_bf16 v[112:127], v[60:63], v[44:47], v[112:127]
    ds_read_b64_tr_b16 v[56:57], v6 offset:10240
    ds_read_b64_tr_b16 v[58:59], v6 offset:10496
    ds_read_b64_tr_b16 v[60:61], v6 offset:10752
    ds_read_b64_tr_b16 v[62:63], v6 offset:11008
    s_waitcnt vmcnt(27)
    v_mfma_f32_16x16x32_bf16 v[96:99], a[0:3], v[220:223], 0
    v_exp_f32 v180, v180
    v_exp_f32 v181, v181
    s_waitcnt vmcnt(26)
    v_mfma_f32_16x16x32_bf16 v[100:103], a[4:7], v[220:223], 0
    v_exp_f32 v182, v182
    v_exp_f32 v183, v183
    s_waitcnt vmcnt(25)
    v_mfma_f32_16x16x32_bf16 v[104:107], a[8:11], v[220:223], 0
    s_add_u32 s38, s23, 8192
    buffer_load_dwordx4 a[40:43], v2, s[4:7], s38 offen offset:2048
    s_add_u32 s38, s23, 8192
    buffer_load_dwordx4 a[44:47], v2, s[4:7], s38 offen offset:3072
    s_add_u32 s38, s23, 12288
    buffer_load_dwordx4 a[48:51], v2, s[4:7], s38 offen offset:0
    v_exp_f32 v184, v184
    v_exp_f32 v185, v185
    s_waitcnt vmcnt(27)
    v_mfma_f32_16x16x32_bf16 v[108:111], a[12:15], v[220:223], 0
    v_exp_f32 v186, v186
    v_exp_f32 v187, v187
    s_waitcnt vmcnt(26)
    v_mfma_f32_16x16x32_bf16 v[96:99], a[16:19], v[220:223], v[96:99]
    v_cvt_pk_bf16_f32 v40, v172, v173
    v_cvt_pk_bf16_f32 v41, v174, v175
    v_cvt_pk_bf16_f32 v42, v176, v177
    v_cvt_pk_bf16_f32 v43, v178, v179
    v_cvt_pk_bf16_f32 v44, v180, v181
    v_cvt_pk_bf16_f32 v45, v182, v183
    v_cvt_pk_bf16_f32 v46, v184, v185
    v_cvt_pk_bf16_f32 v47, v186, v187
    v_exp_f32 v188, v188
    v_exp_f32 v189, v189
    v_exp_f32 v190, v190
    v_exp_f32 v191, v191
    s_waitcnt lgkmcnt(4)
    v_mfma_f32_32x32x16_bf16 v[112:127], v[48:51], v[40:43], v[112:127]
    v_exp_f32 v192, v192
    v_exp_f32 v193, v193
    v_exp_f32 v194, v194
    v_exp_f32 v195, v195
    v_mfma_f32_32x32x16_bf16 v[112:127], v[52:55], v[44:47], v[112:127]
    s_waitcnt vmcnt(25)
    v_mfma_f32_16x16x32_bf16 v[100:103], a[20:23], v[220:223], v[100:103]
    v_exp_f32 v196, v196
    v_exp_f32 v197, v197
    s_waitcnt vmcnt(24)
    v_mfma_f32_16x16x32_bf16 v[104:107], a[24:27], v[220:223], v[104:107]
    v_exp_f32 v198, v198
    v_exp_f32 v199, v199
    s_add_u32 s38, s23, 12288
    buffer_load_dwordx4 a[52:55], v2, s[4:7], s38 offen offset:1024
    s_add_u32 s38, s23, 12288
    buffer_load_dwordx4 a[56:59], v2, s[4:7], s38 offen offset:2048
    s_add_u32 s38, s23, 12288
    buffer_load_dwordx4 a[60:63], v2, s[4:7], s38 offen offset:3072
    v_exp_f32 v200, v200
    v_exp_f32 v201, v201
    s_waitcnt vmcnt(10)
    v_mfma_f32_16x16x32_bf16 v[108:111], a[28:31], v[220:223], v[108:111]
    v_exp_f32 v202, v202
    v_exp_f32 v203, v203
    s_waitcnt vmcnt(9)
    v_mfma_f32_16x16x32_bf16 v[96:99], a[32:35], v[220:223], v[96:99]
    v_cvt_pk_bf16_f32 v40, v188, v189
    v_cvt_pk_bf16_f32 v41, v190, v191
    v_cvt_pk_bf16_f32 v42, v192, v193
    v_cvt_pk_bf16_f32 v43, v194, v195
    v_cvt_pk_bf16_f32 v44, v196, v197
    v_cvt_pk_bf16_f32 v45, v198, v199
    v_cvt_pk_bf16_f32 v46, v200, v201
    v_cvt_pk_bf16_f32 v47, v202, v203
    v_bfi_b32 v40, v32, 0, v40
    v_bfi_b32 v41, v33, 0, v41
    v_bfi_b32 v42, v34, 0, v42
    v_bfi_b32 v43, v35, 0, v43
    v_bfi_b32 v44, v36, 0, v44
    v_bfi_b32 v45, v37, 0, v45
    v_bfi_b32 v46, v38, 0, v46
    v_bfi_b32 v47, v39, 0, v47
    s_waitcnt lgkmcnt(0)
    v_mfma_f32_32x32x16_bf16 v[112:127], v[56:59], v[40:43], v[112:127]
    v_mfma_f32_32x32x16_bf16 v[112:127], v[60:63], v[44:47], v[112:127]
    s_waitcnt vmcnt(8)
    v_mfma_f32_16x16x32_bf16 v[100:103], a[36:39], v[220:223], v[100:103]
    s_add_u32 s38, s23, 16384
    buffer_load_dwordx4 a[64:67], v2, s[4:7], s38 offen offset:0
    s_add_u32 s38, s23, 16384
    buffer_load_dwordx4 a[68:71], v2, s[4:7], s38 offen offset:1024
    s_add_u32 s38, s23, 16384
    buffer_load_dwordx4 a[72:75], v2, s[4:7], s38 offen offset:2048
    s_waitcnt vmcnt(8)
    v_mfma_f32_16x16x32_bf16 v[104:107], a[40:43], v[220:223], v[104:107]
    s_nop 1
    v_subrev_u32 v12, 0x21800000, v120
    v_cmp_gt_u32 vcc, 0x3c000000, v12
    s_cmp_eq_u64 vcc, -1
    s_nop 3
    s_cbranch_scc0 L_fbs_17
L_fbc_18:
    v_rcp_f32 v120, v120
    s_nop 0
    v_pk_mul_f32 v[112:113], v[112:113], v[120:121] op_sel:[0,0] op_sel_hi:[1,0]
    v_pk_mul_f32 v[114:115], v[114:115], v[120:121] op_sel:[0,0] op_sel_hi:[1,0]
    v_pk_mul_f32 v[116:117], v[116:117], v[120:121] op_sel:[0,0] op_sel_hi:[1,0]
    v_pk_mul_f32 v[118:119], v[118:119], v[120:121] op_sel:[0,0] op_sel_hi:[1,0]
    v_cvt_pk_bf16_f32 v124, v112, v113
    v_cvt_pk_bf16_f32 v125, v114, v115
    v_cvt_pk_bf16_f32 v126, v116, v117
    v_cvt_pk_bf16_f32 v127, v118, v119
    buffer_store_dwordx4 v[124:127], v7, s[4:7], s41 offen sc1
    s_add_u32 s38, s23, 16384
    buffer_load_dwordx4 a[76:79], v2, s[4:7], s38 offen offset:3072
    s_add_u32 s38, s23, 20480
    buffer_load_dwordx4 a[80:83], v2, s[4:7], s38 offen offset:0
    s_add_u32 s38, s23, 20480
    buffer_load_dwordx4 a[84:87], v2, s[4:7], s38 offen offset:1024
    buffer_load_dword v14, v5, s[4:7], s43 offen offset:0 sc1
    s_add_u32 s38, s23, 20480
    buffer_load_dwordx4 a[88:91], v2, s[4:7], s38 offen offset:2048
    s_add_u32 s38, s23, 20480
    buffer_load_dwordx4 a[92:95], v2, s[4:7], s38 offen offset:3072
    s_add_u32 s38, s23, 24576
    buffer_load_dwordx4 a[96:99], v2, s[4:7], s38 offen offset:0
    s_add_u32 s38, s23, 24576
    buffer_load_dwordx4 a[100:103], v2, s[4:7], s38 offen offset:1024
    s_add_u32 s38, s23, 24576
    buffer_load_dwordx4 a[104:107], v2, s[4:7], s38 offen offset:2048
    s_waitcnt vmcnt(17)
    v_mfma_f32_16x16x32_bf16 v[108:111], a[44:47], v[220:223], v[108:111]
    s_waitcnt vmcnt(16)
    v_mfma_f32_16x16x32_bf16 v[96:99], a[48:51], v[220:223], v[96:99]
    s_waitcnt vmcnt(15)
    v_mfma_f32_16x16x32_bf16 v[100:103], a[52:55], v[220:223], v[100:103]
    s_waitcnt vmcnt(14)
    v_mfma_f32_16x16x32_bf16 v[104:107], a[56:59], v[220:223], v[104:107]
    s_waitcnt vmcnt(13)
    v_mfma_f32_16x16x32_bf16 v[108:111], a[60:63], v[220:223], v[108:111]
    s_waitcnt vmcnt(12)
    v_mfma_f32_16x16x32_bf16 v[96:99], a[64:67], v[220:223], v[96:99]
    s_waitcnt vmcnt(11)
    v_mfma_f32_16x16x32_bf16 v[100:103], a[68:71], v[220:223], v[100:103]
    s_waitcnt vmcnt(10)
    v_mfma_f32_16x16x32_bf16 v[104:107], a[72:75], v[220:223], v[104:107]
    s_waitcnt vmcnt(8)
    v_mfma_f32_16x16x32_bf16 v[108:111], a[76:79], v[220:223], v[108:111]
    s_waitcnt vmcnt(5)
    v_cmp_gt_u32 vcc, 1, v14
    s_cmp_eq_u64 vcc, 0
    s_cselect_b64 s[70:71], -1, 0
    s_mov_b64 exec, s[70:71]
    buffer_load_dwordx4 v[240:243], v2, s[4:7], s45 offen offset:0
    buffer_load_dwordx4 v[244:247], v2, s[4:7], s45 offen offset:1024
    buffer_load_dwordx4 v[248:251], v2, s[4:7], s45 offen offset:2048
    buffer_load_dwordx4 v[252:255], v2, s[4:7], s45 offen offset:3072
    buffer_load_dwordx4 v[224:227], v2, s[4:7], s44 offen offset:0
    buffer_load_dwordx4 v[228:231], v2, s[4:7], s44 offen offset:1024
    buffer_load_dwordx4 v[232:235], v2, s[4:7], s44 offen offset:2048
    buffer_load_dwordx4 v[236:239], v2, s[4:7], s44 offen offset:3072
    s_mov_b64 exec, -1
    s_add_u32 s38, s23, 24576
    buffer_load_dwordx4 a[108:111], v2, s[4:7], s38 offen offset:3072
    s_add_u32 s38, s23, 28672
    buffer_load_dwordx4 a[112:115], v2, s[4:7], s38 offen offset:0
    s_add_u32 s38, s23, 28672
    buffer_load_dwordx4 a[116:119], v2, s[4:7], s38 offen offset:1024
    s_add_u32 s38, s23, 28672
    buffer_load_dwordx4 a[120:123], v2, s[4:7], s38 offen offset:2048
    s_add_u32 s38, s23, 28672
    buffer_load_dwordx4 a[124:127], v2, s[4:7], s38 offen offset:3072
    s_waitcnt vmcnt(0)
    v_mfma_f32_16x16x32_bf16 v[96:99], a[80:83], v[220:223], v[96:99]
    v_mfma_f32_16x16x32_bf16 v[100:103], a[84:87], v[220:223], v[100:103]
    v_mfma_f32_16x16x32_bf16 v[104:107], a[88:91], v[220:223], v[104:107]
    v_mfma_f32_16x16x32_bf16 v[108:111], a[92:95], v[220:223], v[108:111]
    v_mfma_f32_16x16x32_bf16 v[96:99], a[96:99], v[220:223], v[96:99]
    v_mfma_f32_16x16x32_bf16 v[100:103], a[100:103], v[220:223], v[100:103]
    v_mfma_f32_16x16x32_bf16 v[104:107], a[104:107], v[220:223], v[104:107]
    v_mfma_f32_16x16x32_bf16 v[108:111], a[108:111], v[220:223], v[108:111]
    v_mfma_f32_16x16x32_bf16 v[96:99], a[112:115], v[220:223], v[96:99]
    v_mfma_f32_16x16x32_bf16 v[100:103], a[116:119], v[220:223], v[100:103]
    v_mfma_f32_16x16x32_bf16 v[104:107], a[120:123], v[220:223], v[104:107]
    v_mfma_f32_16x16x32_bf16 v[108:111], a[124:127], v[220:223], v[108:111]
    s_nop 7
    s_branch L_join_6
L_var_3:
    s_waitcnt vmcnt(12)
    s_waitcnt lgkmcnt(0)
    s_barrier
L_top_19:
    v_mfma_f32_32x32x16_bf16 v[172:187], v[156:159], v[24:27], v[64:79]
    ds_read_b64_tr_b16 v[48:49], v6 offset:7168
    ds_read_b64_tr_b16 v[50:51], v6 offset:7424
    ds_read_b64_tr_b16 v[52:53], v6 offset:7680
    ds_read_b64_tr_b16 v[54:55], v6 offset:7936
    v_mfma_f32_32x32x16_bf16 v[188:203], v[160:163], v[24:27], v[64:79]
    s_nop 6
    v_exp_f32 v172, v172
    v_exp_f32 v173, v173
    v_exp_f32 v174, v174
    v_exp_f32 v175, v175
    v_exp_f32 v176, v176
    v_exp_f32 v177, v177
    v_exp_f32 v178, v178
    v_exp_f32 v179, v179
    ds_read_b64_tr_b16 v[56:57], v6 offset:8192
    ds_read_b64_tr_b16 v[58:59], v6 offset:8448
    ds_read_b64_tr_b16 v[60:61], v6 offset:8704
    ds_read_b64_tr_b16 v[62:63], v6 offset:8960
    v_exp_f32 v180, v180
    v_exp_f32 v181, v181
    v_exp_f32 v182, v182
    v_exp_f32 v183, v183
    s_add_u32 s38, s23, 4096
    buffer_load_dwordx4 a[16:19], v2, s[4:7], s38 offen offset:0
    s_add_u32 s38, s23, 4096
    buffer_load_dwordx4 a[20:23], v2, s[4:7], s38 offen offset:1024
    s_add_u32 s38, s23, 4096
    buffer_load_dwordx4 a[24:27], v2, s[4:7], s38 offen offset:2048
    s_add_u32 s38, s35, 0
    buffer_load_dwordx4 v[204:207], v3, s[4:7], s38 offen offset:0
    s_add_u32 s38, s35, 0
    buffer_load_dwordx4 v[208:211], v3, s[4:7], s38 offen offset:1024
    s_add_u32 s38, s35, 0
    buffer_load_dwordx4 v[212:215], v4, s[4:7], s38 offen offset:0
    s_add_u32 s38, s35, 0
    buffer_load_dwordx4 v[216:219], v4, s[4:7], s38 offen offset:1024
    s_add_u32 s38, s35, 8192
    buffer_load_dwordx4 v[128:131], v3, s[4:7], s38 offen offset:0
    s_add_u32 s38, s35, 8192
    buffer_load_dwordx4 v[132:135], v3, s[4:7], s38 offen offset:1024
    s_add_u32 s38, s35, 8192
    buffer_load_dwordx4 v[136:139], v4, s[4:7], s38 offen offset:0
    s_add_u32 s38, s35, 8192
    buffer_load_dwordx4 v[140:143], v4, s[4:7], s38 offen offset:1024
    v_exp_f32 v184, v184
    v_exp_f32 v185, v185
    v_exp_f32 v186, v186
    v_exp_f32 v187, v187
    v_cvt_pk_bf16_f32 v40, v172, v173
    v_cvt_pk_bf16_f32 v41, v174, v175
    v_cvt_pk_bf16_f32 v42, v176, v177
    v_cvt_pk_bf16_f32 v43, v178, v179
    v_cvt_pk_bf16_f32 v44, v180, v181
    v_cvt_pk_bf16_f32 v45, v182, v183
    v_cvt_pk_bf16_f32 v46, v184, v185
    v_cvt_pk_bf16_f32 v47, v186, v187
    v_mfma_f32_32x32x16_bf16 v[172:187], v[156:159], v[28:31], v[80:95]
    v_exp_f32 v188, v188
    v_exp_f32 v189, v189
    v_exp_f32 v190, v190
    v_exp_f32 v191, v191
    s_waitcnt lgkmcnt(4)
    v_mfma_f32_32x32x16_bf16 v[96:111], v[48:51], v[40:43], 0
    v_exp_f32 v192, v192
    v_exp_f32 v193, v193
    v_exp_f32 v194, v194
    v_exp_f32 v195, v195
    v_mfma_f32_32x32x16_bf16 v[96:111], v[52:55], v[44:47], v[96:111]
    ds_read_b64_tr_b16 v[48:49], v6 offset:7168
    ds_read_b64_tr_b16 v[50:51], v6 offset:7424
    ds_read_b64_tr_b16 v[52:53], v6 offset:7680
    ds_read_b64_tr_b16 v[54:55], v6 offset:7936
    v_exp_f32 v196, v196
    v_exp_f32 v197, v197
    v_exp_f32 v198, v198
    v_exp_f32 v199, v199
    s_add_u32 s38, s23, 4096
    buffer_load_dwordx4 a[28:31], v2, s[4:7], s38 offen offset:3072
    s_add_u32 s38, s23, 8192
    buffer_load_dwordx4 a[32:35], v2, s[4:7], s38 offen offset:0
    s_add_u32 s38, s23, 8192
    buffer_load_dwordx4 a[36:39], v2, s[4:7], s38 offen offset:1024
    s_add_u32 s38, s35, 4096
    buffer_load_dwordx4 v[64:67], v3, s[4:7], s38 offen offset:0
    s_add_u32 s38, s35, 4096
    buffer_load_dwordx4 v[68:71], v3, s[4:7], s38 offen offset:1024
    s_add_u32 s38, s35, 4096
    buffer_load_dwordx4 v[72:75], v4, s[4:7], s38 offen offset:0
    s_add_u32 s38, s35, 4096
    buffer_load_dwordx4 v[76:79], v4, s[4:7], s38 offen offset:1024
    s_add_u32 s38, s35, 12288
    buffer_load_dwordx4 v[144:147], v3, s[4:7], s38 offen offset:0
    s_add_u32 s38, s35, 12288
    buffer_load_dwordx4 v[148:151], v3, s[4:7], s38 offen offset:1024
    v_exp_f32 v200, v200
    v_exp_f32 v201, v201
    v_exp_f32 v202, v202
    v_exp_f32 v203, v203
    v_cvt_pk_bf16_f32 v40, v188, v189
    v_cvt_pk_bf16_f32 v41, v190, v191
    v_cvt_pk_bf16_f32 v42, v192, v193
    v_cvt_pk_bf16_f32 v43, v194, v195
    v_cvt_pk_bf16_f32 v44, v196, v197
    v_cvt_pk_bf16_f32 v45, v198, v199
    v_cvt_pk_bf16_f32 v46, v200, v201
    v_cvt_pk_bf16_f32 v47, v202, v203
    v_bfi_b32 v40, v32, 0, v40
    v_bfi_b32 v41, v33, 0, v41
    v_bfi_b32 v42, v34, 0, v42
    v_bfi_b32 v43, v35, 0, v43
    v_bfi_b32 v44, v36, 0, v44
    v_bfi_b32 v45, v37, 0, v45
    v_bfi_b32 v46, v38, 0, v46
    v_bfi_b32 v47, v39, 0, v47
    v_mfma_f32_32x32x16_bf16 v[188:203], v[160:163], v[28:31], v[80:95]
    v_exp_f32 v172, v172
    v_exp_f32 v173, v173
    v_exp_f32 v174, v174
    v_exp_f32 v175, v175
    s_waitcnt lgkmcnt(4)
    v_mfma_f32_32x32x16_bf16 v[96:111], v[56:59], v[40:43], v[96:111]
    v_exp_f32 v176, v176
    v_exp_f32 v177, v177
    v_exp_f32 v178, v178
    v_exp_f32 v179, v179
    v_mfma_f32_32x32x16_bf16 v[96:111], v[60:63], v[44:47], v[96:111]
    ds_read_b64_tr_b16 v[56:57], v6 offset:8192
    ds_read_b64_tr_b16 v[58:59], v6 offset:8448
    ds_read_b64_tr_b16 v[60:61], v6 offset:8704
    ds_read_b64_tr_b16 v[62:63], v6 offset:8960
    v_exp_f32 v180, v180
    v_exp_f32 v181, v181
    v_exp_f32 v182, v182
    v_exp_f32 v183, v183
    s_add_u32 s38, s23, 8192
    buffer_load_dwordx4 a[40:43], v2, s[4:7], s38 offen offset:2048
    s_add_u32 s38, s23, 8192
    buffer_load_dwordx4 a[44:47], v2, s[4:7], s38 offen offset:3072
    s_add_u32 s38, s23, 12288
    buffer_load_dwordx4 a[48:51], v2, s[4:7], s38 offen offset:0
    s_add_u32 s38, s35, 12288
    buffer_load_dwordx4 v[152:155], v4, s[4:7], s38 offen offset:0
    s_add_u32 s38, s35, 12288
    buffer_load_dwordx4 v[156:159], v4, s[4:7], s38 offen offset:1024
    v_exp_f32 v184, v184
    v_exp_f32 v185, v185
    v_exp_f32 v186, v186
    v_exp_f32 v187, v187
    v_subrev_u32 v12, 0x21800000, v104
    v_cmp_gt_u32 vcc, 0x3c000000, v12
    s_cmp_eq_u64 vcc, -1
    s_nop 3
    s_cbranch_scc0 L_fbs_21
L_fbc_22:
    s_waitcnt vmcnt(29)
    v_rcp_f32 v104, v104
    s_nop 0
    v_mul_f32 v96, v96, v104
    v_mul_f32 v97, v97, v104
    v_mul_f32 v98, v98, v104
    v_mul_f32 v99, v99, v104
    v_mul_f32 v100, v100, v104
    v_mul_f32 v101, v101, v104
    v_mul_f32 v102, v102, v104
    v_mul_f32 v103, v103, v104
    v_cvt_pk_bf16_f32 v108, v96, v97
    v_cvt_pk_bf16_f32 v109, v98, v99
    v_cvt_pk_bf16_f32 v110, v100, v101
    v_cvt_pk_bf16_f32 v111, v102, v103
    buffer_store_dwordx4 v[108:111], v7, s[4:7], s40 offen sc1
    v_mov_b32 v12, 1
    s_mov_b64 exec, 1
    buffer_store_dword v12, off, s[4:7], s42 offset:0 sc1
    s_mov_b64 exec, -1
    v_cvt_pk_bf16_f32 v40, v172, v173
    v_cvt_pk_bf16_f32 v41, v174, v175
    v_cvt_pk_bf16_f32 v42, v176, v177
    v_cvt_pk_bf16_f32 v43, v178, v179
    v_cvt_pk_bf16_f32 v44, v180, v181
    v_cvt_pk_bf16_f32 v45, v182, v183
    v_cvt_pk_bf16_f32 v46, v184, v185
    v_cvt_pk_bf16_f32 v47, v186, v187
    v_mfma_f32_32x32x16_bf16 v[172:187], v[164:167], v[28:31], v[80:95]
    v_exp_f32 v188, v188
    v_exp_f32 v189, v189
    v_exp_f32 v190, v190
    v_exp_f32 v191, v191
    s_waitcnt lgkmcnt(4)
    v_mfma_f32_32x32x16_bf16 v[112:127], v[48:51], v[40:43], 0
    v_exp_f32 v192, v192
    v_exp_f32 v193, v193
    v_exp_f32 v194, v194
    v_exp_f32 v195, v195
    v_mfma_f32_32x32x16_bf16 v[112:127], v[52:55], v[44:47], v[112:127]
    ds_read_b64_tr_b16 v[48:49], v6 offset:9216
    ds_read_b64_tr_b16 v[50:51], v6 offset:9472
    ds_read_b64_tr_b16 v[52:53], v6 offset:9728
    ds_read_b64_tr_b16 v[54:55], v6 offset:9984
    s_waitcnt vmcnt(30)
    v_mfma_f32_16x16x32_bf16 v[96:99], a[0:3], v[220:223], 0
    v_exp_f32 v196, v196
    v_exp_f32 v197, v197
    s_waitcnt vmcnt(29)
    v_mfma_f32_16x16x32_bf16 v[100:103], a[4:7], v[220:223], 0
    v_exp_f32 v198, v198
    v_exp_f32 v199, v199
    s_waitcnt vmcnt(28)
    v_mfma_f32_16x16x32_bf16 v[104:107], a[8:11], v[220:223], 0
    s_add_u32 s38, s23, 12288
    buffer_load_dwordx4 a[52:55], v2, s[4:7], s38 offen offset:1024
    s_add_u32 s38, s23, 12288
    buffer_load_dwordx4 a[56:59], v2, s[4:7], s38 offen offset:2048
    s_add_u32 s38, s23, 12288
    buffer_load_dwordx4 a[60:63], v2, s[4:7], s38 offen offset:3072
    v_exp_f32 v200, v200
    v_exp_f32 v201, v201
    s_waitcnt vmcnt(30)
    v_mfma_f32_16x16x32_bf16 v[108:111], a[12:15], v[220:223], 0
    v_exp_f32 v202, v202
    v_exp_f32 v203, v203
    s_waitcnt vmcnt(29)
    v_mfma_f32_16x16x32_bf16 v[96:99], a[16:19], v[220:223], v[96:99]
    v_cvt_pk_bf16_f32 v40, v188, v189
    v_cvt_pk_bf16_f32 v41, v190, v191
    v_cvt_pk_bf16_f32 v42, v192, v193
    v_cvt_pk_bf16_f32 v43, v194, v195
    v_cvt_pk_bf16_f32 v44, v196, v197
    v_cvt_pk_bf16_f32 v45, v198, v199
    v_cvt_pk_bf16_f32 v46, v200, v201
    v_cvt_pk_bf16_f32 v47, v202, v203
    v_mfma_f32_32x32x16_bf16 v[188:203], v[168:171], v[28:31], v[80:95]
    v_exp_f32 v172, v172
    v_exp_f32 v173, v173
    v_exp_f32 v174, v174
    v_exp_f32 v175, v175
    s_waitcnt lgkmcnt(4)
    v_mfma_f32_32x32x16_bf16 v[112:127], v[56:59], v[40:43], v[112:127]
    v_exp_f32 v176, v176
    v_exp_f32 v177, v177
    v_exp_f32 v178, v178
    v_exp_f32 v179, v179
    v_mfma_f32_32x32x16_bf16 v[112:127], v[60:63], v[44:47], v[112:127]
    ds_read_b64_tr_b16 v[56:57], v6 offset:10240
    ds_read_b64_tr_b16 v[58:59], v6 offset:10496
    ds_read_b64_tr_b16 v[60:61], v6 offset:10752
    ds_read_b64_tr_b16 v[62:63], v6 offset:11008
    s_waitcnt vmcnt(28)
    v_mfma_f32_16x16x32_bf16 v[100:103], a[20:23], v[220:223], v[100:103]
    v_exp_f32 v180, v180
    v_exp_f32 v181, v181
    s_waitcnt vmcnt(27)
    v_mfma_f32_16x16x32_bf16 v[104:107], a[24:27], v[220:223], v[104:107]
    v_exp_f32 v182, v182
    v_exp_f32 v183, v183
    s_waitcnt vmcnt(18)
    v_mfma_f32_16x16x32_bf16 v[108:111], a[28:31], v[220:223], v[108:111]
    s_add_u32 s38, s23, 16384
    buffer_load_dwordx4 a[64:67], v2, s[4:7], s38 offen offset:0
    s_add_u32 s38, s23, 16384
    buffer_load_dwordx4 a[68:71], v2, s[4:7], s38 offen offset:1024
    s_add_u32 s38, s23, 16384
    buffer_load_dwordx4 a[72:75], v2, s[4:7], s38 offen offset:2048
    v_exp_f32 v184, v184
    v_exp_f32 v185, v185
    s_waitcnt vmcnt(20)
    v_mfma_f32_16x16x32_bf16 v[96:99], a[32:35], v[220:223], v[96:99]
    v_exp_f32 v186, v186
    v_exp_f32 v187, v187
    s_waitcnt vmcnt(19)
    v_mfma_f32_16x16x32_bf16 v[100:103], a[36:39], v[220:223], v[100:103]
    v_cvt_pk_bf16_f32 v40, v172, v173
    v_cvt_pk_bf16_f32 v41, v174, v175
    v_cvt_pk_bf16_f32 v42, v176, v177
    v_cvt_pk_bf16_f32 v43, v178, v179
    v_cvt_pk_bf16_f32 v44, v180, v181
    v_cvt_pk_bf16_f32 v45, v182, v183
    v_cvt_pk_bf16_f32 v46, v184, v185
    v_cvt_pk_bf16_f32 v47, v186, v187
    v_exp_f32 v188, v188
    v_exp_f32 v189, v189
    v_exp_f32 v190, v190
    v_exp_f32 v191, v191
    s_waitcnt lgkmcnt(4)
    v_mfma_f32_32x32x16_bf16 v[112:127], v[48:51], v[40:43], v[112:127]
    v_exp_f32 v192, v192
    v_exp_f32 v193, v193
    v_exp_f32 v194, v194
    v_exp_f32 v195, v195
    v_mfma_f32_32x32x16_bf16 v[112:127], v[52:55], v[44:47], v[112:127]
    s_waitcnt vmcnt(12)
    v_mfma_f32_16x16x32_bf16 v[104:107], a[40:43], v[220:223], v[104:107]
    v_exp_f32 v196, v196
    v_exp_f32 v197, v197
    s_waitcnt vmcnt(11)
    v_mfma_f32_16x16x32_bf16 v[108:111], a[44:47], v[220:223], v[108:111]
    v_exp_f32 v198, v198
    v_exp_f32 v199, v199
    s_waitcnt vmcnt(10)
    v_mfma_f32_16x16x32_bf16 v[96:99], a[48:51], v[220:223], v[96:99]
    s_add_u32 s38, s23, 16384
    buffer_load_dwordx4 a[76:79], v2, s[4:7], s38 offen offset:3072
    s_add_u32 s38, s23, 20480
    buffer_load_dwordx4 a[80:83], v2, s[4:7], s38 offen offset:0
    s_add_u32 s38, s23, 20480
    buffer_load_dwordx4 a[84:87], v2, s[4:7], s38 offen offset:1024
    v_exp_f32 v200, v200
    v_exp_f32 v201, v201
    s_waitcnt vmcnt(8)
    v_mfma_f32_16x16x32_bf16 v[100:103], a[52:55], v[220:223], v[100:103]
    v_exp_f32 v202, v202
    v_exp_f32 v203, v203
    v_cvt_pk_bf16_f32 v40, v188, v189
    v_cvt_pk_bf16_f32 v41, v190, v191
    v_cvt_pk_bf16_f32 v42, v192, v193
    v_cvt_pk_bf16_f32 v43, v194, v195
    v_cvt_pk_bf16_f32 v44, v196, v197
    v_cvt_pk_bf16_f32 v45, v198, v199
    v_cvt_pk_bf16_f32 v46, v200, v201
    v_cvt_pk_bf16_f32 v47, v202, v203
    v_bfi_b32 v40, v32, 0, v40
    v_bfi_b32 v41, v33, 0, v41
    v_bfi_b32 v42, v34, 0, v42
    v_bfi_b32 v43, v35, 0, v43
    v_bfi_b32 v44, v36, 0, v44
    v_bfi_b32 v45, v37, 0, v45
    v_bfi_b32 v46, v38, 0, v46
    v_bfi_b32 v47, v39, 0, v47
    s_waitcnt lgkmcnt(0)
    v_mfma_f32_32x32x16_bf16 v[112:127], v[56:59], v[40:43], v[112:127]
    v_mfma_f32_32x32x16_bf16 v[112:127], v[60:63], v[44:47], v[112:127]
    s_nop 11
    v_subrev_u32 v12, 0x21800000, v120
    v_cmp_gt_u32 vcc, 0x3c000000, v12
    s_cmp_eq_u64 vcc, -1
    s_nop 3
    s_cbranch_scc0 L_fbs_23
L_fbc_24:
    v_rcp_f32 v120, v120
    s_nop 0
    v_pk_mul_f32 v[112:113], v[112:113], v[120:121] op_sel:[0,0] op_sel_hi:[1,0]
    v_pk_mul_f32 v[114:115], v[114:115], v[120:121] op_sel:[0,0] op_sel_hi:[1,0]
    v_pk_mul_f32 v[116:117], v[116:117], v[120:121] op_sel:[0,0] op_sel_hi:[1,0]
    v_pk_mul_f32 v[118:119], v[118:119], v[120:121] op_sel:[0,0] op_sel_hi:[1,0]
    v_cvt_pk_bf16_f32 v124, v112, v113
    v_cvt_pk_bf16_f32 v125, v114, v115
    v_cvt_pk_bf16_f32 v126, v116, v117
    v_cvt_pk_bf16_f32 v127, v118, v119
    buffer_store_dwordx4 v[124:127], v7, s[4:7], s41 offen sc1
    buffer_load_dword v14, v5, s[4:7], s43 offen offset:0 sc1
    s_add_u32 s38, s23, 20480
    buffer_load_dwordx4 a[88:91], v2, s[4:7], s38 offen offset:2048
    s_add_u32 s38, s23, 20480
    buffer_load_dwordx4 a[92:95], v2, s[4:7], s38 offen offset:3072
    s_add_u32 s38, s23, 24576
    buffer_load_dwordx4 a[96:99], v2, s[4:7], s38 offen offset:0
    s_add_u32 s38, s23, 24576
    buffer_load_dwordx4 a[100:103], v2, s[4:7], s38 offen offset:1024
    s_add_u32 s38, s23, 24576
    buffer_load_dwordx4 a[104:107], v2, s[4:7], s38 offen offset:2048
    s_waitcnt vmcnt(14)
    v_mfma_f32_16x16x32_bf16 v[104:107], a[56:59], v[220:223], v[104:107]
    s_waitcnt vmcnt(13)
    v_mfma_f32_16x16x32_bf16 v[108:111], a[60:63], v[220:223], v[108:111]
    s_waitcnt vmcnt(12)
    v_mfma_f32_16x16x32_bf16 v[96:99], a[64:67], v[220:223], v[96:99]
    s_waitcnt vmcnt(11)
    v_mfma_f32_16x16x32_bf16 v[100:103], a[68:71], v[220:223], v[100:103]
    s_waitcnt vmcnt(10)
    v_mfma_f32_16x16x32_bf16 v[104:107], a[72:75], v[220:223], v[104:107]
    s_waitcnt vmcnt(9)
    v_mfma_f32_16x16x32_bf16 v[108:111], a[76:79], v[220:223], v[108:111]
    s_waitcnt vmcnt(8)
    v_mfma_f32_16x16x32_bf16 v[96:99], a[80:83], v[220:223], v[96:99]
    s_waitcnt vmcnt(5)
    v_cmp_gt_u32 vcc, 1, v14
    s_cmp_eq_u64 vcc, 0
    s_cselect_b64 s[70:71], -1, 0
    s_mov_b64 exec, s[70:71]
    buffer_load_dwordx4 v[240:243], v2, s[4:7], s45 offen offset:0
    buffer_load_dwordx4 v[244:247], v2, s[4:7], s45 offen offset:1024
    buffer_load_dwordx4 v[248:251], v2, s[4:7], s45 offen offset:2048
    buffer_load_dwordx4 v[252:255], v2, s[4:7], s45 offen offset:3072
    buffer_load_dwordx4 v[224:227], v2, s[4:7], s44 offen offset:0
    buffer_load_dwordx4 v[228:231], v2, s[4:7], s44 offen offset:1024
    buffer_load_dwordx4 v[232:235], v2, s[4:7], s44 offen offset:2048
    buffer_load_dwordx4 v[236:239], v2, s[4:7], s44 offen offset:3072
    s_mov_b64 exec, -1
    s_add_u32 s38, s23, 24576
    buffer_load_dwordx4 a[108:111], v2, s[4:7], s38 offen offset:3072
    s_add_u32 s38, s23, 28672
    buffer_load_dwordx4 a[112:115], v2, s[4:7], s38 offen offset:0
    s_add_u32 s38, s23, 28672
    buffer_load_dwordx4 a[116:119], v2, s[4:7], s38 offen offset:1024
    s_add_u32 s38, s23, 28672
    buffer_load_dwordx4 a[120:123], v2, s[4:7], s38 offen offset:2048
    s_add_u32 s38, s23, 28672
    buffer_load_dwordx4 a[124:127], v2, s[4:7], s38 offen offset:3072
    s_waitcnt vmcnt(0)
    v_mfma_f32_16x16x32_bf16 v[100:103], a[84:87], v[220:223], v[100:103]
    v_mfma_f32_16x16x32_bf16 v[104:107], a[88:91], v[220:223], v[104:107]
    v_mfma_f32_16x16x32_bf16 v[108:111], a[92:95], v[220:223], v[108:111]
    v_mfma_f32_16x16x32_bf16 v[96:99], a[96:99], v[220:223], v[96:99]
    v_mfma_f32_16x16x32_bf16 v[100:103], a[100:103], v[220:223], v[100:103]
    v_mfma_f32_16x16x32_bf16 v[104:107], a[104:107], v[220:223], v[104:107]
    v_mfma_f32_16x16x32_bf16 v[108:111], a[108:111], v[220:223], v[108:111]
    v_mfma_f32_16x16x32_bf16 v[96:99], a[112:115], v[220:223], v[96:99]
    v_mfma_f32_16x16x32_bf16 v[100:103], a[116:119], v[220:223], v[100:103]
    v_mfma_f32_16x16x32_bf16 v[104:107], a[120:123], v[220:223], v[104:107]
    v_mfma_f32_16x16x32_bf16 v[108:111], a[124:127], v[220:223], v[108:111]
    s_nop 7
    s_branch L_join_6
L_var_4:
    s_waitcnt vmcnt(12)
    s_waitcnt lgkmcnt(0)
    s_barrier
L_top_25:
    v_mfma_f32_32x32x16_bf16 v[172:187], v[144:147], v[24:27], v[64:79]
    ds_read_b64_tr_b16 v[48:49], v6 offset:4096
    ds_read_b64_tr_b16 v[50:51], v6 offset:4352
    ds_read_b64_tr_b16 v[52:53], v6 offset:4608
    ds_read_b64_tr_b16 v[54:55], v6 offset:4864
    v_mfma_f32_32x32x16_bf16 v[188:203], v[148:151], v[24:27], v[64:79]
    s_nop 6
    v_exp_f32 v172, v172
    v_exp_f32 v173, v173
    v_exp_f32 v174, v174
    v_exp_f32 v175, v175
    v_exp_f32 v176, v176
    v_exp_f32 v177, v177
    v_exp_f32 v178, v178
    v_exp_f32 v179, v179
    ds_read_b64_tr_b16 v[56:57], v6 offset:5120
    ds_read_b64_tr_b16 v[58:59], v6 offset:5376
    ds_read_b64_tr_b16 v[60:61], v6 offset:5632
    ds_read_b64_tr_b16 v[62:63], v6 offset:5888
    v_exp_f32 v180, v180
    v_exp_f32 v181, v181
    v_exp_f32 v182, v182
    v_exp_f32 v183, v183
    s_add_u32 s38, s23, 4096
    buffer_load_dwordx4 a[16:19], v2, s[4:7], s38 offen offset:0
    s_add_u32 s38, s23, 4096
    buffer_load_dwordx4 a[20:23], v2, s[4:7], s38 offen offset:1024
    s_add_u32 s38, s23, 4096
    buffer_load_dwordx4 a[24:27], v2, s[4:7], s38 offen offset:2048
    v_exp_f32 v184, v184
    v_exp_f32 v185, v185
    v_exp_f32 v186, v186
    v_exp_f32 v187, v187
    v_cvt_pk_bf16_f32 v40, v172, v173
    v_cvt_pk_bf16_f32 v41, v174, v175
    v_cvt_pk_bf16_f32 v42, v176, v177
    v_cvt_pk_bf16_f32 v43, v178, v179
    v_cvt_pk_bf16_f32 v44, v180, v181
    v_cvt_pk_bf16_f32 v45, v182, v183
    v_cvt_pk_bf16_f32 v46, v184, v185
    v_cvt_pk_bf16_f32 v47, v186, v187
    v_mfma_f32_32x32x16_bf16 v[172:187], v[152:155], v[24:27], v[64:79]
    v_exp_f32 v188, v188
    v_exp_f32 v189, v189
    v_exp_f32 v190, v190
    v_exp_f32 v191, v191
    s_waitcnt lgkmcnt(4)
    v_mfma_f32_32x32x16_bf16 v[96:111], v[48:51], v[40:43], 0
    v_exp_f32 v192, v192
    v_exp_f32 v193, v193
    v_exp_f32 v194, v194
    v_exp_f32 v195, v195
    v_mfma_f32_32x32x16_bf16 v[96:111], v[52:55], v[44:47], v[96:111]
    ds_read_b64_tr_b16 v[48:49], v6 offset:6144
    ds_read_b64_tr_b16 v[50:51], v6 offset:6400
    ds_read_b64_tr_b16 v[52:53], v6 offset:6656
    ds_read_b64_tr_b16 v[54:55], v6 offset:6912
    v_exp_f32 v196, v196
    v_exp_f32 v197, v197
    v_exp_f32 v198, v198
    v_exp_f32 v199, v199
    s_add_u32 s38, s23, 4096
    buffer_load_dwordx4 a[28:31], v2, s[4:7], s38 offen offset:3072
    s_add_u32 s38, s23, 8192
    buffer_load_dwordx4 a[32:35], v2, s[4:7], s38 offen offset:0
    s_add_u32 s38, s23, 8192
    buffer_load_dwordx4 a[36:39], v2, s[4:7], s38 offen offset:1024
    s_add_u32 s38, s35, 0
    buffer_load_dwordx4 v[204:207], v3, s[4:7], s38 offen offset:0
    s_add_u32 s38, s35, 0
    buffer_load_dwordx4 v[208:211], v3, s[4:7], s38 offen offset:1024
    v_exp_f32 v200, v200
    v_exp_f32 v201, v201
    v_exp_f32 v202, v202
    v_exp_f32 v203, v203
    v_cvt_pk_bf16_f32 v40, v188, v189
    v_cvt_pk_bf16_f32 v41, v190, v191
    v_cvt_pk_bf16_f32 v42, v192, v193
    v_cvt_pk_bf16_f32 v43, v194, v195
    v_cvt_pk_bf16_f32 v44, v196, v197
    v_cvt_pk_bf16_f32 v45, v198, v199
    v_cvt_pk_bf16_f32 v46, v200, v201
    v_cvt_pk_bf16_f32 v47, v202, v203
    v_mfma_f32_32x32x16_bf16 v[188:203], v[156:159], v[24:27], v[64:79]
    v_exp_f32 v172, v172
    v_exp_f32 v173, v173
    v_exp_f32 v174, v174
    v_exp_f32 v175, v175
    s_waitcnt lgkmcnt(4)
    v_mfma_f32_32x32x16_bf16 v[96:111], v[56:59], v[40:43], v[96:111]
    v_exp_f32 v176, v176
    v_exp_f32 v177, v177
    v_exp_f32 v178, v178
    v_exp_f32 v179, v179
    v_mfma_f32_32x32x16_bf16 v[96:111], v[60:63], v[44:47], v[96:111]
    ds_read_b64_tr_b16 v[56:57], v6 offset:7168
    ds_read_b64_tr_b16 v[58:59], v6 offset:7424
    ds_read_b64_tr_b16 v[60:61], v6 offset:7680
    ds_read_b64_tr_b16 v[62:63], v6 offset:7936
    v_exp_f32 v180, v180
    v_exp_f32 v181, v181
    v_exp_f32 v182, v182
    v_exp_f32 v183, v183
    s_add_u32 s38, s23, 8192
    buffer_load_dwordx4 a[40:43], v2, s[4:7], s38 offen offset:2048
    s_add_u32 s38, s23, 8192
    buffer_load_dwordx4 a[44:47], v2, s[4:7], s38 offen offset:3072
    s_add_u32 s38, s23, 12288
    buffer_load_dwordx4 a[48:51], v2, s[4:7], s38 offen offset:0
    s_add_u32 s38, s35, 0
    buffer_load_dwordx4 v[212:215], v4, s[4:7], s38 offen offset:0
    s_add_u32 s38, s35, 0
    buffer_load_dwordx4 v[216:219], v4, s[4:7], s38 offen offset:1024
    v_exp_f32 v184, v184
    v_exp_f32 v185, v185
    v_exp_f32 v186, v186
    v_exp_f32 v187, v187
    v_cvt_pk_bf16_f32 v40, v172, v173
    v_cvt_pk_bf16_f32 v41, v174, v175
    v_cvt_pk_bf16_f32 v42, v176, v177
    v_cvt_pk_bf16_f32 v43, v178, v179
    v_cvt_pk_bf16_f32 v44, v180, v181
    v_cvt_pk_bf16_f32 v45, v182, v183
    v_cvt_pk_bf16_f32 v46, v184, v185
    v_cvt_pk_bf16_f32 v47, v186, v187
    v_mfma_f32_32x32x16_bf16 v[172:187], v[160:163], v[24:27], v[64:79]
    v_exp_f32 v188, v188
    v_exp_f32 v189, v189
    v_exp_f32 v190, v190
    v_exp_f32 v191, v191
    s_waitcnt lgkmcnt(4)
    v_mfma_f32_32x32x16_bf16 v[96:111], v[48:51], v[40:43], v[96:111]
    v_exp_f32 v192, v192
    v_exp_f32 v193, v193
    v_exp_f32 v194, v194
    v_exp_f32 v195, v195
    v_mfma_f32_32x32x16_bf16 v[96:111], v[52:55], v[44:47], v[96:111]
    ds_read_b64_tr_b16 v[48:49], v6 offset:8192
    ds_read_b64_tr_b16 v[50:51], v6 offset:8448
    ds_read_b64_tr_b16 v[52:53], v6 offset:8704
    ds_read_b64_tr_b16 v[54:55], v6 offset:8960
    v_exp_f32 v196, v196
    v_exp_f32 v197, v197
    v_exp_f32 v198, v198
    v_exp_f32 v199, v199
    s_add_u32 s38, s23, 12288
    buffer_load_dwordx4 a[52:55], v2, s[4:7], s38 offen offset:1024
    s_add_u32 s38, s23, 12288
    buffer_load_dwordx4 a[56:59], v2, s[4:7], s38 offen offset:2048
    s_add_u32 s38, s23, 12288
    buffer_load_dwordx4 a[60:63], v2, s[4:7], s38 offen offset:3072
    v_exp_f32 v200, v200
    v_exp_f32 v201, v201
    v_exp_f32 v202, v202
    v_exp_f32 v203, v203
    v_cvt_pk_bf16_f32 v40, v188, v189
    v_cvt_pk_bf16_f32 v41, v190, v191
    v_cvt_pk_bf16_f32 v42, v192, v193
    v_cvt_pk_bf16_f32 v43, v194, v195
    v_cvt_pk_bf16_f32 v44, v196, v197
    v_cvt_pk_bf16_f32 v45, v198, v199
    v_cvt_pk_bf16_f32 v46, v200, v201
    v_cvt_pk_bf16_f32 v47, v202, v203
    v_mfma_f32_32x32x16_bf16 v[188:203], v[144:147], v[28:31], v[80:95]
    v_exp_f32 v172, v172
    v_exp_f32 v173, v173
    v_exp_f32 v174, v174
    v_exp_f32 v175, v175
    s_waitcnt lgkmcnt(4)
    v_mfma_f32_32x32x16_bf16 v[96:111], v[56:59], v[40:43], v[96:111]
    v_exp_f32 v176, v176
    v_exp_f32 v177, v177
    v_exp_f32 v178, v178
    v_exp_f32 v179, v179
    v_mfma_f32_32x32x16_bf16 v[96:111], v[60:63], v[44:47], v[96:111]
    ds_read_b64_tr_b16 v[56:57], v6 offset:4096
    ds_read_b64_tr_b16 v[58:59], v6 offset:4352
    ds_read_b64_tr_b16 v[60:61], v6 offset:4608
    ds_read_b64_tr_b16 v[62:63], v6 offset:4864
    v_exp_f32 v180, v180
    v_exp_f32 v181, v181
    v_exp_f32 v182, v182
    v_exp_f32 v183, v183
    s_add_u32 s38, s23, 16384
    buffer_load_dwordx4 a[64:67], v2, s[4:7], s38 offen offset:0
    s_add_u32 s38, s23, 16384
    buffer_load_dwordx4 a[68:71], v2, s[4:7], s38 offen offset:1024
    s_add_u32 s38, s23, 16384
    buffer_load_dwordx4 a[72:75], v2, s[4:7], s38 offen offset:2048
    s_add_u32 s38, s35, 4096
    buffer_load_dwordx4 v[64:67], v3, s[4:7], s38 offen offset:0
    s_add_u32 s38, s35, 4096
    buffer_load_dwordx4 v[68:71], v3, s[4:7], s38 offen offset:1024
    s_add_u32 s38, s35, 4096
    buffer_load_dwordx4 v[72:75], v4, s[4:7], s38 offen offset:0
    s_add_u32 s38, s35, 4096
    buffer_load_dwordx4 v[76:79], v4, s[4:7], s38 offen offset:1024
    v_exp_f32 v184, v184
    v_exp_f32 v185, v185
    v_exp_f32 v186, v186
    v_exp_f32 v187, v187
    v_cvt_pk_bf16_f32 v40, v172, v173
    v_cvt_pk_bf16_f32 v41, v174, v175
    v_cvt_pk_bf16_f32 v42, v176, v177
    v_cvt_pk_bf16_f32 v43, v178, v179
    v_cvt_pk_bf16_f32 v44, v180, v181
    v_cvt_pk_bf16_f32 v45, v182, v183
    v_cvt_pk_bf16_f32 v46, v184, v185
    v_cvt_pk_bf16_f32 v47, v186, v187
    v_bfi_b32 v40, v32, 0, v40
    v_bfi_b32 v41, v33, 0, v41
    v_bfi_b32 v42, v34, 0, v42
    v_bfi_b32 v43, v35, 0, v43
    v_bfi_b32 v44, v36, 0, v44
    v_bfi_b32 v45, v37, 0, v45
    v_bfi_b32 v46, v38, 0, v46
    v_bfi_b32 v47, v39, 0, v47
    v_mfma_f32_32x32x16_bf16 v[172:187], v[148:151], v[28:31], v[80:95]
    v_exp_f32 v188, v188
    v_exp_f32 v189, v189
    v_exp_f32 v190, v190
    v_exp_f32 v191, v191
    s_waitcnt lgkmcnt(4)
    v_mfma_f32_32x32x16_bf16 v[96:111], v[48:51], v[40:43], v[96:111]
    v_exp_f32 v192, v192
    v_exp_f32 v193, v193
    v_exp_f32 v194, v194
    v_exp_f32 v195, v195
    v_mfma_f32_32x32x16_bf16 v[96:111], v[52:55], v[44:47], v[96:111]
    ds_read_b64_tr_b16 v[48:49], v6 offset:5120
    ds_read_b64_tr_b16 v[50:51], v6 offset:5376
    ds_read_b64_tr_b16 v[52:53], v6 offset:5632
    ds_read_b64_tr_b16 v[54:55], v6 offset:5888
    v_exp_f32 v196, v196
    v_exp_f32 v197, v197
    v_exp_f32 v198, v198
    v_exp_f32 v199, v199
    s_add_u32 s38, s23, 16384
    buffer_load_dwordx4 a[76:79], v2, s[4:7], s38 offen offset:3072
    s_add_u32 s38, s23, 20480
    buffer_load_dwordx4 a[80:83], v2, s[4:7], s38 offen offset:0
    s_add_u32 s38, s23, 20480
    buffer_load_dwordx4 a[84:87], v2, s[4:7], s38 offen offset:1024
    s_add_u32 s38, s35, 8192
    buffer_load_dwordx4 v[128:131], v3, s[4:7], s38 offen offset:0
    s_add_u32 s38, s35, 8192
    buffer_load_dwordx4 v[132:135], v3, s[4:7], s38 offen offset:1024
    v_exp_f32 v200, v200
    v_exp_f32 v201, v201
    v_exp_f32 v202, v202
    v_exp_f32 v203, v203
    v_subrev_u32 v12, 0x21800000, v104
    v_cmp_gt_u32 vcc, 0x3c000000, v12
    s_cmp_eq_u64 vcc, -1
    s_nop 3
    s_cbranch_scc0 L_fbs_27
L_fbc_28:
    s_waitcnt vmcnt(32)
    v_rcp_f32 v104, v104
    s_nop 0
    v_mul_f32 v96, v96, v104
    v_mul_f32 v97, v97, v104
    v_mul_f32 v98, v98, v104
    v_mul_f32 v99, v99, v104
    v_mul_f32 v100, v100, v104
    v_mul_f32 v101, v101, v104
    v_mul_f32 v102, v102, v104
    v_mul_f32 v103, v103, v104
    v_cvt_pk_bf16_f32 v108, v96, v97
    v_cvt_pk_bf16_f32 v109, v98, v99
    v_cvt_pk_bf16_f32 v110, v100, v101
    v_cvt_pk_bf16_f32 v111, v102, v103
    buffer_store_dwordx4 v[108:111], v7, s[4:7], s40 offen sc1
    v_mov_b32 v12, 1
    s_mov_b64 exec, 1
    buffer_store_dword v12, off, s[4:7], s42 offset:0 sc1
    s_mov_b64 exec, -1
    v_cvt_pk_bf16_f32 v40, v188, v189
    v_cvt_pk_bf16_f32 v41, v190, v191
    v_cvt_pk_bf16_f32 v42, v192, v193
    v_cvt_pk_bf16_f32 v43, v194, v195
    v_cvt_pk_bf16_f32 v44, v196, v197
    v_cvt_pk_bf16_f32 v45, v198, v199
    v_cvt_pk_bf16_f32 v46, v200, v201
    v_cvt_pk_bf16_f32 v47, v202, v203
    v_mfma_f32_32x32x16_bf16 v[188:203], v[152:155], v[28:31], v[80:95]
    v_exp_f32 v172, v172
    v_exp_f32 v173, v173
    v_exp_f32 v174, v174
    v_exp_f32 v175, v175
    s_waitcnt lgkmcnt(4)
    v_mfma_f32_32x32x16_bf16 v[112:127], v[56:59], v[40:43], 0
    v_exp_f32 v176, v176
    v_exp_f32 v177, v177
    v_exp_f32 v178, v178
    v_exp_f32 v179, v179
    v_mfma_f32_32x32x16_bf16 v[112:127], v[60:63], v[44:47], v[112:127]
    ds_read_b64_tr_b16 v[56:57], v6 offset:6144
    ds_read_b64_tr_b16 v[58:59], v6 offset:6400
    ds_read_b64_tr_b16 v[60:61], v6 offset:6656
    ds_read_b64_tr_b16 v[62:63], v6 offset:6912
    s_waitcnt vmcnt(33)
    v_mfma_f32_16x16x32_bf16 v[96:99], a[0:3], v[220:223], 0
    v_exp_f32 v180, v180
    v_exp_f32 v181, v181
    s_waitcnt vmcnt(32)
    v_mfma_f32_16x16x32_bf16 v[100:103], a[4:7], v[220:223], 0
    v_exp_f32 v182, v182
    v_exp_f32 v183, v183
    s_waitcnt vmcnt(31)
    v_mfma_f32_16x16x32_bf16 v[104:107], a[8:11], v[220:223], 0
    s_add_u32 s38, s35, 8192
    buffer_load_dwordx4 v[136:139], v4, s[4:7], s38 offen offset:0
    s_add_u32 s38, s35, 8192
    buffer_load_dwordx4 v[140:143], v4, s[4:7], s38 offen offset:1024
    v_exp_f32 v184, v184
    v_exp_f32 v185, v185
    s_waitcnt vmcnt(32)
    v_mfma_f32_16x16x32_bf16 v[108:111], a[12:15], v[220:223], 0
    v_exp_f32 v186, v186
    v_exp_f32 v187, v187
    s_waitcnt vmcnt(31)
    v_mfma_f32_16x16x32_bf16 v[96:99], a[16:19], v[220:223], v[96:99]
    v_cvt_pk_bf16_f32 v40, v172, v173
    v_cvt_pk_bf16_f32 v41, v174, v175
    v_cvt_pk_bf16_f32 v42, v176, v177
    v_cvt_pk_bf16_f32 v43, v178, v179
    v_cvt_pk_bf16_f32 v44, v180, v181
    v_cvt_pk_bf16_f32 v45, v182, v183
    v_cvt_pk_bf16_f32 v46, v184, v185
    v_cvt_pk_bf16_f32 v47, v186, v187
    v_mfma_f32_32x32x16_bf16 v[172:187], v[156:159], v[28:31], v[80:95]
    v_exp_f32 v188, v188
    v_exp_f32 v189, v189
    v_exp_f32 v190, v190
    v_exp_f32 v191, v191
    s_waitcnt lgkmcnt(4)
    v_mfma_f32_32x32x16_bf16 v[112:127], v[48:51], v[40:43], v[112:127]
    v_exp_f32 v192, v192
    v_exp_f32 v193, v193
    v_exp_f32 v194, v194
    v_exp_f32 v195, v195
    v_mfma_f32_32x32x16_bf16 v[112:127], v[52:55], v[44:47], v[112:127]
    ds_read_b64_tr_b16 v[48:49], v6 offset:7168
    ds_read_b64_tr_b16 v[50:51], v6 offset:7424
    ds_read_b64_tr_b16 v[52:53], v6 offset:7680
    ds_read_b64_tr_b16 v[54:55], v6 offset:7936
    s_waitcnt vmcnt(30)
    v_mfma_f32_16x16x32_bf16 v[100:103], a[20:23], v[220:223], v[100:103]
    v_exp_f32 v196, v196
    v_exp_f32 v197, v197
    s_waitcnt vmcnt(29)
    v_mfma_f32_16x16x32_bf16 v[104:107], a[24:27], v[220:223], v[104:107]
    v_exp_f32 v198, v198
    v_exp_f32 v199, v199
    s_waitcnt vmcnt(28)
    v_mfma_f32_16x16x32_bf16 v[108:111], a[28:31], v[220:223], v[108:111]
    s_add_u32 s38, s35, 12288
    buffer_load_dwordx4 v[144:147], v3, s[4:7], s38 offen offset:0
    s_add_u32 s38, s35, 12288
    buffer_load_dwordx4 v[148:151], v3, s[4:7], s38 offen offset:1024
    v_exp_f32 v200, v200
    v_exp_f32 v201, v201
    s_waitcnt vmcnt(29)
    v_mfma_f32_16x16x32_bf16 v[96:99], a[32:35], v[220:223], v[96:99]
    v_exp_f32 v202, v202
    v_exp_f32 v203, v203
    s_waitcnt vmcnt(28)
    v_mfma_f32_16x16x32_bf16 v[100:103], a[36:39], v[220:223], v[100:103]
    v_cvt_pk_bf16_f32 v40, v188, v189
    v_cvt_pk_bf16_f32 v41, v190, v191
    v_cvt_pk_bf16_f32 v42, v192, v193
    v_cvt_pk_bf16_f32 v43, v194, v195
    v_cvt_pk_bf16_f32 v44, v196, v197
    v_cvt_pk_bf16_f32 v45, v198, v199
    v_cvt_pk_bf16_f32 v46, v200, v201
    v_cvt_pk_bf16_f32 v47, v202, v203
    v_mfma_f32_32x32x16_bf16 v[188:203], v[160:163], v[28:31], v[80:95]
    v_exp_f32 v172, v172
    v_exp_f32 v173, v173
    v_exp_f32 v174, v174
    v_exp_f32 v175, v175
    s_waitcnt lgkmcnt(4)
    v_mfma_f32_32x32x16_bf16 v[112:127], v[56:59], v[40:43], v[112:127]
    v_exp_f32 v176, v176
    v_exp_f32 v177, v177
    v_exp_f32 v178, v178
    v_exp_f32 v179, v179
    v_mfma_f32_32x32x16_bf16 v[112:127], v[60:63], v[44:47], v[112:127]
    ds_read_b64_tr_b16 v[56:57], v6 offset:8192
    ds_read_b64_tr_b16 v[58:59], v6 offset:8448
    ds_read_b64_tr_b16 v[60:61], v6 offset:8704
    ds_read_b64_tr_b16 v[62:63], v6 offset:8960
    s_waitcnt vmcnt(25)
    v_mfma_f32_16x16x32_bf16 v[104:107], a[40:43], v[220:223], v[104:107]
    v_exp_f32 v180, v180
    v_exp_f32 v181, v181
    s_waitcnt vmcnt(24)
    v_mfma_f32_16x16x32_bf16 v[108:111], a[44:47], v[220:223], v[108:111]
    v_exp_f32 v182, v182
    v_exp_f32 v183, v183
    s_waitcnt vmcnt(23)
    v_mfma_f32_16x16x32_bf16 v[96:99], a[48:51], v[220:223], v[96:99]
    s_add_u32 s38, s35, 12288
    buffer_load_dwordx4 v[152:155], v4, s[4:7], s38 offen offset:0
    s_add_u32 s38, s35, 12288
    buffer_load_dwordx4 v[156:159], v4, s[4:7], s38 offen offset:1024
    v_exp_f32 v184, v184
    v_exp_f32 v185, v185
    s_waitcnt vmcnt(22)
    v_mfma_f32_16x16x32_bf16 v[100:103], a[52:55], v[220:223], v[100:103]
    v_exp_f32 v186, v186
    v_exp_f32 v187, v187
    s_waitcnt vmcnt(21)
    v_mfma_f32_16x16x32_bf16 v[104:107], a[56:59], v[220:223], v[104:107]
    v_cvt_pk_bf16_f32 v40, v172, v173
    v_cvt_pk_bf16_f32 v41, v174, v175
    v_cvt_pk_bf16_f32 v42, v176, v177
    v_cvt_pk_bf16_f32 v43, v178, v179
    v_cvt_pk_bf16_f32 v44, v180, v181
    v_cvt_pk_bf16_f32 v45, v182, v183
    v_cvt_pk_bf16_f32 v46, v184, v185
    v_cvt_pk_bf16_f32 v47, v186, v187
    v_mfma_f32_32x32x16_bf16 v[172:187], v[164:167], v[28:31], v[80:95]
    v_exp_f32 v188, v188
    v_exp_f32 v189, v189
    v_exp_f32 v190, v190
    v_exp_f32 v191, v191
    s_waitcnt lgkmcnt(4)
    v_mfma_f32_32x32x16_bf16 v[112:127], v[48:51], v[40:43], v[112:127]
    v_exp_f32 v192, v192
    v_exp_f32 v193, v193
    v_exp_f32 v194, v194
    v_exp_f32 v195, v195
    v_mfma_f32_32x32x16_bf16 v[112:127], v[52:55], v[44:47], v[112:127]
    ds_read_b64_tr_b16 v[48:49], v6 offset:9216
    ds_read_b64_tr_b16 v[50:51], v6 offset:9472
    ds_read_b64_tr_b16 v[52:53], v6 offset:9728
    ds_read_b64_tr_b16 v[54:55], v6 offset:9984
    s_waitcnt vmcnt(20)
    v_mfma_f32_16x16x32_bf16 v[108:111], a[60:63], v[220:223], v[108:111]
    v_exp_f32 v196, v196
    v_exp_f32 v197, v197
    s_waitcnt vmcnt(19)
    v_mfma_f32_16x16x32_bf16 v[96:99], a[64:67], v[220:223], v[96:99]
    v_exp_f32 v198, v198
    v_exp_f32 v199, v199
    s_waitcnt vmcnt(18)
    v_mfma_f32_16x16x32_bf16 v[100:103], a[68:71], v[220:223], v[100:103]
    v_exp_f32 v200, v200
    v_exp_f32 v201, v201
    s_waitcnt vmcnt(17)
    v_mfma_f32_16x16x32_bf16 v[104:107], a[72:75], v[220:223], v[104:107]
    v_exp_f32 v202, v202
    v_exp_f32 v203, v203
    s_waitcnt vmcnt(12)
    v_mfma_f32_16x16x32_bf16 v[108:111], a[76:79], v[220:223], v[108:111]
    v_cvt_pk_bf16_f32 v40, v188, v189
    v_cvt_pk_bf16_f32 v41, v190, v191
    v_cvt_pk_bf16_f32 v42, v192, v193
    v_cvt_pk_bf16_f32 v43, v194, v195
    v_cvt_pk_bf16_f32 v44, v196, v197
    v_cvt_pk_bf16_f32 v45, v198, v199
    v_cvt_pk_bf16_f32 v46, v200, v201
    v_cvt_pk_bf16_f32 v47, v202, v203
    v_mfma_f32_32x32x16_bf16 v[188:203], v[168:171], v[28:31], v[80:95]
    v_exp_f32 v172, v172
    v_exp_f32 v173, v173
    v_exp_f32 v174, v174
    v_exp_f32 v175, v175
    s_waitcnt lgkmcnt(4)
    v_mfma_f32_32x32x16_bf16 v[112:127], v[56:59], v[40:43], v[112:127]
    v_exp_f32 v176, v176
    v_exp_f32 v177, v177
    v_exp_f32 v178, v178
    v_exp_f32 v179, v179
    v_mfma_f32_32x32x16_bf16 v[112:127], v[60:63], v[44:47], v[112:127]
    ds_read_b64_tr_b16 v[56:57], v6 offset:10240
    ds_read_b64_tr_b16 v[58:59], v6 offset:10496
    ds_read_b64_tr_b16 v[60:61], v6 offset:10752
    ds_read_b64_tr_b16 v[62:63], v6 offset:11008
    s_waitcnt vmcnt(11)
    v_mfma_f32_16x16x32_bf16 v[96:99], a[80:83], v[220:223], v[96:99]
    v_exp_f32 v180, v180
    v_exp_f32 v181, v181
    s_waitcnt vmcnt(10)
    v_mfma_f32_16x16x32_bf16 v[100:103], a[84:87], v[220:223], v[100:103]
    v_exp_f32 v182, v182
    v_exp_f32 v183, v183
    v_exp_f32 v184, v184
    v_exp_f32 v185, v185
    v_exp_f32 v186, v186
    v_exp_f32 v187, v187
    v_cvt_pk_bf16_f32 v40, v172, v173
    v_cvt_pk_bf16_f32 v41, v174, v175
    v_cvt_pk_bf16_f32 v42, v176, v177
    v_cvt_pk_bf16_f32 v43, v178, v179
    v_cvt_pk_bf16_f32 v44, v180, v181
    v_cvt_pk_bf16_f32 v45, v182, v183
    v_cvt_pk_bf16_f32 v46, v184, v185
    v_cvt_pk_bf16_f32 v47, v186, v187
    v_exp_f32 v188, v188
    v_exp_f32 v189, v189
    v_exp_f32 v190, v190
    v_exp_f32 v191, v191
    s_waitcnt lgkmcnt(4)
    v_mfma_f32_32x32x16_bf16 v[112:127], v[48:51], v[40:43], v[112:127]
    v_exp_f32 v192, v192
    v_exp_f32 v193, v193
    v_exp_f32 v194, v194
    v_exp_f32 v195, v195
    v_mfma_f32_32x32x16_bf16 v[112:127], v[52:55], v[44:47], v[112:127]
    v_exp_f32 v196, v196
    v_exp_f32 v197, v197
    v_exp_f32 v198, v198
    v_exp_f32 v199, v199
    v_exp_f32 v200, v200
    v_exp_f32 v201, v201
    v_exp_f32 v202, v202
    v_exp_f32 v203, v203
    v_cvt_pk_bf16_f32 v40, v188, v189
    v_cvt_pk_bf16_f32 v41, v190, v191
    v_cvt_pk_bf16_f32 v42, v192, v193
    v_cvt_pk_bf16_f32 v43, v194, v195
    v_cvt_pk_bf16_f32 v44, v196, v197
    v_cvt_pk_bf16_f32 v45, v198, v199
    v_cvt_pk_bf16_f32 v46, v200, v201
    v_cvt_pk_bf16_f32 v47, v202, v203
    v_bfi_b32 v40, v32, 0, v40
    v_bfi_b32 v41, v33, 0, v41
    v_bfi_b32 v42, v34, 0, v42
    v_bfi_b32 v43, v35, 0, v43
    v_bfi_b32 v44, v36, 0, v44
    v_bfi_b32 v45, v37, 0, v45
    v_bfi_b32 v46, v38, 0, v46
    v_bfi_b32 v47, v39, 0, v47
    s_waitcnt lgkmcnt(0)
    v_mfma_f32_32x32x16_bf16 v[112:127], v[56:59], v[40:43], v[112:127]
    v_mfma_f32_32x32x16_bf16 v[112:127], v[60:63], v[44:47], v[112:127]
    s_nop 11
    v_subrev_u32 v12, 0x21800000, v120
    v_cmp_gt_u32 vcc, 0x3c000000, v12
    s_cmp_eq_u64 vcc, -1
    s_nop 3
    s_cbranch_scc0 L_fbs_29
L_fbc_30:
    v_rcp_f32 v120, v120
    s_nop 0
    v_pk_mul_f32 v[112:113], v[112:113], v[120:121] op_sel:[0,0] op_sel_hi:[1,0]
    v_pk_mul_f32 v[114:115], v[114:115], v[120:121] op_sel:[0,0] op_sel_hi:[1,0]
    v_pk_mul_f32 v[116:117], v[116:117], v[120:121] op_sel:[0,0] op_sel_hi:[1,0]
    v_pk_mul_f32 v[118:119], v[118:119], v[120:121] op_sel:[0,0] op_sel_hi:[1,0]
    v_cvt_pk_bf16_f32 v124, v112, v113
    v_cvt_pk_bf16_f32 v125, v114, v115
    v_cvt_pk_bf16_f32 v126, v116, v117
    v_cvt_pk_bf16_f32 v127, v118, v119
    buffer_store_dwordx4 v[124:127], v7, s[4:7], s41 offen sc1
    buffer_load_dword v14, v5, s[4:7], s43 offen offset:0 sc1
    s_add_u32 s38, s23, 20480
    buffer_load_dwordx4 a[88:91], v2, s[4:7], s38 offen offset:2048
    s_add_u32 s38, s23, 20480
    buffer_load_dwordx4 a[92:95], v2, s[4:7], s38 offen offset:3072
    s_add_u32 s38, s23, 24576
    buffer_load_dwordx4 a[96:99], v2, s[4:7], s38 offen offset:0
    s_add_u32 s38, s23, 24576
    buffer_load_dwordx4 a[100:103], v2, s[4:7], s38 offen offset:1024
    s_add_u32 s38, s23, 24576
    buffer_load_dwordx4 a[104:107], v2, s[4:7], s38 offen offset:2048
    s_waitcnt vmcnt(5)
    v_cmp_gt_u32 vcc, 1, v14
    s_cmp_eq_u64 vcc, 0
    s_cselect_b64 s[70:71], -1, 0
    s_mov_b64 exec, s[70:71]
    buffer_load_dwordx4 v[240:243], v2, s[4:7], s45 offen offset:0
    buffer_load_dwordx4 v[244:247], v2, s[4:7], s45 offen offset:1024
    buffer_load_dwordx4 v[248:251], v2, s[4:7], s45 offen offset:2048
    buffer_load_dwordx4 v[252:255], v2, s[4:7], s45 offen offset:3072
    buffer_load_dwordx4 v[224:227], v2, s[4:7], s44 offen offset:0
    buffer_load_dwordx4 v[228:231], v2, s[4:7], s44 offen offset:1024
    buffer_load_dwordx4 v[232:235], v2, s[4:7], s44 offen offset:2048
    buffer_load_dwordx4 v[236:239], v2, s[4:7], s44 offen offset:3072
    s_mov_b64 exec, -1
    s_add_u32 s38, s23, 24576
    buffer_load_dwordx4 a[108:111], v2, s[4:7], s38 offen offset:3072
    s_add_u32 s38, s23, 28672
    buffer_load_dwordx4 a[112:115], v2, s[4:7], s38 offen offset:0
    s_add_u32 s38, s23, 28672
    buffer_load_dwordx4 a[116:119], v2, s[4:7], s38 offen offset:1024
    s_add_u32 s38, s23, 28672
    buffer_load_dwordx4 a[120:123], v2, s[4:7], s38 offen offset:2048
    s_add_u32 s38, s23, 28672
    buffer_load_dwordx4 a[124:127], v2, s[4:7], s38 offen offset:3072
    s_waitcnt vmcnt(0)
    v_mfma_f32_16x16x32_bf16 v[104:107], a[88:91], v[220:223], v[104:107]
    v_mfma_f32_16x16x32_bf16 v[108:111], a[92:95], v[220:223], v[108:111]
    v_mfma_f32_16x16x32_bf16 v[96:99], a[96:99], v[220:223], v[96:99]
    v_mfma_f32_16x16x32_bf16 v[100:103], a[100:103], v[220:223], v[100:103]
    v_mfma_f32_16x16x32_bf16 v[104:107], a[104:107], v[220:223], v[104:107]
    v_mfma_f32_16x16x32_bf16 v[108:111], a[108:111], v[220:223], v[108:111]
    v_mfma_f32_16x16x32_bf16 v[96:99], a[112:115], v[220:223], v[96:99]
    v_mfma_f32_16x16x32_bf16 v[100:103], a[116:119], v[220:223], v[100:103]
    v_mfma_f32_16x16x32_bf16 v[104:107], a[120:123], v[220:223], v[104:107]
    v_mfma_f32_16x16x32_bf16 v[108:111], a[124:127], v[220:223], v[108:111]
    s_nop 7
    s_branch L_join_6
L_var_5:
    s_waitcnt vmcnt(12)
    s_waitcnt lgkmcnt(0)
    s_barrier
L_top_31:
    v_mfma_f32_32x32x16_bf16 v[172:187], v[140:143], v[24:27], v[64:79]
    ds_read_b64_tr_b16 v[48:49], v6 offset:3072
    ds_read_b64_tr_b16 v[50:51], v6 offset:3328
    ds_read_b64_tr_b16 v[52:53], v6 offset:3584
    ds_read_b64_tr_b16 v[54:55], v6 offset:3840
    v_mfma_f32_32x32x16_bf16 v[188:203], v[144:147], v[24:27], v[64:79]
    s_nop 6
    v_exp_f32 v172, v172
    v_exp_f32 v173, v173
    v_exp_f32 v174, v174
    v_exp_f32 v175, v175
    v_exp_f32 v176, v176
    v_exp_f32 v177, v177
    v_exp_f32 v178, v178
    v_exp_f32 v179, v179
    ds_read_b64_tr_b16 v[56:57], v6 offset:4096
    ds_read_b64_tr_b16 v[58:59], v6 offset:4352
    ds_read_b64_tr_b16 v[60:61], v6 offset:4608
    ds_read_b64_tr_b16 v[62:63], v6 offset:4864
    v_exp_f32 v180, v180
    v_exp_f32 v181, v181
    v_exp_f32 v182, v182
    v_exp_f32 v183, v183
    s_add_u32 s38, s23, 4096
    buffer_load_dwordx4 a[16:19], v2, s[4:7], s38 offen offset:0
    s_add_u32 s38, s23, 4096
    buffer_load_dwordx4 a[20:23], v2, s[4:7], s38 offen offset:1024
    s_add_u32 s38, s23, 4096
    buffer_load_dwordx4 a[24:27], v2, s[4:7], s38 offen offset:2048
    v_exp_f32 v184, v184
    v_exp_f32 v185, v185
    v_exp_f32 v186, v186
    v_exp_f32 v187, v187
    v_cvt_pk_bf16_f32 v40, v172, v173
    v_cvt_pk_bf16_f32 v41, v174, v175
    v_cvt_pk_bf16_f32 v42, v176, v177
    v_cvt_pk_bf16_f32 v43, v178, v179
    v_cvt_pk_bf16_f32 v44, v180, v181
    v_cvt_pk_bf16_f32 v45, v182, v183
    v_cvt_pk_bf16_f32 v46, v184, v185
    v_cvt_pk_bf16_f32 v47, v186, v187
    v_mfma_f32_32x32x16_bf16 v[172:187], v[148:151], v[24:27], v[64:79]
    v_exp_f32 v188, v188
    v_exp_f32 v189, v189
    v_exp_f32 v190, v190
    v_exp_f32 v191, v191
    s_waitcnt lgkmcnt(4)
    v_mfma_f32_32x32x16_bf16 v[96:111], v[48:51], v[40:43], 0
    v_exp_f32 v192, v192
    v_exp_f32 v193, v193
    v_exp_f32 v194, v194
    v_exp_f32 v195, v195
    v_mfma_f32_32x32x16_bf16 v[96:111], v[52:55], v[44:47], v[96:111]
    ds_read_b64_tr_b16 v[48:49], v6 offset:5120
    ds_read_b64_tr_b16 v[50:51], v6 offset:5376
    ds_read_b64_tr_b16 v[52:53], v6 offset:5632
    ds_read_b64_tr_b16 v[54:55], v6 offset:5888
    v_exp_f32 v196, v196
    v_exp_f32 v197, v197
    v_exp_f32 v198, v198
    v_exp_f32 v199, v199
    s_add_u32 s38, s23, 4096
    buffer_load_dwordx4 a[28:31], v2, s[4:7], s38 offen offset:3072
    s_add_u32 s38, s23, 8192
    buffer_load_dwordx4 a[32:35], v2, s[4:7], s38 offen offset:0
    s_add_u32 s38, s23, 8192
    buffer_load_dwordx4 a[36:39], v2, s[4:7], s38 offen offset:1024
    v_exp_f32 v200, v200
    v_exp_f32 v201, v201
    v_exp_f32 v202, v202
    v_exp_f32 v203, v203
    v_cvt_pk_bf16_f32 v40, v188, v189
    v_cvt_pk_bf16_f32 v41, v190, v191
    v_cvt_pk_bf16_f32 v42, v192, v193
    v_cvt_pk_bf16_f32 v43, v194, v195
    v_cvt_pk_bf16_f32 v44, v196, v197
    v_cvt_pk_bf16_f32 v45, v198, v199
    v_cvt_pk_bf16_f32 v46, v200, v201
    v_cvt_pk_bf16_f32 v47, v202, v203
    v_mfma_f32_32x32x16_bf16 v[188:203], v[152:155], v[24:27], v[64:79]
    v_exp_f32 v172, v172
    v_exp_f32 v173, v173
    v_exp_f32 v174, v174
    v_exp_f32 v175, v175
    s_waitcnt lgkmcnt(4)
    v_mfma_f32_32x32x16_bf16 v[96:111], v[56:59], v[40:43], v[96:111]
    v_exp_f32 v176, v176
    v_exp_f32 v177, v177
    v_exp_f32 v178, v178
    v_exp_f32 v179, v179
    v_mfma_f32_32x32x16_bf16 v[96:111], v[60:63], v[44:47], v[96:111]
    ds_read_b64_tr_b16 v[56:57], v6 offset:6144
    ds_read_b64_tr_b16 v[58:59], v6 offset:6400
    ds_read_b64_tr_b16 v[60:61], v6 offset:6656
    ds_read_b64_tr_b16 v[62:63], v6 offset:6912
    v_exp_f32 v180, v180
    v_exp_f32 v181, v181
    v_exp_f32 v182, v182
    v_exp_f32 v183, v183
    s_add_u32 s38, s23, 8192
    buffer_load_dwordx4 a[40:43], v2, s[4:7], s38 offen offset:2048
    s_add_u32 s38, s23, 8192
    buffer_load_dwordx4 a[44:47], v2, s[4:7], s38 offen offset:3072
    s_add_u32 s38, s23, 12288
    buffer_load_dwordx4 a[48:51], v2, s[4:7], s38 offen offset:0
    v_exp_f32 v184, v184
    v_exp_f32 v185, v185
    v_exp_f32 v186, v186
    v_exp_f32 v187, v187
    v_cvt_pk_bf16_f32 v40, v172, v173
    v_cvt_pk_bf16_f32 v41, v174, v175
    v_cvt_pk_bf16_f32 v42, v176, v177
    v_cvt_pk_bf16_f32 v43, v178, v179
    v_cvt_pk_bf16_f32 v44, v180, v181
    v_cvt_pk_bf16_f32 v45, v182, v183
    v_cvt_pk_bf16_f32 v46, v184, v185
    v_cvt_pk_bf16_f32 v47, v186, v187
    v_mfma_f32_32x32x16_bf16 v[172:187], v[156:159], v[24:27], v[64:79]
    v_exp_f32 v188, v188
    v_exp_f32 v189, v189
    v_exp_f32 v190, v190
    v_exp_f32 v191, v191
    s_waitcnt lgkmcnt(4)
    v_mfma_f32_32x32x16_bf16 v[96:111], v[48:51], v[40:43], v[96:111]
    v_exp_f32 v192, v192
    v_exp_f32 v193, v193
    v_exp_f32 v194, v194
    v_exp_f32 v195, v195
    v_mfma_f32_32x32x16_bf16 v[96:111], v[52:55], v[44:47], v[96:111]
    ds_read_b64_tr_b16 v[48:49], v6 offset:7168
    ds_read_b64_tr_b16 v[50:51], v6 offset:7424
    ds_read_b64_tr_b16 v[52:53], v6 offset:7680
    ds_read_b64_tr_b16 v[54:55], v6 offset:7936
    v_exp_f32 v196, v196
    v_exp_f32 v197, v197
    v_exp_f32 v198, v198
    v_exp_f32 v199, v199
    s_add_u32 s38, s23, 12288
    buffer_load_dwordx4 a[52:55], v2, s[4:7], s38 offen offset:1024
    s_add_u32 s38, s23, 12288
    buffer_load_dwordx4 a[56:59], v2, s[4:7], s38 offen offset:2048
    s_add_u32 s38, s23, 12288
    buffer_load_dwordx4 a[60:63], v2, s[4:7], s38 offen offset:3072
    s_add_u32 s38, s35, 0
    buffer_load_dwordx4 v[204:207], v3, s[4:7], s38 offen offset:0
    s_add_u32 s38, s35, 0
    buffer_load_dwordx4 v[208:211], v3, s[4:7], s38 offen offset:1024
    v_exp_f32 v200, v200
    v_exp_f32 v201, v201
    v_exp_f32 v202, v202
    v_exp_f32 v203, v203
    v_cvt_pk_bf16_f32 v40, v188, v189
    v_cvt_pk_bf16_f32 v41, v190, v191
    v_cvt_pk_bf16_f32 v42, v192, v193
    v_cvt_pk_bf16_f32 v43, v194, v195
    v_cvt_pk_bf16_f32 v44, v196, v197
    v_cvt_pk_bf16_f32 v45, v198, v199
    v_cvt_pk_bf16_f32 v46, v200, v201
    v_cvt_pk_bf16_f32 v47, v202, v203
    v_mfma_f32_32x32x16_bf16 v[188:203], v[160:163], v[24:27], v[64:79]
    v_exp_f32 v172, v172
    v_exp_f32 v173, v173
    v_exp_f32 v174, v174
    v_exp_f32 v175, v175
    s_waitcnt lgkmcnt(4)
    v_mfma_f32_32x32x16_bf16 v[96:111], v[56:59], v[40:43], v[96:111]
    v_exp_f32 v176, v176
    v_exp_f32 v177, v177
    v_exp_f32 v178, v178
    v_exp_f32 v179, v179
    v_mfma_f32_32x32x16_bf16 v[96:111], v[60:63], v[44:47], v[96:111]
    ds_read_b64_tr_b16 v[56:57], v6 offset:8192
    ds_read_b64_tr_b16 v[58:59], v6 offset:8448
    ds_read_b64_tr_b16 v[60:61], v6 offset:8704
    ds_read_b64_tr_b16 v[62:63], v6 offset:8960
    v_exp_f32 v180, v180
    v_exp_f32 v181, v181
    v_exp_f32 v182, v182
    v_exp_f32 v183, v183
    s_add_u32 s38, s23, 16384
    buffer_load_dwordx4 a[64:67], v2, s[4:7], s38 offen offset:0
    s_add_u32 s38, s23, 16384
    buffer_load_dwordx4 a[68:71], v2, s[4:7], s38 offen offset:1024
    s_add_u32 s38, s23, 16384
    buffer_load_dwordx4 a[72:75], v2, s[4:7], s38 offen offset:2048
    s_add_u32 s38, s35, 0
    buffer_load_dwordx4 v[212:215], v4, s[4:7], s38 offen offset:0
    s_add_u32 s38, s35, 0
    buffer_load_dwordx4 v[216:219], v4, s[4:7], s38 offen offset:1024
    v_exp_f32 v184, v184
    v_exp_f32 v185, v185
    v_exp_f32 v186, v186
    v_exp_f32 v187, v187
    v_cvt_pk_bf16_f32 v40, v172, v173
    v_cvt_pk_bf16_f32 v41, v174, v175
    v_cvt_pk_bf16_f32 v42, v176, v177
    v_cvt_pk_bf16_f32 v43, v178, v179
    v_cvt_pk_bf16_f32 v44, v180, v181
    v_cvt_pk_bf16_f32 v45, v182, v183
    v_cvt_pk_bf16_f32 v46, v184, v185
    v_cvt_pk_bf16_f32 v47, v186, v187
    v_mfma_f32_32x32x16_bf16 v[172:187], v[140:143], v[28:31], v[80:95]
    v_exp_f32 v188, v188
    v_exp_f32 v189, v189
    v_exp_f32 v190, v190
    v_exp_f32 v191, v191
    s_waitcnt lgkmcnt(4)
    v_mfma_f32_32x32x16_bf16 v[96:111], v[48:51], v[40:43], v[96:111]
    v_exp_f32 v192, v192
    v_exp_f32 v193, v193
    v_exp_f32 v194, v194
    v_exp_f32 v195, v195
    v_mfma_f32_32x32x16_bf16 v[96:111], v[52:55], v[44:47], v[96:111]
    ds_read_b64_tr_b16 v[48:49], v6 offset:3072
    ds_read_b64_tr_b16 v[50:51], v6 offset:3328
    ds_read_b64_tr_b16 v[52:53], v6 offset:3584
    ds_read_b64_tr_b16 v[54:55], v6 offset:3840
    v_exp_f32 v196, v196
    v_exp_f32 v197, v197
    v_exp_f32 v198, v198
    v_exp_f32 v199, v199
    s_add_u32 s38, s23, 16384
    buffer_load_dwordx4 a[76:79], v2, s[4:7], s38 offen offset:3072
    s_add_u32 s38, s23, 20480
    buffer_load_dwordx4 a[80:83], v2, s[4:7], s38 offen offset:0
    s_add_u32 s38, s23, 20480
    buffer_load_dwordx4 a[84:87], v2, s[4:7], s38 offen offset:1024
    s_add_u32 s38, s35, 4096
    buffer_load_dwordx4 v[64:67], v3, s[4:7], s38 offen offset:0
    s_add_u32 s38, s35, 4096
    buffer_load_dwordx4 v[68:71], v3, s[4:7], s38 offen offset:1024
    v_exp_f32 v200, v200
    v_exp_f32 v201, v201
    v_exp_f32 v202, v202
    v_exp_f32 v203, v203
    v_cvt_pk_bf16_f32 v40, v188, v189
    v_cvt_pk_bf16_f32 v41, v190, v191
    v_cvt_pk_bf16_f32 v42, v192, v193
    v_cvt_pk_bf16_f32 v43, v194, v195
    v_cvt_pk_bf16_f32 v44, v196, v197
    v_cvt_pk_bf16_f32 v45, v198, v199
    v_cvt_pk_bf16_f32 v46, v200, v201
    v_cvt_pk_bf16_f32 v47, v202, v203
    v_bfi_b32 v40, v32, 0, v40
    v_bfi_b32 v41, v33, 0, v41
    v_bfi_b32 v42, v34, 0, v42
    v_bfi_b32 v43, v35, 0, v43
    v_bfi_b32 v44, v36, 0, v44
    v_bfi_b32 v45, v37, 0, v45
    v_bfi_b32 v46, v38, 0, v46
    v_bfi_b32 v47, v39, 0, v47
    v_mfma_f32_32x32x16_bf16 v[188:203], v[144:147], v[28:31], v[80:95]
    v_exp_f32 v172, v172
    v_exp_f32 v173, v173
    v_exp_f32 v174, v174
    v_exp_f32 v175, v175
    s_waitcnt lgkmcnt(4)
    v_mfma_f32_32x32x16_bf16 v[96:111], v[56:59], v[40:43], v[96:111]
    v_exp_f32 v176, v176
    v_exp_f32 v177, v177
    v_exp_f32 v178, v178
    v_exp_f32 v179, v179
    v_mfma_f32_32x32x16_bf16 v[96:111], v[60:63], v[44:47], v[96:111]
    ds_read_b64_tr_b16 v[56:57], v6 offset:4096
    ds_read_b64_tr_b16 v[58:59], v6 offset:4352
    ds_read_b64_tr_b16 v[60:61], v6 offset:4608
    ds_read_b64_tr_b16 v[62:63], v6 offset:4864
    v_exp_f32 v180, v180
    v_exp_f32 v181, v181
    v_exp_f32 v182, v182
    v_exp_f32 v183, v183
    s_add_u32 s38, s35, 4096
    buffer_load_dwordx4 v[72:75], v4, s[4:7], s38 offen offset:0
    s_add_u32 s38, s35, 4096
    buffer_load_dwordx4 v[76:79], v4, s[4:7], s38 offen offset:1024
    v_exp_f32 v184, v184
    v_exp_f32 v185, v185
    v_exp_f32 v186, v186
    v_exp_f32 v187, v187
    v_subrev_u32 v12, 0x21800000, v104
    v_cmp_gt_u32 vcc, 0x3c000000, v12
    s_cmp_eq_u64 vcc, -1
    s_nop 3
    s_cbranch_scc0 L_fbs_33
L_fbc_34:
    s_waitcnt vmcnt(30)
    v_rcp_f32 v104, v104
    s_nop 0
    v_mul_f32 v96, v96, v104
    v_mul_f32 v97, v97, v104
    v_mul_f32 v98, v98, v104
    v_mul_f32 v99, v99, v104
    v_mul_f32 v100, v100, v104
    v_mul_f32 v101, v101, v104
    v_mul_f32 v102, v102, v104
    v_mul_f32 v103, v103, v104
    v_cvt_pk_bf16_f32 v108, v96, v97
    v_cvt_pk_bf16_f32 v109, v98, v99
    v_cvt_pk_bf16_f32 v110, v100, v101
    v_cvt_pk_bf16_f32 v111, v102, v103
    buffer_store_dwordx4 v[108:111], v7, s[4:7], s40 offen sc1
    v_mov_b32 v12, 1
    s_mov_b64 exec, 1
    buffer_store_dword v12, off, s[4:7], s42 offset:0 sc1
    s_mov_b64 exec, -1
    v_cvt_pk_bf16_f32 v40, v172, v173
    v_cvt_pk_bf16_f32 v41, v174, v175
    v_cvt_pk_bf16_f32 v42, v176, v177
    v_cvt_pk_bf16_f32 v43, v178, v179
    v_cvt_pk_bf16_f32 v44, v180, v181
    v_cvt_pk_bf16_f32 v45, v182, v183
    v_cvt_pk_bf16_f32 v46, v184, v185
    v_cvt_pk_bf16_f32 v47, v186, v187
    v_mfma_f32_32x32x16_bf16 v[172:187], v[148:151], v[28:31], v[80:95]
    v_exp_f32 v188, v188
    v_exp_f32 v189, v189
    v_exp_f32 v190, v190
    v_exp_f32 v191, v191
    s_waitcnt lgkmcnt(4)
    v_mfma_f32_32x32x16_bf16 v[112:127], v[48:51], v[40:43], 0
    v_exp_f32 v192, v192
    v_exp_f32 v193, v193
    v_exp_f32 v194, v194
    v_exp_f32 v195, v195
    v_mfma_f32_32x32x16_bf16 v[112:127], v[52:55], v[44:47], v[112:127]
    ds_read_b64_tr_b16 v[48:49], v6 offset:5120
    ds_read_b64_tr_b16 v[50:51], v6 offset:5376
    ds_read_b64_tr_b16 v[52:53], v6 offset:5632
    ds_read_b64_tr_b16 v[54:55], v6 offset:5888
    s_waitcnt vmcnt(31)
    v_mfma_f32_16x16x32_bf16 v[96:99], a[0:3], v[220:223], 0
    v_exp_f32 v196, v196
    v_exp_f32 v197, v197
    s_waitcnt vmcnt(30)
    v_mfma_f32_16x16x32_bf16 v[100:103], a[4:7], v[220:223], 0
    v_exp_f32 v198, v198
    v_exp_f32 v199, v199
    s_waitcnt vmcnt(29)
    v_mfma_f32_16x16x32_bf16 v[104:107], a[8:11], v[220:223], 0
    s_add_u32 s38, s35, 8192
    buffer_load_dwordx4 v[128:131], v3, s[4:7], s38 offen offset:0
    s_add_u32 s38, s35, 8192
    buffer_load_dwordx4 v[132:135], v3, s[4:7], s38 offen offset:1024
    v_exp_f32 v200, v200
    v_exp_f32 v201, v201
    s_waitcnt vmcnt(30)
    v_mfma_f32_16x16x32_bf16 v[108:111], a[12:15], v[220:223], 0
    v_exp_f32 v202, v202
    v_exp_f32 v203, v203
    s_waitcnt vmcnt(29)
    v_mfma_f32_16x16x32_bf16 v[96:99], a[16:19], v[220:223], v[96:99]
    v_cvt_pk_bf16_f32 v40, v188, v189
    v_cvt_pk_bf16_f32 v41, v190, v191
    v_cvt_pk_bf16_f32 v42, v192, v193
    v_cvt_pk_bf16_f32 v43, v194, v195
    v_cvt_pk_bf16_f32 v44, v196, v197
    v_cvt_pk_bf16_f32 v45, v198, v199
    v_cvt_pk_bf16_f32 v46, v200, v201
    v_cvt_pk_bf16_f32 v47, v202, v203
    v_mfma_f32_32x32x16_bf16 v[188:203], v[152:155], v[28:31], v[80:95]
    v_exp_f32 v172, v172
    v_exp_f32 v173, v173
    v_exp_f32 v174, v174
    v_exp_f32 v175, v175
    s_waitcnt lgkmcnt(4)
    v_mfma_f32_32x32x16_bf16 v[112:127], v[56:59], v[40:43], v[112:127]
    v_exp_f32 v176, v176
    v_exp_f32 v177, v177
    v_exp_f32 v178, v178
    v_exp_f32 v179, v179
    v_mfma_f32_32x32x16_bf16 v[112:127], v[60:63], v[44:47], v[112:127]
    ds_read_b64_tr_b16 v[56:57], v6 offset:6144
    ds_read_b64_tr_b16 v[58:59], v6 offset:6400
    ds_read_b64_tr_b16 v[60:61], v6 offset:6656
    ds_read_b64_tr_b16 v[62:63], v6 offset:6912
    s_waitcnt vmcnt(28)
    v_mfma_f32_16x16x32_bf16 v[100:103], a[20:23], v[220:223], v[100:103]
    v_exp_f32 v180, v180
    v_exp_f32 v181, v181
    s_waitcnt vmcnt(27)
    v_mfma_f32_16x16x32_bf16 v[104:107], a[24:27], v[220:223], v[104:107]
    v_exp_f32 v182, v182
    v_exp_f32 v183, v183
    s_waitcnt vmcnt(26)
    v_mfma_f32_16x16x32_bf16 v[108:111], a[28:31], v[220:223], v[108:111]
    s_add_u32 s38, s35, 8192
    buffer_load_dwordx4 v[136:139], v4, s[4:7], s38 offen offset:0
    s_add_u32 s38, s35, 8192
    buffer_load_dwordx4 v[140:143], v4, s[4:7], s38 offen offset:1024
    v_exp_f32 v184, v184
    v_exp_f32 v185, v185
    s_waitcnt vmcnt(27)
    v_mfma_f32_16x16x32_bf16 v[96:99], a[32:35], v[220:223], v[96:99]
    v_exp_f32 v186, v186
    v_exp_f32 v187, v187
    s_waitcnt vmcnt(26)
    v_mfma_f32_16x16x32_bf16 v[100:103], a[36:39], v[220:223], v[100:103]
    v_cvt_pk_bf16_f32 v40, v172, v173
    v_cvt_pk_bf16_f32 v41, v174, v175
    v_cvt_pk_bf16_f32 v42, v176, v177
    v_cvt_pk_bf16_f32 v43, v178, v179
    v_cvt_pk_bf16_f32 v44, v180, v181
    v_cvt_pk_bf16_f32 v45, v182, v183
    v_cvt_pk_bf16_f32 v46, v184, v185
    v_cvt_pk_bf16_f32 v47, v186, v187
    v_mfma_f32_32x32x16_bf16 v[172:187], v[156:159], v[28:31], v[80:95]
    v_exp_f32 v188, v188
    v_exp_f32 v189, v189
    v_exp_f32 v190, v190
    v_exp_f32 v191, v191
    s_waitcnt lgkmcnt(4)
    v_mfma_f32_32x32x16_bf16 v[112:127], v[48:51], v[40:43], v[112:127]
    v_exp_f32 v192, v192
    v_exp_f32 v193, v193
    v_exp_f32 v194, v194
    v_exp_f32 v195, v195
    v_mfma_f32_32x32x16_bf16 v[112:127], v[52:55], v[44:47], v[112:127]
    ds_read_b64_tr_b16 v[48:49], v6 offset:7168
    ds_read_b64_tr_b16 v[50:51], v6 offset:7424
    ds_read_b64_tr_b16 v[52:53], v6 offset:7680
    ds_read_b64_tr_b16 v[54:55], v6 offset:7936
    s_waitcnt vmcnt(25)
    v_mfma_f32_16x16x32_bf16 v[104:107], a[40:43], v[220:223], v[104:107]
    v_exp_f32 v196, v196
    v_exp_f32 v197, v197
    s_waitcnt vmcnt(24)
    v_mfma_f32_16x16x32_bf16 v[108:111], a[44:47], v[220:223], v[108:111]
    v_exp_f32 v198, v198
    v_exp_f32 v199, v199
    s_waitcnt vmcnt(23)
    v_mfma_f32_16x16x32_bf16 v[96:99], a[48:51], v[220:223], v[96:99]
    s_add_u32 s38, s35, 12288
    buffer_load_dwordx4 v[144:147], v3, s[4:7], s38 offen offset:0
    s_add_u32 s38, s35, 12288
    buffer_load_dwordx4 v[148:151], v3, s[4:7], s38 offen offset:1024
    v_exp_f32 v200, v200
    v_exp_f32 v201, v201
    s_waitcnt vmcnt(24)
    v_mfma_f32_16x16x32_bf16 v[100:103], a[52:55], v[220:223], v[100:103]
    v_exp_f32 v202, v202
    v_exp_f32 v203, v203
    s_waitcnt vmcnt(23)
    v_mfma_f32_16x16x32_bf16 v[104:107], a[56:59], v[220:223], v[104:107]
    v_cvt_pk_bf16_f32 v40, v188, v189
    v_cvt_pk_bf16_f32 v41, v190, v191
    v_cvt_pk_bf16_f32 v42, v192, v193
    v_cvt_pk_bf16_f32 v43, v194, v195
    v_cvt_pk_bf16_f32 v44, v196, v197
    v_cvt_pk_bf16_f32 v45, v198, v199
    v_cvt_pk_bf16_f32 v46, v200, v201
    v_cvt_pk_bf16_f32 v47, v202, v203
    v_mfma_f32_32x32x16_bf16 v[188:203], v[160:163], v[28:31], v[80:95]
    v_exp_f32 v172, v172
    v_exp_f32 v173, v173
    v_exp_f32 v174, v174
    v_exp_f32 v175, v175
    s_waitcnt lgkmcnt(4)
    v_mfma_f32_32x32x16_bf16 v[112:127], v[56:59], v[40:43], v[112:127]
    v_exp_f32 v176, v176
    v_exp_f32 v177, v177
    v_exp_f32 v178, v178
    v_exp_f32 v179, v179
    v_mfma_f32_32x32x16_bf16 v[112:127], v[60:63], v[44:47], v[112:127]
    ds_read_b64_tr_b16 v[56:57], v6 offset:8192
    ds_read_b64_tr_b16 v[58:59], v6 offset:8448
    ds_read_b64_tr_b16 v[60:61], v6 offset:8704
    ds_read_b64_tr_b16 v[62:63], v6 offset:8960
    s_waitcnt vmcnt(22)
    v_mfma_f32_16x16x32_bf16 v[108:111], a[60:63], v[220:223], v[108:111]
    v_exp_f32 v180, v180
    v_exp_f32 v181, v181
    s_waitcnt vmcnt(19)
    v_mfma_f32_16x16x32_bf16 v[96:99], a[64:67], v[220:223], v[96:99]
    v_exp_f32 v182, v182
    v_exp_f32 v183, v183
    s_waitcnt vmcnt(18)
    v_mfma_f32_16x16x32_bf16 v[100:103], a[68:71], v[220:223], v[100:103]
    s_add_u32 s38, s35, 12288
    buffer_load_dwordx4 v[152:155], v4, s[4:7], s38 offen offset:0
    s_add_u32 s38, s35, 12288
    buffer_load_dwordx4 v[156:159], v4, s[4:7], s38 offen offset:1024
    v_exp_f32 v184, v184
    v_exp_f32 v185, v185
    s_waitcnt vmcnt(19)
    v_mfma_f32_16x16x32_bf16 v[104:107], a[72:75], v[220:223], v[104:107]
    v_exp_f32 v186, v186
    v_exp_f32 v187, v187
    s_waitcnt vmcnt(16)
    v_mfma_f32_16x16x32_bf16 v[108:111], a[76:79], v[220:223], v[108:111]
    v_cvt_pk_bf16_f32 v40, v172, v173
    v_cvt_pk_bf16_f32 v41, v174, v175
    v_cvt_pk_bf16_f32 v42, v176, v177
    v_cvt_pk_bf16_f32 v43, v178, v179
    v_cvt_pk_bf16_f32 v44, v180, v181
    v_cvt_pk_bf16_f32 v45, v182, v183
    v_cvt_pk_bf16_f32 v46, v184, v185
    v_cvt_pk_bf16_f32 v47, v186, v187
    v_mfma_f32_32x32x16_bf16 v[172:187], v[164:167], v[28:31], v[80:95]
    v_exp_f32 v188, v188
    v_exp_f32 v189, v189
    v_exp_f32 v190, v190
    v_exp_f32 v191, v191
    s_waitcnt lgkmcnt(4)
    v_mfma_f32_32x32x16_bf16 v[112:127], v[48:51], v[40:43], v[112:127]
    v_exp_f32 v192, v192
    v_exp_f32 v193, v193
    v_exp_f32 v194, v194
    v_exp_f32 v195, v195
    v_mfma_f32_32x32x16_bf16 v[112:127], v[52:55], v[44:47], v[112:127]
    ds_read_b64_tr_b16 v[48:49], v6 offset:9216
    ds_read_b64_tr_b16 v[50:51], v6 offset:9472
    ds_read_b64_tr_b16 v[52:53], v6 offset:9728
    ds_read_b64_tr_b16 v[54:55], v6 offset:9984
    s_waitcnt vmcnt(15)
    v_mfma_f32_16x16x32_bf16 v[96:99], a[80:83], v[220:223], v[96:99]
    v_exp_f32 v196, v196
    v_exp_f32 v197, v197
    s_waitcnt vmcnt(14)
    v_mfma_f32_16x16x32_bf16 v[100:103], a[84:87], v[220:223], v[100:103]
    v_exp_f32 v198, v198
    v_exp_f32 v199, v199
    v_exp_f32 v200, v200
    v_exp_f32 v201, v201
    v_exp_f32 v202, v202
    v_exp_f32 v203, v203
    v_cvt_pk_bf16_f32 v40, v188, v189
    v_cvt_pk_bf16_f32 v41, v190, v191
    v_cvt_pk_bf16_f32 v42, v192, v193
    v_cvt_pk_bf16_f32 v43, v194, v195
    v_cvt_pk_bf16_f32 v44, v196, v197
    v_cvt_pk_bf16_f32 v45, v198, v199
    v_cvt_pk_bf16_f32 v46, v200, v201
    v_cvt_pk_bf16_f32 v47, v202, v203
    v_mfma_f32_32x32x16_bf16 v[188:203], v[168:171], v[28:31], v[80:95]
    v_exp_f32 v172, v172
    v_exp_f32 v173, v173
    v_exp_f32 v174, v174
    v_exp_f32 v175, v175
    s_waitcnt lgkmcnt(4)
    v_mfma_f32_32x32x16_bf16 v[112:127], v[56:59], v[40:43], v[112:127]
    v_exp_f32 v176, v176
    v_exp_f32 v177, v177
    v_exp_f32 v178, v178
    v_exp_f32 v179, v179
    v_mfma_f32_32x32x16_bf16 v[112:127], v[60:63], v[44:47], v[112:127]
    ds_read_b64_tr_b16 v[56:57], v6 offset:10240
    ds_read_b64_tr_b16 v[58:59], v6 offset:10496
    ds_read_b64_tr_b16 v[60:61], v6 offset:10752
    ds_read_b64_tr_b16 v[62:63], v6 offset:11008
    v_exp_f32 v180, v180
    v_exp_f32 v181, v181
    v_exp_f32 v182, v182
    v_exp_f32 v183, v183
    v_exp_f32 v184, v184
    v_exp_f32 v185, v185
    v_exp_f32 v186, v186
    v_exp_f32 v187, v187
    v_cvt_pk_bf16_f32 v40, v172, v173
    v_cvt_pk_bf16_f32 v41, v174, v175
    v_cvt_pk_bf16_f32 v42, v176, v177
    v_cvt_pk_bf16_f32 v43, v178, v179
    v_cvt_pk_bf16_f32 v44, v180, v181
    v_cvt_pk_bf16_f32 v45, v182, v183
    v_cvt_pk_bf16_f32 v46, v184, v185
    v_cvt_pk_bf16_f32 v47, v186, v187
    v_exp_f32 v188, v188
    v_exp_f32 v189, v189
    v_exp_f32 v190, v190
    v_exp_f32 v191, v191
    s_waitcnt lgkmcnt(4)
    v_mfma_f32_32x32x16_bf16 v[112:127], v[48:51], v[40:43], v[112:127]
    v_exp_f32 v192, v192
    v_exp_f32 v193, v193
    v_exp_f32 v194, v194
    v_exp_f32 v195, v195
    v_mfma_f32_32x32x16_bf16 v[112:127], v[52:55], v[44:47], v[112:127]
    v_exp_f32 v196, v196
    v_exp_f32 v197, v197
    v_exp_f32 v198, v198
    v_exp_f32 v199, v199
    v_exp_f32 v200, v200
    v_exp_f32 v201, v201
    v_exp_f32 v202, v202
    v_exp_f32 v203, v203
    v_cvt_pk_bf16_f32 v40, v188, v189
    v_cvt_pk_bf16_f32 v41, v190, v191
    v_cvt_pk_bf16_f32 v42, v192, v193
    v_cvt_pk_bf16_f32 v43, v194, v195
    v_cvt_pk_bf16_f32 v44, v196, v197
    v_cvt_pk_bf16_f32 v45, v198, v199
    v_cvt_pk_bf16_f32 v46, v200, v201
    v_cvt_pk_bf16_f32 v47, v202, v203
    v_bfi_b32 v40, v32, 0, v40
    v_bfi_b32 v41, v33, 0, v41
    v_bfi_b32 v42, v34, 0, v42
    v_bfi_b32 v43, v35, 0, v43
    v_bfi_b32 v44, v36, 0, v44
    v_bfi_b32 v45, v37, 0, v45
    v_bfi_b32 v46, v38, 0, v46
    v_bfi_b32 v47, v39, 0, v47
    s_waitcnt lgkmcnt(0)
    v_mfma_f32_32x32x16_bf16 v[112:127], v[56:59], v[40:43], v[112:127]
    v_mfma_f32_32x32x16_bf16 v[112:127], v[60:63], v[44:47], v[112:127]
    s_nop 11
    v_subrev_u32 v12, 0x21800000, v120
    v_cmp_gt_u32 vcc, 0x3c000000, v12
    s_cmp_eq_u64 vcc, -1
    s_nop 3
    s_cbranch_scc0 L_fbs_35
L_fbc_36:
    v_rcp_f32 v120, v120
    s_nop 0
    v_pk_mul_f32 v[112:113], v[112:113], v[120:121] op_sel:[0,0] op_sel_hi:[1,0]
    v_pk_mul_f32 v[114:115], v[114:115], v[120:121] op_sel:[0,0] op_sel_hi:[1,0]
    v_pk_mul_f32 v[116:117], v[116:117], v[120:121] op_sel:[0,0] op_sel_hi:[1,0]
    v_pk_mul_f32 v[118:119], v[118:119], v[120:121] op_sel:[0,0] op_sel_hi:[1,0]
    v_cvt_pk_bf16_f32 v124, v112, v113
    v_cvt_pk_bf16_f32 v125, v114, v115
    v_cvt_pk_bf16_f32 v126, v116, v117
    v_cvt_pk_bf16_f32 v127, v118, v119
    buffer_store_dwordx4 v[124:127], v7, s[4:7], s41 offen sc1
    buffer_load_dword v14, v5, s[4:7], s43 offen offset:0 sc1
    s_add_u32 s38, s23, 20480
    buffer_load_dwordx4 a[88:91], v2, s[4:7], s38 offen offset:2048
    s_add_u32 s38, s23, 20480
    buffer_load_dwordx4 a[92:95], v2, s[4:7], s38 offen offset:3072
    s_add_u32 s38, s23, 24576
    buffer_load_dwordx4 a[96:99], v2, s[4:7], s38 offen offset:0
    s_add_u32 s38, s23, 24576
    buffer_load_dwordx4 a[100:103], v2, s[4:7], s38 offen offset:1024
    s_add_u32 s38, s23, 24576
    buffer_load_dwordx4 a[104:107], v2, s[4:7], s38 offen offset:2048
    s_waitcnt vmcnt(5)
    v_cmp_gt_u32 vcc, 1, v14
    s_cmp_eq_u64 vcc, 0
    s_cselect_b64 s[70:71], -1, 0
    s_mov_b64 exec, s[70:71]
    buffer_load_dwordx4 v[240:243], v2, s[4:7], s45 offen offset:0
    buffer_load_dwordx4 v[244:247], v2, s[4:7], s45 offen offset:1024
    buffer_load_dwordx4 v[248:251], v2, s[4:7], s45 offen offset:2048
    buffer_load_dwordx4 v[252:255], v2, s[4:7], s45 offen offset:3072
    buffer_load_dwordx4 v[224:227], v2, s[4:7], s44 offen offset:0
    buffer_load_dwordx4 v[228:231], v2, s[4:7], s44 offen offset:1024
    buffer_load_dwordx4 v[232:235], v2, s[4:7], s44 offen offset:2048
    buffer_load_dwordx4 v[236:239], v2, s[4:7], s44 offen offset:3072
    s_mov_b64 exec, -1
    s_add_u32 s38, s23, 24576
    buffer_load_dwordx4 a[108:111], v2, s[4:7], s38 offen offset:3072
    s_add_u32 s38, s23, 28672
    buffer_load_dwordx4 a[112:115], v2, s[4:7], s38 offen offset:0
    s_add_u32 s38, s23, 28672
    buffer_load_dwordx4 a[116:119], v2, s[4:7], s38 offen offset:1024
    s_add_u32 s38, s23, 28672
    buffer_load_dwordx4 a[120:123], v2, s[4:7], s38 offen offset:2048
    s_add_u32 s38, s23, 28672
    buffer_load_dwordx4 a[124:127], v2, s[4:7], s38 offen offset:3072
    s_waitcnt vmcnt(0)
    v_mfma_f32_16x16x32_bf16 v[104:107], a[88:91], v[220:223], v[104:107]
    v_mfma_f32_16x16x32_bf16 v[108:111], a[92:95], v[220:223], v[108:111]
    v_mfma_f32_16x16x32_bf16 v[96:99], a[96:99], v[220:223], v[96:99]
    v_mfma_f32_16x16x32_bf16 v[100:103], a[100:103], v[220:223], v[100:103]
    v_mfma_f32_16x16x32_bf16 v[104:107], a[104:107], v[220:223], v[104:107]
    v_mfma_f32_16x16x32_bf16 v[108:111], a[108:111], v[220:223], v[108:111]
    v_mfma_f32_16x16x32_bf16 v[96:99], a[112:115], v[220:223], v[96:99]
    v_mfma_f32_16x16x32_bf16 v[100:103], a[116:119], v[220:223], v[100:103]
    v_mfma_f32_16x16x32_bf16 v[104:107], a[120:123], v[220:223], v[104:107]
    v_mfma_f32_16x16x32_bf16 v[108:111], a[124:127], v[220:223], v[108:111]
    s_nop 7
L_join_6:
    s_cmp_eq_u32 s70, 0
    s_cbranch_scc1 L_late_37
L_lback_38:
    s_add_u32 s38, s23, 32768
    buffer_load_dwordx4 a[128:131], v2, s[4:7], s38 offen offset:0
    s_add_u32 s38, s23, 32768
    buffer_load_dwordx4 a[132:135], v2, s[4:7], s38 offen offset:1024
    s_add_u32 s38, s23, 32768
    s_waitcnt vmcnt(62)
    buffer_load_dwordx4 a[136:139], v2, s[4:7], s38 offen offset:2048
    s_add_u32 s38, s23, 32768
    s_waitcnt vmcnt(62)
    buffer_load_dwordx4 a[140:143], v2, s[4:7], s38 offen offset:3072
    s_add_u32 s38, s23, 36864
    s_waitcnt vmcnt(62)
    buffer_load_dwordx4 a[144:147], v2, s[4:7], s38 offen offset:0
    s_add_u32 s38, s23, 36864
    s_waitcnt vmcnt(62)
    buffer_load_dwordx4 a[148:151], v2, s[4:7], s38 offen offset:1024
    s_xor_b32 s32, s3, 1
    s_mul_i32 s32, s32, 6144
    s_add_u32 s32, s32, 65536
    v_add_u32 v8, s32, v2
    s_xor_b32 s32, s3, 2
    s_mul_i32 s32, s32, 6144
    s_add_u32 s32, s32, 67584
    v_add_u32 v9, s32, v2
    s_xor_b32 s32, s3, 3
    s_mul_i32 s32, s32, 6144
    s_add_u32 s32, s32, 69632
    v_add_u32 v10, s32, v2
    s_mul_i32 s32, s3, 6144
    s_add_u32 s32, s32, 65536
    v_add_u32 v11, s32, v2
    v_lshrrev_b32 v6, 5, v1
    v_lshl_add_u32 v6, v6, 6, v5
    v_mov_b32 v7, 0x3f803f80
    v_lshlrev_b32 v24, 16, v16
    v_and_b32 v25, 0xffff0000, v16
    v_lshlrev_b32 v26, 16, v17
    v_and_b32 v27, 0xffff0000, v17
    v_lshlrev_b32 v28, 16, v18
    v_and_b32 v29, 0xffff0000, v18
    v_lshlrev_b32 v30, 16, v19
    v_and_b32 v31, 0xffff0000, v19
    s_waitcnt vmcnt(7)
    v_mfma_f32_16x16x32_bf16 v[48:51], v[204:207], v[240:243], 0
    v_mfma_f32_16x16x32_bf16 v[52:55], v[208:211], v[240:243], 0
    v_mfma_f32_16x16x32_bf16 v[56:59], v[212:215], v[240:243], 0
    v_mfma_f32_16x16x32_bf16 v[60:63], v[216:219], v[240:243], 0
    v_mfma_f32_16x16x32_bf16 v[48:51], v[64:67], v[244:247], v[48:51]
    v_mfma_f32_16x16x32_bf16 v[52:55], v[68:71], v[244:247], v[52:55]
    v_mfma_f32_16x16x32_bf16 v[56:59], v[72:75], v[244:247], v[56:59]
    v_mfma_f32_16x16x32_bf16 v[60:63], v[76:79], v[244:247], v[60:63]
    v_mfma_f32_16x16x32_bf16 v[48:51], v[128:131], v[248:251], v[48:51]
    v_mfma_f32_16x16x32_bf16 v[52:55], v[132:135], v[248:251], v[52:55]
    v_mfma_f32_16x16x32_bf16 v[56:59], v[136:139], v[248:251], v[56:59]
    v_mfma_f32_16x16x32_bf16 v[60:63], v[140:143], v[248:251], v[60:63]
    v_mfma_f32_16x16x32_bf16 v[48:51], v[144:147], v[252:255], v[48:51]
    v_mfma_f32_16x16x32_bf16 v[52:55], v[148:151], v[252:255], v[52:55]
    v_mfma_f32_16x16x32_bf16 v[56:59], v[152:155], v[252:255], v[56:59]
    v_mfma_f32_16x16x32_bf16 v[60:63], v[156:159], v[252:255], v[60:63]
    v_mfma_f32_16x16x32_bf16 v[40:43], v[212:215], v[224:227], 0
    v_mfma_f32_16x16x32_bf16 v[44:47], v[216:219], v[224:227], 0
    v_mfma_f32_16x16x32_bf16 v[40:43], v[72:75], v[228:231], v[40:43]
    v_mfma_f32_16x16x32_bf16 v[44:47], v[76:79], v[228:231], v[44:47]
    s_nop 0
    ds_write_b128 v9, v[48:51] offset:0
    v_mfma_f32_16x16x32_bf16 v[40:43], v[136:139], v[232:235], v[40:43]
    v_mfma_f32_16x16x32_bf16 v[44:47], v[140:143], v[232:235], v[44:47]
    ds_write_b128 v9, v[52:55] offset:1024
    v_mfma_f32_16x16x32_bf16 v[40:43], v[152:155], v[236:239], v[40:43]
    v_mfma_f32_16x16x32_bf16 v[44:47], v[156:159], v[236:239], v[44:47]
    ds_write_b128 v10, v[56:59] offset:0
    v_mfma_f32_16x16x32_bf16 v[32:35], v[204:207], v[224:227], 0
    v_mfma_f32_16x16x32_bf16 v[36:39], v[208:211], v[224:227], 0
    ds_write_b128 v10, v[60:63] offset:1024
    v_mfma_f32_16x16x32_bf16 v[32:35], v[64:67], v[228:231], v[32:35]
    v_mfma_f32_16x16x32_bf16 v[36:39], v[68:71], v[228:231], v[36:39]
    v_mfma_f32_16x16x32_bf16 v[32:35], v[128:131], v[232:235], v[32:35]
    v_mfma_f32_16x16x32_bf16 v[36:39], v[132:135], v[232:235], v[36:39]
    ds_write_b128 v8, v[40:43] offset:0
    v_mfma_f32_16x16x32_bf16 v[32:35], v[144:147], v[236:239], v[32:35]
    v_mfma_f32_16x16x32_bf16 v[36:39], v[148:151], v[236:239], v[36:39]
    ds_write_b128 v8, v[44:47] offset:1024
    v_cmp_u_f32 vcc, v48, v40
    s_nop 5
    s_cbranch_vccnz L_slow3_39
L_back3_40:
    s_waitcnt lgkmcnt(0)
    s_barrier
    ds_read_b128 v[160:163], v11 offset:0
    ds_read_b128 v[164:167], v11 offset:1024
    ds_read_b128 v[168:171], v11 offset:2048
    ds_read_b128 v[172:175], v11 offset:3072
    ds_read_b128 v[176:179], v11 offset:4096
    ds_read_b128 v[180:183], v11 offset:5120
    v_pk_add_f32 v[32:33], v[32:33], v[24:25] op_sel:[0,0] op_sel_hi:[1,1]
    v_pk_add_f32 v[34:35], v[34:35], v[26:27] op_sel:[0,0] op_sel_hi:[1,1]
    v_pk_add_f32 v[36:37], v[36:37], v[28:29] op_sel:[0,0] op_sel_hi:[1,1]
    v_pk_add_f32 v[38:39], v[38:39], v[30:31] op_sel:[0,0] op_sel_hi:[1,1]
    s_waitcnt lgkmcnt(4)
    v_pk_add_f32 v[32:33], v[32:33], v[160:161] op_sel:[0,0] op_sel_hi:[1,1]
    v_pk_add_f32 v[34:35], v[34:35], v[162:163] op_sel:[0,0] op_sel_hi:[1,1]
    v_pk_add_f32 v[36:37], v[36:37], v[164:165] op_sel:[0,0] op_sel_hi:[1,1]
    v_pk_add_f32 v[38:39], v[38:39], v[166:167] op_sel:[0,0] op_sel_hi:[1,1]
    s_waitcnt lgkmcnt(2)
    v_pk_add_f32 v[32:33], v[32:33], v[168:169] op_sel:[0,0] op_sel_hi:[1,1]
    v_pk_add_f32 v[34:35], v[34:35], v[170:171] op_sel:[0,0] op_sel_hi:[1,1]
    v_pk_add_f32 v[36:37], v[36:37], v[172:173] op_sel:[0,0] op_sel_hi:[1,1]
    v_pk_add_f32 v[38:39], v[38:39], v[174:175] op_sel:[0,0] op_sel_hi:[1,1]
    s_waitcnt lgkmcnt(0)
    v_pk_add_f32 v[32:33], v[32:33], v[176:177] op_sel:[0,0] op_sel_hi:[1,1]
    v_pk_add_f32 v[34:35], v[34:35], v[178:179] op_sel:[0,0] op_sel_hi:[1,1]
    v_pk_add_f32 v[36:37], v[36:37], v[180:181] op_sel:[0,0] op_sel_hi:[1,1]
    v_pk_add_f32 v[38:39], v[38:39], v[182:183] op_sel:[0,0] op_sel_hi:[1,1]
    v_cvt_pk_bf16_f32 v16, v32, v33
    v_cvt_pk_bf16_f32 v17, v34, v35
    v_cvt_pk_bf16_f32 v18, v36, v37
    v_cvt_pk_bf16_f32 v19, v38, v39
    buffer_store_dwordx4 v[16:19], v2, s[4:7], s46 offen sc1
    v_dot2_f32_bf16 v13, v16, v7, 0
    v_dot2_f32_bf16 v14, v16, v16, 0
    v_dot2_f32_bf16 v13, v17, v7, v13
    v_dot2_f32_bf16 v14, v17, v17, v14
    v_dot2_f32_bf16 v13, v18, v7, v13
    v_dot2_f32_bf16 v14, v18, v18, v14
    v_dot2_f32_bf16 v13, v19, v7, v13
    v_dot2_f32_bf16 v14, v19, v19, v14
    s_nop 2
    v_permlane32_swap_b32 v13, v14
    s_nop 0
    v_add_f32 v13, v13, v14
    v_mov_b32 v14, v13
    s_nop 1
    v_permlane16_swap_b32 v13, v14
    s_nop 0
    v_add_f32 v13, v13, v14
    buffer_store_dword v13, v6, s[4:7], s47 offen sc1
    v_mov_b32 v15, 1
    s_mov_b64 exec, 1
    buffer_store_dword v15, off, s[4:7], s48 offset:0 sc1
    s_mov_b64 exec, -1
    s_add_u32 s46, s46, 65536
    s_add_u32 s47, s47, 2048
    buffer_load_dwordx4 v[80:83], v2, s[4:7], s73 offen offset:0
    buffer_load_dwordx4 v[84:87], v2, s[4:7], s73 offen offset:1024
    buffer_load_dwordx4 v[88:91], v2, s[4:7], s73 offen offset:2048
    buffer_load_dwordx4 v[92:95], v2, s[4:7], s73 offen offset:3072
    buffer_load_dwordx4 v[184:187], v2, s[4:7], s72 offen offset:0
    buffer_load_dwordx4 v[188:191], v2, s[4:7], s72 offen offset:1024
    buffer_load_dwordx4 v[192:195], v2, s[4:7], s72 offen offset:2048
    buffer_load_dwordx4 v[196:199], v2, s[4:7], s72 offen offset:3072
    v_lshlrev_b32 v24, 16, v20
    v_and_b32 v25, 0xffff0000, v20
    v_lshlrev_b32 v26, 16, v21
    v_and_b32 v27, 0xffff0000, v21
    v_lshlrev_b32 v28, 16, v22
    v_and_b32 v29, 0xffff0000, v22
    v_lshlrev_b32 v30, 16, v23
    v_and_b32 v31, 0xffff0000, v23
    s_waitcnt vmcnt(7)
    v_mfma_f32_16x16x32_bf16 v[48:51], v[204:207], v[80:83], 0
    v_mfma_f32_16x16x32_bf16 v[52:55], v[208:211], v[80:83], 0
    v_mfma_f32_16x16x32_bf16 v[56:59], v[212:215], v[80:83], 0
    v_mfma_f32_16x16x32_bf16 v[60:63], v[216:219], v[80:83], 0
    s_add_u32 s38, s23, 36864
    buffer_load_dwordx4 a[152:155], v2, s[4:7], s38 offen offset:2048
    s_waitcnt vmcnt(7)
    v_mfma_f32_16x16x32_bf16 v[48:51], v[64:67], v[84:87], v[48:51]
    v_mfma_f32_16x16x32_bf16 v[52:55], v[68:71], v[84:87], v[52:55]
    v_mfma_f32_16x16x32_bf16 v[56:59], v[72:75], v[84:87], v[56:59]
    v_mfma_f32_16x16x32_bf16 v[60:63], v[76:79], v[84:87], v[60:63]
    s_add_u32 s38, s23, 36864
    buffer_load_dwordx4 a[156:159], v2, s[4:7], s38 offen offset:3072
    s_waitcnt vmcnt(7)
    v_mfma_f32_16x16x32_bf16 v[48:51], v[128:131], v[88:91], v[48:51]
    v_mfma_f32_16x16x32_bf16 v[52:55], v[132:135], v[88:91], v[52:55]
    v_mfma_f32_16x16x32_bf16 v[56:59], v[136:139], v[88:91], v[56:59]
    v_mfma_f32_16x16x32_bf16 v[60:63], v[140:143], v[88:91], v[60:63]
    s_add_u32 s38, s23, 40960
    buffer_load_dwordx4 a[160:163], v2, s[4:7], s38 offen offset:0
    s_waitcnt vmcnt(7)
    v_mfma_f32_16x16x32_bf16 v[48:51], v[144:147], v[92:95], v[48:51]
    v_mfma_f32_16x16x32_bf16 v[52:55], v[148:151], v[92:95], v[52:55]
    v_mfma_f32_16x16x32_bf16 v[56:59], v[152:155], v[92:95], v[56:59]
    v_mfma_f32_16x16x32_bf16 v[60:63], v[156:159], v[92:95], v[60:63]
    s_add_u32 s38, s23, 40960
    buffer_load_dwordx4 a[164:167], v2, s[4:7], s38 offen offset:1024
    buffer_load_dword v12, v5, s[4:7], s49 offen offset:0 sc1
    s_waitcnt vmcnt(8)
    v_mfma_f32_16x16x32_bf16 v[40:43], v[212:215], v[184:187], 0
    v_mfma_f32_16x16x32_bf16 v[44:47], v[216:219], v[184:187], 0
    s_add_u32 s38, s23, 40960
    buffer_load_dwordx4 a[168:171], v2, s[4:7], s38 offen offset:2048
    s_waitcnt vmcnt(8)
    v_mfma_f32_16x16x32_bf16 v[40:43], v[72:75], v[188:191], v[40:43]
    v_mfma_f32_16x16x32_bf16 v[44:47], v[76:79], v[188:191], v[44:47]
    ds_write_b128 v9, v[48:51] offset:24576
    s_add_u32 s38, s23, 40960
    buffer_load_dwordx4 a[172:175], v2, s[4:7], s38 offen offset:3072
    s_waitcnt vmcnt(8)
    v_mfma_f32_16x16x32_bf16 v[40:43], v[136:139], v[192:195], v[40:43]
    v_mfma_f32_16x16x32_bf16 v[44:47], v[140:143], v[192:195], v[44:47]
    ds_write_b128 v9, v[52:55] offset:25600
    s_waitcnt vmcnt(7)
    v_mfma_f32_16x16x32_bf16 v[40:43], v[152:155], v[196:199], v[40:43]
    v_mfma_f32_16x16x32_bf16 v[44:47], v[156:159], v[196:199], v[44:47]
    ds_write_b128 v10, v[56:59] offset:24576
    v_mfma_f32_16x16x32_bf16 v[32:35], v[204:207], v[184:187], 0
    v_mfma_f32_16x16x32_bf16 v[36:39], v[208:211], v[184:187], 0
    ds_write_b128 v10, v[60:63] offset:25600
    v_mfma_f32_16x16x32_bf16 v[32:35], v[64:67], v[188:191], v[32:35]
    v_mfma_f32_16x16x32_bf16 v[36:39], v[68:71], v[188:191], v[36:39]
    v_mfma_f32_16x16x32_bf16 v[32:35], v[128:131], v[192:195], v[32:35]
    v_mfma_f32_16x16x32_bf16 v[36:39], v[132:135], v[192:195], v[36:39]
    ds_write_b128 v8, v[40:43] offset:24576
    v_mfma_f32_16x16x32_bf16 v[32:35], v[144:147], v[196:199], v[32:35]
    v_mfma_f32_16x16x32_bf16 v[36:39], v[148:151], v[196:199], v[36:39]
    ds_write_b128 v8, v[44:47] offset:25600
    v_cmp_u_f32 vcc, v48, v40
    s_nop 5
    s_cbranch_vccnz L_slow3_41
L_back3_42:
    s_waitcnt lgkmcnt(0)
    s_barrier
    ds_read_b128 v[160:163], v11 offset:24576
    ds_read_b128 v[164:167], v11 offset:25600
    ds_read_b128 v[168:171], v11 offset:26624
    ds_read_b128 v[172:175], v11 offset:27648
    ds_read_b128 v[176:179], v11 offset:28672
    ds_read_b128 v[180:183], v11 offset:29696
    v_pk_add_f32 v[32:33], v[32:33], v[24:25] op_sel:[0,0] op_sel_hi:[1,1]
    v_pk_add_f32 v[34:35], v[34:35], v[26:27] op_sel:[0,0] op_sel_hi:[1,1]
    v_pk_add_f32 v[36:37], v[36:37], v[28:29] op_sel:[0,0] op_sel_hi:[1,1]
    v_pk_add_f32 v[38:39], v[38:39], v[30:31] op_sel:[0,0] op_sel_hi:[1,1]
    s_waitcnt lgkmcnt(4)
    v_pk_add_f32 v[32:33], v[32:33], v[160:161] op_sel:[0,0] op_sel_hi:[1,1]
    v_pk_add_f32 v[34:35], v[34:35], v[162:163] op_sel:[0,0] op_sel_hi:[1,1]
    v_pk_add_f32 v[36:37], v[36:37], v[164:165] op_sel:[0,0] op_sel_hi:[1,1]
    v_pk_add_f32 v[38:39], v[38:39], v[166:167] op_sel:[0,0] op_sel_hi:[1,1]
    s_waitcnt lgkmcnt(2)
    v_pk_add_f32 v[32:33], v[32:33], v[168:169] op_sel:[0,0] op_sel_hi:[1,1]
    v_pk_add_f32 v[34:35], v[34:35], v[170:171] op_sel:[0,0] op_sel_hi:[1,1]
    v_pk_add_f32 v[36:37], v[36:37], v[172:173] op_sel:[0,0] op_sel_hi:[1,1]
    v_pk_add_f32 v[38:39], v[38:39], v[174:175] op_sel:[0,0] op_sel_hi:[1,1]
    s_waitcnt lgkmcnt(0)
    v_pk_add_f32 v[32:33], v[32:33], v[176:177] op_sel:[0,0] op_sel_hi:[1,1]
    v_pk_add_f32 v[34:35], v[34:35], v[178:179] op_sel:[0,0] op_sel_hi:[1,1]
    v_pk_add_f32 v[36:37], v[36:37], v[180:181] op_sel:[0,0] op_sel_hi:[1,1]
    v_pk_add_f32 v[38:39], v[38:39], v[182:183] op_sel:[0,0] op_sel_hi:[1,1]
    v_cvt_pk_bf16_f32 v20, v32, v33
    v_cvt_pk_bf16_f32 v21, v34, v35
    v_cvt_pk_bf16_f32 v22, v36, v37
    v_cvt_pk_bf16_f32 v23, v38, v39
    v_dot2_f32_bf16 v13, v20, v7, 0
    v_dot2_f32_bf16 v14, v20, v20, 0
    v_dot2_f32_bf16 v13, v21, v7, v13
    v_dot2_f32_bf16 v14, v21, v21, v14
    v_dot2_f32_bf16 v13, v22, v7, v13
    v_dot2_f32_bf16 v14, v22, v22, v14
    v_dot2_f32_bf16 v13, v23, v7, v13
    v_dot2_f32_bf16 v14, v23, v23, v14
    s_nop 2
    v_permlane32_swap_b32 v13, v14
    s_nop 0
    v_add_f32 v13, v13, v14
    v_mov_b32 v14, v13
    s_nop 1
    v_permlane16_swap_b32 v13, v14
    s_nop 0
    v_add_f32 v13, v13, v14
    s_waitcnt vmcnt(2)
    v_cmp_gt_u32 vcc, 1, v12
    s_cmp_eq_u64 vcc, 0
    s_nop 3
    s_cbranch_scc1 L_pok_43
    s_mov_b32 s39, 20000
L_poll_44:
    buffer_load_dword v12, v5, s[4:7], s49 offen offset:0 sc1
    s_waitcnt vmcnt(0)
    v_cmp_gt_u32 vcc, 1, v12
    s_sub_u32 s39, s39, 1
    s_nop 3
    s_cbranch_scc1 L_pollx_45
    s_cmp_lg_u64 vcc, 0
    s_cbranch_scc1 L_poll_44
L_pollx_45:
L_pok_43:
    s_add_u32 m0, s51, 0x0
    s_add_u32 s66, s50, 0x0
    buffer_load_dwordx4 v2, s[4:7], s66 offen offset:0 lds
    s_add_u32 m0, s51, 0x0
    s_add_u32 s66, s50, 0x0
    buffer_load_dwordx4 v2, s[4:7], s66 offen offset:1024 lds
    s_add_u32 m0, s51, 0x0
    s_add_u32 s66, s50, 0x0
    buffer_load_dwordx4 v2, s[4:7], s66 offen offset:2048 lds
    s_add_u32 m0, s51, 0x0
    s_add_u32 s66, s50, 0x0
    buffer_load_dwordx4 v2, s[4:7], s66 offen offset:3072 lds
    s_add_u32 m0, s51, 0x20000
    s_nop 0
    buffer_load_dwordx4 v2, s[4:7], s52 offen offset:0 lds
    s_add_u32 m0, s51, 0x20000
    s_nop 0
    buffer_load_dwordx4 v2, s[4:7], s52 offen offset:1024 lds
    buffer_store_dwordx4 v[20:23], v2, s[4:7], s46 offen sc1
    buffer_store_dword v13, v6, s[4:7], s47 offen sc1
    s_add_u32 s38, s23, 45056
    buffer_load_dwordx4 a[176:179], v2, s[4:7], s38 offen offset:0
    s_add_u32 s38, s23, 45056
    buffer_load_dwordx4 a[180:183], v2, s[4:7], s38 offen offset:1024
    v_mfma_f32_16x16x32_bf16 v[96:99], a[128:131], v[220:223], v[96:99]
    v_mfma_f32_16x16x32_bf16 v[100:103], a[132:135], v[220:223], v[100:103]
    v_mfma_f32_16x16x32_bf16 v[104:107], a[136:139], v[220:223], v[104:107]
    v_mfma_f32_16x16x32_bf16 v[108:111], a[140:143], v[220:223], v[108:111]
    v_mfma_f32_16x16x32_bf16 v[96:99], a[144:147], v[220:223], v[96:99]
    v_mfma_f32_16x16x32_bf16 v[100:103], a[148:151], v[220:223], v[100:103]
    v_mfma_f32_16x16x32_bf16 v[104:107], a[152:155], v[220:223], v[104:107]
    v_mfma_f32_16x16x32_bf16 v[108:111], a[156:159], v[220:223], v[108:111]
    v_mfma_f32_16x16x32_bf16 v[96:99], a[160:163], v[220:223], v[96:99]
    v_mfma_f32_16x16x32_bf16 v[100:103], a[164:167], v[220:223], v[100:103]
    s_waitcnt vmcnt(11)
    v_mfma_f32_16x16x32_bf16 v[104:107], a[168:171], v[220:223], v[104:107]
    s_waitcnt vmcnt(10)
    v_mfma_f32_16x16x32_bf16 v[108:111], a[172:175], v[220:223], v[108:111]
    v_add_u32 v3, 0x10000, v2
    v_bfe_u32 v4, v1, 4, 1
    v_lshlrev_b32 v4, 7, v4
    v_lshrrev_b32 v6, 5, v1
    v_lshl_add_u32 v4, v6, 6, v4
    v_add_u32 v4, v4, v5
    s_lshl_b32 s32, s3, 9
    s_add_u32 s32, s32, 0x20000
    v_add_u32 v4, s32, v4
    v_lshlrev_b32 v7, 2, v5
    v_add_u32 v7, 0x24000, v7
    s_lshl_b32 s32, s3, 8
    v_add_u32 v6, s32, v7
    v_mov_b32 v252, -1
    v_mov_b32 v253, -1
    v_mov_b32 v254, -1
    v_mov_b32 v255, -1
    v_add_u32 v11, s51, v2
    s_waitcnt vmcnt(4)
    s_barrier
    ds_read_b128 v[64:67], v2 offset:0
    ds_read_b128 v[68:71], v2 offset:1024
    ds_read_b128 v[72:75], v2 offset:2048
    ds_read_b128 v[76:79], v2 offset:3072
    s_waitcnt lgkmcnt(3)
    v_mfma_f32_16x16x32_bf16 v[32:35], a[0:3], v[64:67], 0
    ds_read_b128 v[80:83], v2 offset:4096
    s_add_u32 s38, s23, 45056
    buffer_load_dwordx4 a[184:187], v2, s[4:7], s38 offen offset:2048
    s_add_u32 s38, s23, 45056
    buffer_load_dwordx4 a[188:191], v2, s[4:7], s38 offen offset:3072
    v_mfma_f32_16x16x32_bf16 v[36:39], a[4:7], v[64:67], 0
    ds_read2st64_b32 v[88:89], v4 offset0:0 offset1:1
    ds_read2st64_b32 v[90:91], v4 offset0:16 offset1:17
    ds_read2st64_b32 v[92:93], v4 offset0:32 offset1:33
    ds_read2st64_b32 v[94:95], v4 offset0:48 offset1:49
    v_mfma_f32_16x16x32_bf16 v[40:43], a[8:11], v[64:67], 0
    v_mfma_f32_16x16x32_bf16 v[44:47], a[12:15], v[64:67], 0
    s_waitcnt lgkmcnt(7)
    v_mfma_f32_16x16x32_bf16 v[32:35], a[16:19], v[68:71], v[32:35]
    ds_read_b128 v[84:87], v2 offset:5120
    s_add_u32 m0, s51, 0x4000
    s_add_u32 s66, s50, 0x4000
    buffer_load_dwordx4 v2, s[4:7], s66 offen offset:0 lds
    s_add_u32 m0, s51, 0x4000
    s_add_u32 s66, s50, 0x4000
    buffer_load_dwordx4 v2, s[4:7], s66 offen offset:1024 lds
    v_mfma_f32_16x16x32_bf16 v[36:39], a[20:23], v[68:71], v[36:39]
    s_waitcnt lgkmcnt(1)
    v_add_f32 v88, v88, v89
    v_add_f32 v90, v90, v91
    v_mfma_f32_16x16x32_bf16 v[40:43], a[24:27], v[68:71], v[40:43]
    v_add_f32 v92, v92, v93
    v_add_f32 v94, v94, v95
    v_mfma_f32_16x16x32_bf16 v[44:47], a[28:31], v[68:71], v[44:47]
    v_add_f32 v88, v88, v90
    v_add_f32 v92, v92, v94
    v_mfma_f32_16x16x32_bf16 v[32:35], a[32:35], v[72:75], v[32:35]
    ds_read_b128 v[64:67], v2 offset:6144
    s_add_u32 m0, s51, 0x4000
    s_add_u32 s66, s50, 0x4000
    buffer_load_dwordx4 v2, s[4:7], s66 offen offset:2048 lds
    s_add_u32 m0, s51, 0x4000
    s_add_u32 s66, s50, 0x4000
    buffer_load_dwordx4 v2, s[4:7], s66 offen offset:3072 lds
    v_mfma_f32_16x16x32_bf16 v[36:39], a[36:39], v[72:75], v[36:39]
    v_add_f32 v88, v88, v92
    v_mov_b32 v89, v88
    v_mfma_f32_16x16x32_bf16 v[40:43], a[40:43], v[72:75], v[40:43]
    s_nop 0
    v_permlane16_swap_b32 v88, v89
    v_mfma_f32_16x16x32_bf16 v[44:47], a[44:47], v[72:75], v[44:47]
    v_add_f32 v88, v88, v89
    v_mov_b32 v89, v88
    v_mfma_f32_16x16x32_bf16 v[32:35], a[48:51], v[76:79], v[32:35]
    ds_read_b128 v[68:71], v2 offset:7168
    s_add_u32 s38, s23, 49152
    buffer_load_dwordx4 a[192:195], v2, s[4:7], s38 offen offset:0
    s_add_u32 s38, s23, 49152
    buffer_load_dwordx4 a[196:199], v2, s[4:7], s38 offen offset:1024
    v_mfma_f32_16x16x32_bf16 v[36:39], a[52:55], v[76:79], v[36:39]
    v_permlane32_swap_b32 v88, v89
    v_mfma_f32_16x16x32_bf16 v[40:43], a[56:59], v[76:79], v[40:43]
    v_mul_f32 v92, 0xbb000000, v88
    v_mul_f32 v94, 0x3b000000, v89
    v_mfma_f32_16x16x32_bf16 v[44:47], a[60:63], v[76:79], v[44:47]
    v_add_f32 v94, 0x3727c5ac, v94
    v_fma_f32 v94, -v92, v92, v94
    v_mfma_f32_16x16x32_bf16 v[32:35], a[64:67], v[80:83], v[32:35]
    ds_read_b128 v[72:75], v2 offset:8192
    s_add_u32 s38, s23, 49152
    buffer_load_dwordx4 a[200:203], v2, s[4:7], s38 offen offset:2048
    s_add_u32 s38, s23, 49152
    buffer_load_dwordx4 a[204:207], v2, s[4:7], s38 offen offset:3072
    v_mfma_f32_16x16x32_bf16 v[36:39], a[68:71], v[80:83], v[36:39]
    v_rsq_f32 v93, v94
    v_mfma_f32_16x16x32_bf16 v[40:43], a[72:75], v[80:83], v[40:43]
    v_mul_f32 v93, 0xbfb8aa3b, v93
    ds_write_b96 v6, v[92:94] offset:0
    v_mfma_f32_16x16x32_bf16 v[44:47], a[76:79], v[80:83], v[44:47]
    s_waitcnt lgkmcnt(4)
    v_mfma_f32_16x16x32_bf16 v[32:35], a[80:83], v[84:87], v[32:35]
    ds_read_b128 v[76:79], v2 offset:9216
    s_add_u32 s38, s23, 53248
    buffer_load_dwordx4 a[208:211], v2, s[4:7], s38 offen offset:0
    s_add_u32 s38, s23, 53248
    buffer_load_dwordx4 a[212:215], v2, s[4:7], s38 offen offset:1024
    v_mfma_f32_16x16x32_bf16 v[36:39], a[84:87], v[84:87], v[36:39]
    v_mfma_f32_16x16x32_bf16 v[40:43], a[88:91], v[84:87], v[40:43]
    v_mfma_f32_16x16x32_bf16 v[44:47], a[92:95], v[84:87], v[44:47]
    s_waitcnt lgkmcnt(4)
    v_mfma_f32_16x16x32_bf16 v[32:35], a[96:99], v[64:67], v[32:35]
    ds_read_b128 v[80:83], v2 offset:10240
    s_add_u32 s38, s23, 53248
    buffer_load_dwordx4 a[216:219], v2, s[4:7], s38 offen offset:2048
    s_add_u32 s38, s23, 53248
    buffer_load_dwordx4 a[220:223], v2, s[4:7], s38 offen offset:3072
    v_mfma_f32_16x16x32_bf16 v[36:39], a[100:103], v[64:67], v[36:39]
    v_mfma_f32_16x16x32_bf16 v[40:43], a[104:107], v[64:67], v[40:43]
    v_mfma_f32_16x16x32_bf16 v[44:47], a[108:111], v[64:67], v[44:47]
    s_waitcnt lgkmcnt(4)
    v_mfma_f32_16x16x32_bf16 v[32:35], a[112:115], v[68:71], v[32:35]
    ds_read_b128 v[84:87], v2 offset:11264
    s_waitcnt vmcnt(16)
    v_mov_b32 v15, 2
    s_mov_b64 exec, 1
    buffer_store_dword v15, off, s[4:7], s48 offset:0 sc1
    s_mov_b64 exec, -1
    s_add_u32 s38, s23, 57344
    buffer_load_dwordx4 a[224:227], v2, s[4:7], s38 offen offset:0
    s_add_u32 s38, s23, 57344
    buffer_load_dwordx4 a[228:231], v2, s[4:7], s38 offen offset:1024
    v_mfma_f32_16x16x32_bf16 v[36:39], a[116:119], v[68:71], v[36:39]
    v_mfma_f32_16x16x32_bf16 v[40:43], a[120:123], v[68:71], v[40:43]
    v_mfma_f32_16x16x32_bf16 v[44:47], a[124:127], v[68:71], v[44:47]
    s_waitcnt lgkmcnt(4)
    v_mfma_f32_16x16x32_bf16 v[32:35], a[128:131], v[72:75], v[32:35]
    ds_read_b128 v[64:67], v2 offset:12288
    s_add_u32 s38, s23, 57344
    buffer_load_dwordx4 a[232:235], v2, s[4:7], s38 offen offset:2048
    s_add_u32 s38, s23, 57344
    buffer_load_dwordx4 a[236:239], v2, s[4:7], s38 offen offset:3072
    v_mfma_f32_16x16x32_bf16 v[36:39], a[132:135], v[72:75], v[36:39]
    v_mfma_f32_16x16x32_bf16 v[40:43], a[136:139], v[72:75], v[40:43]
    v_mfma_f32_16x16x32_bf16 v[44:47], a[140:143], v[72:75], v[44:47]
    s_waitcnt lgkmcnt(3)
    v_mfma_f32_16x16x32_bf16 v[32:35], a[144:147], v[76:79], v[32:35]
    ds_read_b128 v[68:71], v2 offset:13312
    s_add_u32 s38, s23, 61440
    buffer_load_dwordx4 a[240:243], v2, s[4:7], s38 offen offset:0
    s_add_u32 s38, s23, 61440
    buffer_load_dwordx4 a[244:247], v2, s[4:7], s38 offen offset:1024
    v_mfma_f32_16x16x32_bf16 v[36:39], a[148:151], v[76:79], v[36:39]
    v_mfma_f32_16x16x32_bf16 v[40:43], a[152:155], v[76:79], v[40:43]
    v_mfma_f32_16x16x32_bf16 v[44:47], a[156:159], v[76:79], v[44:47]
    s_waitcnt lgkmcnt(3)
    v_mfma_f32_16x16x32_bf16 v[32:35], a[160:163], v[80:83], v[32:35]
    ds_read_b128 v[72:75], v2 offset:14336
    s_add_u32 s38, s23, 61440
    buffer_load_dwordx4 a[248:251], v2, s[4:7], s38 offen offset:2048
    s_add_u32 s38, s23, 61440
    buffer_load_dwordx4 a[252:255], v2, s[4:7], s38 offen offset:3072
    v_mfma_f32_16x16x32_bf16 v[36:39], a[164:167], v[80:83], v[36:39]
    v_mfma_f32_16x16x32_bf16 v[40:43], a[168:171], v[80:83], v[40:43]
    v_mfma_f32_16x16x32_bf16 v[44:47], a[172:175], v[80:83], v[44:47]
    s_waitcnt lgkmcnt(3)
    s_waitcnt vmcnt(24)
    v_mfma_f32_16x16x32_bf16 v[32:35], a[176:179], v[84:87], v[32:35]
    v_mfma_f32_16x16x32_bf16 v[96:99], a[176:179], v[220:223], v[96:99]
    ds_read_b128 v[76:79], v2 offset:15360
    s_add_u32 m0, s51, 0x8000
    s_add_u32 s66, s50, 0x8000
    buffer_load_dwordx4 v2, s[4:7], s66 offen offset:0 lds
    s_add_u32 m0, s51, 0x8000
    s_add_u32 s66, s50, 0x8000
    buffer_load_dwordx4 v2, s[4:7], s66 offen offset:1024 lds
    s_waitcnt vmcnt(25)
    v_mfma_f32_16x16x32_bf16 v[36:39], a[180:183], v[84:87], v[36:39]
    v_mfma_f32_16x16x32_bf16 v[100:103], a[180:183], v[220:223], v[100:103]
    s_waitcnt vmcnt(24)
    v_mfma_f32_16x16x32_bf16 v[40:43], a[184:187], v[84:87], v[40:43]
    v_mfma_f32_16x16x32_bf16 v[104:107], a[184:187], v[220:223], v[104:107]
    s_waitcnt vmcnt(23)
    v_mfma_f32_16x16x32_bf16 v[44:47], a[188:191], v[84:87], v[44:47]
    v_mfma_f32_16x16x32_bf16 v[108:111], a[188:191], v[220:223], v[108:111]
    s_waitcnt lgkmcnt(3)
    s_waitcnt vmcnt(18)
    v_mfma_f32_16x16x32_bf16 v[32:35], a[192:195], v[64:67], v[32:35]
    v_mfma_f32_16x16x32_bf16 v[96:99], a[192:195], v[220:223], v[96:99]
    s_barrier
    ds_read_b128 v[80:83], v2 offset:16384
    s_add_u32 m0, s51, 0x8000
    s_add_u32 s66, s50, 0x8000
    buffer_load_dwordx4 v2, s[4:7], s66 offen offset:2048 lds
    s_add_u32 m0, s51, 0x8000
    s_add_u32 s66, s50, 0x8000
    buffer_load_dwordx4 v2, s[4:7], s66 offen offset:3072 lds
    s_waitcnt vmcnt(19)
    v_mfma_f32_16x16x32_bf16 v[36:39], a[196:199], v[64:67], v[36:39]
    v_mfma_f32_16x16x32_bf16 v[100:103], a[196:199], v[220:223], v[100:103]
    s_waitcnt vmcnt(18)
    v_mfma_f32_16x16x32_bf16 v[40:43], a[200:203], v[64:67], v[40:43]
    v_mfma_f32_16x16x32_bf16 v[104:107], a[200:203], v[220:223], v[104:107]
    s_waitcnt vmcnt(17)
    v_mfma_f32_16x16x32_bf16 v[44:47], a[204:207], v[64:67], v[44:47]
    v_mfma_f32_16x16x32_bf16 v[108:111], a[204:207], v[220:223], v[108:111]
    s_waitcnt lgkmcnt(3)
    s_waitcnt vmcnt(16)
    v_mfma_f32_16x16x32_bf16 v[32:35], a[208:211], v[68:71], v[32:35]
    v_mfma_f32_16x16x32_bf16 v[96:99], a[208:211], v[220:223], v[96:99]
    ds_read_b128 v[84:87], v2 offset:17408
    s_add_u32 m0, s51, 0xc000
    s_add_u32 s66, s50, 0xc000
    buffer_load_dwordx4 v2, s[4:7], s66 offen offset:0 lds
    s_add_u32 m0, s51, 0xc000
    s_add_u32 s66, s50, 0xc000
    buffer_load_dwordx4 v2, s[4:7], s66 offen offset:1024 lds
    ds_read_b96 v[8:10], v7 offset:0
    s_waitcnt vmcnt(17)
    v_mfma_f32_16x16x32_bf16 v[36:39], a[212:215], v[68:71], v[36:39]
    v_mfma_f32_16x16x32_bf16 v[100:103], a[212:215], v[220:223], v[100:103]
    s_waitcnt vmcnt(16)
    v_mfma_f32_16x16x32_bf16 v[40:43], a[216:219], v[68:71], v[40:43]
    v_mfma_f32_16x16x32_bf16 v[104:107], a[216:219], v[220:223], v[104:107]
    s_waitcnt vmcnt(15)
    v_mfma_f32_16x16x32_bf16 v[44:47], a[220:223], v[68:71], v[44:47]
    v_mfma_f32_16x16x32_bf16 v[108:111], a[220:223], v[220:223], v[108:111]
    s_waitcnt lgkmcnt(4)
    s_waitcnt vmcnt(13)
    v_mfma_f32_16x16x32_bf16 v[32:35], a[224:227], v[72:75], v[32:35]
    v_mfma_f32_16x16x32_bf16 v[96:99], a[224:227], v[220:223], v[96:99]
    ds_read_b128 v[64:67], v2 offset:18432
    s_add_u32 m0, s51, 0xc000
    s_add_u32 s66, s50, 0xc000
    buffer_load_dwordx4 v2, s[4:7], s66 offen offset:2048 lds
    s_add_u32 m0, s51, 0xc000
    s_add_u32 s66, s50, 0xc000
    buffer_load_dwordx4 v2, s[4:7], s66 offen offset:3072 lds
    s_waitcnt vmcnt(14)
    v_mfma_f32_16x16x32_bf16 v[36:39], a[228:231], v[72:75], v[36:39]
    v_mfma_f32_16x16x32_bf16 v[100:103], a[228:231], v[220:223], v[100:103]
    s_waitcnt vmcnt(13)
    v_mfma_f32_16x16x32_bf16 v[40:43], a[232:235], v[72:75], v[40:43]
    v_mfma_f32_16x16x32_bf16 v[104:107], a[232:235], v[220:223], v[104:107]
    s_waitcnt vmcnt(12)
    v_mfma_f32_16x16x32_bf16 v[44:47], a[236:239], v[72:75], v[44:47]
    v_mfma_f32_16x16x32_bf16 v[108:111], a[236:239], v[220:223], v[108:111]
    s_waitcnt lgkmcnt(4)
    s_waitcnt vmcnt(11)
    v_mfma_f32_16x16x32_bf16 v[32:35], a[240:243], v[76:79], v[32:35]
    v_mfma_f32_16x16x32_bf16 v[96:99], a[240:243], v[220:223], v[96:99]
    ds_read_b128 v[68:71], v2 offset:19456
    s_waitcnt vmcnt(10)
    v_mfma_f32_16x16x32_bf16 v[36:39], a[244:247], v[76:79], v[36:39]
    v_mfma_f32_16x16x32_bf16 v[100:103], a[244:247], v[220:223], v[100:103]
    s_waitcnt vmcnt(9)
    v_mfma_f32_16x16x32_bf16 v[40:43], a[248:251], v[76:79], v[40:43]
    v_mfma_f32_16x16x32_bf16 v[104:107], a[248:251], v[220:223], v[104:107]
    s_waitcnt vmcnt(8)
    v_mfma_f32_16x16x32_bf16 v[44:47], a[252:255], v[76:79], v[44:47]
    v_mfma_f32_16x16x32_bf16 v[108:111], a[252:255], v[220:223], v[108:111]
    s_waitcnt lgkmcnt(4)
    v_mfma_f32_16x16x32_bf16 v[48:51], a[0:3], v[80:83], 0
    ds_read_b128 v[72:75], v2 offset:20480
    buffer_load_dword v0, v5, s[4:7], s49 offen offset:0 sc1
    v_mfma_f32_16x16x32_bf16 v[52:55], a[4:7], v[80:83], 0
    v_mfma_f32_16x16x32_bf16 v[56:59], a[8:11], v[80:83], 0
    s_waitcnt lgkmcnt(3)
    v_cmp_u_f32 vcc, v32, v10
    s_nop 5
    s_cbranch_vccnz L_slow4_46
L_back4_47:
    v_fma_f32 v32, v96, v8, v32
    v_fma_f32 v33, v97, v8, v33
    v_mfma_f32_16x16x32_bf16 v[60:63], a[12:15], v[80:83], 0
    v_fma_f32 v34, v98, v8, v34
    v_fma_f32 v35, v99, v8, v35
    v_mfma_f32_16x16x32_bf16 v[48:51], a[16:19], v[84:87], v[48:51]
    ds_read_b128 v[76:79], v2 offset:21504
    s_add_u32 s66, s56, 0x0
    buffer_load_dwordx4 v[112:115], v2, s[4:7], s66 offen offset:0
    v_mfma_f32_16x16x32_bf16 v[52:55], a[20:23], v[84:87], v[52:55]
    v_fma_f32 v36, v100, v8, v36
    v_fma_f32 v37, v101, v8, v37
    v_mfma_f32_16x16x32_bf16 v[56:59], a[24:27], v[84:87], v[56:59]
    v_fma_f32 v38, v102, v8, v38
    v_fma_f32 v39, v103, v8, v39
    v_mfma_f32_16x16x32_bf16 v[60:63], a[28:31], v[84:87], v[60:63]
    v_mul_f32 v24, v32, v9
    v_mul_f32 v25, v33, v9
    s_waitcnt lgkmcnt(3)
    v_mfma_f32_16x16x32_bf16 v[48:51], a[32:35], v[64:67], v[48:51]
    ds_read_b128 v[80:83], v2 offset:22528
    s_add_u32 s66, s56, 0x0
    buffer_load_dwordx4 v[116:119], v2, s[4:7], s66 offen offset:1024
    v_mfma_f32_16x16x32_bf16 v[52:55], a[36:39], v[64:67], v[52:55]
    v_mul_f32 v26, v34, v9
    v_mul_f32 v27, v35, v9
    v_mfma_f32_16x16x32_bf16 v[56:59], a[40:43], v[64:67], v[56:59]
    v_mul_f32 v28, v36, v9
    v_mul_f32 v29, v37, v9
    v_mfma_f32_16x16x32_bf16 v[60:63], a[44:47], v[64:67], v[60:63]
    v_mul_f32 v30, v38, v9
    v_mul_f32 v31, v39, v9
    s_waitcnt lgkmcnt(3)
    v_mfma_f32_16x16x32_bf16 v[48:51], a[48:51], v[68:71], v[48:51]
    ds_read_b128 v[84:87], v2 offset:23552
    s_add_u32 s66, s56, 0x0
    buffer_load_dwordx4 v[120:123], v2, s[4:7], s66 offen offset:2048
    v_mfma_f32_16x16x32_bf16 v[52:55], a[52:55], v[68:71], v[52:55]
    v_exp_f32 v24, v24
    v_mfma_f32_16x16x32_bf16 v[56:59], a[56:59], v[68:71], v[56:59]
    v_exp_f32 v25, v25
    v_mfma_f32_16x16x32_bf16 v[60:63], a[60:63], v[68:71], v[60:63]
    v_exp_f32 v26, v26
    s_waitcnt lgkmcnt(3)
    v_mfma_f32_16x16x32_bf16 v[48:51], a[64:67], v[72:75], v[48:51]
    ds_read_b128 v[64:67], v2 offset:24576
    s_add_u32 s66, s53, 0x46000
    buffer_store_dwordx4 v[252:255], v2, s[4:7], s66 offen sc1
    s_add_u32 s66, s53, 0x54000
    buffer_store_dwordx4 v[252:255], v2, s[4:7], s66 offen sc1
    s_add_u32 s66, s53, 0x62000
    buffer_store_dwordx4 v[252:255], v2, s[4:7], s66 offen sc1
    s_add_u32 s66, s56, 0x0
    buffer_load_dwordx4 v[124:127], v2, s[4:7], s66 offen offset:3072
    v_mfma_f32_16x16x32_bf16 v[52:55], a[68:71], v[72:75], v[52:55]
    v_exp_f32 v27, v27
    v_mfma_f32_16x16x32_bf16 v[56:59], a[72:75], v[72:75], v[56:59]
    v_exp_f32 v28, v28
    v_mfma_f32_16x16x32_bf16 v[60:63], a[76:79], v[72:75], v[60:63]
    v_exp_f32 v29, v29
    s_waitcnt lgkmcnt(3)
    v_mfma_f32_16x16x32_bf16 v[48:51], a[80:83], v[76:79], v[48:51]
    ds_read_b128 v[68:71], v2 offset:25600
    s_add_u32 s66, s56, 0x1000
    buffer_load_dwordx4 v[128:131], v2, s[4:7], s66 offen offset:0
    v_mfma_f32_16x16x32_bf16 v[52:55], a[84:87], v[76:79], v[52:55]
    v_exp_f32 v30, v30
    v_mfma_f32_16x16x32_bf16 v[56:59], a[88:91], v[76:79], v[56:59]
    v_exp_f32 v31, v31
    v_mfma_f32_16x16x32_bf16 v[60:63], a[92:95], v[76:79], v[60:63]
    v_fma_f32 v40, v104, v8, v40
    v_fma_f32 v41, v105, v8, v41
    s_waitcnt lgkmcnt(3)
    v_mfma_f32_16x16x32_bf16 v[48:51], a[96:99], v[80:83], v[48:51]
    ds_read_b128 v[72:75], v2 offset:26624
    s_add_u32 s66, s56, 0x1000
    buffer_load_dwordx4 v[132:135], v2, s[4:7], s66 offen offset:1024
    v_mfma_f32_16x16x32_bf16 v[52:55], a[100:103], v[80:83], v[52:55]
    v_fma_f32 v42, v106, v8, v42
    v_fma_f32 v43, v107, v8, v43
    v_mfma_f32_16x16x32_bf16 v[56:59], a[104:107], v[80:83], v[56:59]
    v_fma_f32 v44, v108, v8, v44
    v_fma_f32 v45, v109, v8, v45
    v_mfma_f32_16x16x32_bf16 v[60:63], a[108:111], v[80:83], v[60:63]
    v_fma_f32 v46, v110, v8, v46
    v_fma_f32 v47, v111, v8, v47
    s_waitcnt lgkmcnt(3)
    v_mfma_f32_16x16x32_bf16 v[48:51], a[112:115], v[84:87], v[48:51]
    ds_read_b128 v[76:79], v2 offset:27648
    s_add_u32 s66, s56, 0x1000
    buffer_load_dwordx4 v[136:139], v2, s[4:7], s66 offen offset:2048
    v_mfma_f32_16x16x32_bf16 v[52:55], a[116:119], v[84:87], v[52:55]
    v_fma_f32 v24, v24, v10, v10
    v_fma_f32 v25, v25, v10, v10
    v_mfma_f32_16x16x32_bf16 v[56:59], a[120:123], v[84:87], v[56:59]
    v_fma_f32 v26, v26, v10, v10
    v_fma_f32 v27, v27, v10, v10
    v_mfma_f32_16x16x32_bf16 v[60:63], a[124:127], v[84:87], v[60:63]
    v_fma_f32 v28, v28, v10, v10
    v_fma_f32 v29, v29, v10, v10
    s_waitcnt lgkmcnt(3)
    v_mfma_f32_16x16x32_bf16 v[48:51], a[128:131], v[64:67], v[48:51]
    ds_read_b128 v[80:83], v2 offset:28672
    s_add_u32 s66, s56, 0x1000
    buffer_load_dwordx4 v[140:143], v2, s[4:7], s66 offen offset:3072
    v_mfma_f32_16x16x32_bf16 v[52:55], a[132:135], v[64:67], v[52:55]
    v_fma_f32 v30, v30, v10, v10
    v_fma_f32 v31, v31, v10, v10
    v_mfma_f32_16x16x32_bf16 v[56:59], a[136:139], v[64:67], v[56:59]
    v_rcp_f32 v24, v24
    v_mfma_f32_16x16x32_bf16 v[60:63], a[140:143], v[64:67], v[60:63]
    v_rcp_f32 v25, v25
    s_waitcnt lgkmcnt(3)
    v_mfma_f32_16x16x32_bf16 v[48:51], a[144:147], v[68:71], v[48:51]
    ds_read_b128 v[84:87], v2 offset:29696
    s_add_u32 s66, s56, 0x2000
    buffer_load_dwordx4 v[144:147], v2, s[4:7], s66 offen offset:0
    v_mfma_f32_16x16x32_bf16 v[52:55], a[148:151], v[68:71], v[52:55]
    v_rcp_f32 v26, v26
    v_mfma_f32_16x16x32_bf16 v[56:59], a[152:155], v[68:71], v[56:59]
    v_rcp_f32 v27, v27
    v_mfma_f32_16x16x32_bf16 v[60:63], a[156:159], v[68:71], v[60:63]
    v_rcp_f32 v28, v28
    s_waitcnt lgkmcnt(3)
    v_mfma_f32_16x16x32_bf16 v[48:51], a[160:163], v[72:75], v[48:51]
    ds_read_b128 v[64:67], v2 offset:30720
    s_add_u32 s66, s56, 0x2000
    buffer_load_dwordx4 v[148:151], v2, s[4:7], s66 offen offset:1024
    v_mfma_f32_16x16x32_bf16 v[52:55], a[164:167], v[72:75], v[52:55]
    v_rcp_f32 v29, v29
    v_mfma_f32_16x16x32_bf16 v[56:59], a[168:171], v[72:75], v[56:59]
    v_rcp_f32 v30, v30
    v_mfma_f32_16x16x32_bf16 v[60:63], a[172:175], v[72:75], v[60:63]
    v_rcp_f32 v31, v31
    s_waitcnt lgkmcnt(3)
    v_mfma_f32_16x16x32_bf16 v[48:51], a[176:179], v[76:79], v[48:51]
    ds_read_b128 v[68:71], v2 offset:31744
    s_add_u32 s66, s56, 0x2000
    buffer_load_dwordx4 v[152:155], v2, s[4:7], s66 offen offset:2048
    v_mfma_f32_16x16x32_bf16 v[52:55], a[180:183], v[76:79], v[52:55]
    v_mul_f32 v32, v32, v40
    v_mul_f32 v33, v33, v41
    v_mfma_f32_16x16x32_bf16 v[56:59], a[184:187], v[76:79], v[56:59]
    v_mul_f32 v34, v34, v42
    v_mul_f32 v35, v35, v43
    v_mfma_f32_16x16x32_bf16 v[60:63], a[188:191], v[76:79], v[60:63]
    v_mul_f32 v36, v36, v44
    v_mul_f32 v37, v37, v45
    s_waitcnt lgkmcnt(3)
    v_mfma_f32_16x16x32_bf16 v[48:51], a[192:195], v[80:83], v[48:51]
    s_waitcnt vmcnt(19)
    s_barrier
    ds_read_b128 v[72:75], v2 offset:32768
    s_waitcnt vmcnt(14)
    v_cmp_gt_u32 vcc, 2, v0
    s_cmp_eq_u64 vcc, 0
    s_nop 3
    s_cbranch_scc1 L_pok_49
    s_mov_b32 s39, 20000
L_poll_50:
    buffer_load_dword v0, v5, s[4:7], s49 offen offset:0 sc1
    s_waitcnt vmcnt(0)
    v_cmp_gt_u32 vcc, 2, v0
    s_sub_u32 s39, s39, 1
    s_nop 3
    s_cbranch_scc1 L_pollx_51
    s_cmp_lg_u64 vcc, 0
    s_cbranch_scc1 L_poll_50
L_pollx_51:
L_pok_49:
    s_add_u32 m0, s51, 0x10000
    s_add_u32 s66, s50, 0x10000
    buffer_load_dwordx4 v2, s[4:7], s66 offen offset:0 lds
    v_mfma_f32_16x16x32_bf16 v[52:55], a[196:199], v[80:83], v[52:55]
    v_mul_f32 v38, v38, v46
    v_mul_f32 v39, v39, v47
    v_mfma_f32_16x16x32_bf16 v[56:59], a[200:203], v[80:83], v[56:59]
    v_mul_f32 v32, v32, v24
    v_mul_f32 v33, v33, v25
    v_mfma_f32_16x16x32_bf16 v[60:63], a[204:207], v[80:83], v[60:63]
    v_mul_f32 v34, v34, v26
    v_mul_f32 v35, v35, v27
    s_waitcnt lgkmcnt(3)
    v_mfma_f32_16x16x32_bf16 v[48:51], a[208:211], v[84:87], v[48:51]
    ds_read_b128 v[76:79], v2 offset:33792
    s_add_u32 m0, s51, 0x10000
    s_add_u32 s66, s50, 0x10000
    buffer_load_dwordx4 v2, s[4:7], s66 offen offset:1024 lds
    ds_read_b96 v[12:14], v7 offset:256
    v_mfma_f32_16x16x32_bf16 v[52:55], a[212:215], v[84:87], v[52:55]
    v_mul_f32 v36, v36, v28
    v_mul_f32 v37, v37, v29
    v_mfma_f32_16x16x32_bf16 v[56:59], a[216:219], v[84:87], v[56:59]
    v_mul_f32 v38, v38, v30
    v_mul_f32 v39, v39, v31
    v_mfma_f32_16x16x32_bf16 v[60:63], a[220:223], v[84:87], v[60:63]
    v_cvt_pk_bf16_f32 v40, v32, v33
    v_cvt_pk_bf16_f32 v41, v34, v35
    s_waitcnt lgkmcnt(4)
    v_mfma_f32_16x16x32_bf16 v[48:51], a[224:227], v[64:67], v[48:51]
    ds_read_b128 v[80:83], v2 offset:34816
    s_add_u32 m0, s51, 0x10000
    s_add_u32 s66, s50, 0x10000
    buffer_load_dwordx4 v2, s[4:7], s66 offen offset:2048 lds
    v_mfma_f32_16x16x32_bf16 v[52:55], a[228:231], v[64:67], v[52:55]
    v_cvt_pk_bf16_f32 v42, v36, v37
    v_cvt_pk_bf16_f32 v43, v38, v39
    s_add_u32 s66, s53, 0x0
    buffer_store_dwordx4 v[40:43], v2, s[4:7], s66 offen sc1
    v_mfma_f32_16x16x32_bf16 v[56:59], a[232:235], v[64:67], v[56:59]
    v_mfma_f32_16x16x32_bf16 v[60:63], a[236:239], v[64:67], v[60:63]
    s_waitcnt lgkmcnt(4)
    v_mfma_f32_16x16x32_bf16 v[48:51], a[240:243], v[68:71], v[48:51]
    ds_read_b128 v[84:87], v2 offset:35840
    s_add_u32 m0, s51, 0x10000
    s_add_u32 s66, s50, 0x10000
    buffer_load_dwordx4 v2, s[4:7], s66 offen offset:3072 lds
    v_mfma_f32_16x16x32_bf16 v[52:55], a[244:247], v[68:71], v[52:55]
    v_mfma_f32_16x16x32_bf16 v[56:59], a[248:251], v[68:71], v[56:59]
    v_mfma_f32_16x16x32_bf16 v[60:63], a[252:255], v[68:71], v[60:63]
    s_waitcnt lgkmcnt(4)
    v_mfma_f32_16x16x32_bf16 v[32:35], a[0:3], v[72:75], 0
    ds_read_b128 v[64:67], v2 offset:36864
    s_add_u32 m0, s51, 0x20000
    s_nop 0
    buffer_load_dwordx4 v2, s[4:7], s52 offen offset:2048 lds
    v_mfma_f32_16x16x32_bf16 v[36:39], a[4:7], v[72:75], 0
    v_mfma_f32_16x16x32_bf16 v[40:43], a[8:11], v[72:75], 0
    s_waitcnt lgkmcnt(3)
    v_cmp_u_f32 vcc, v48, v14
    s_nop 5
    s_cbranch_vccnz L_slow4_52
L_back4_53:
    v_fma_f32 v48, v96, v12, v48
    v_fma_f32 v49, v97, v12, v49
    v_mfma_f32_16x16x32_bf16 v[44:47], a[12:15], v[72:75], 0
    v_fma_f32 v50, v98, v12, v50
    v_fma_f32 v51, v99, v12, v51
    v_mfma_f32_16x16x32_bf16 v[32:35], a[16:19], v[76:79], v[32:35]
    ds_read_b128 v[68:71], v2 offset:37888
    s_add_u32 m0, s51, 0x20000
    s_nop 0
    buffer_load_dwordx4 v2, s[4:7], s52 offen offset:3072 lds
    v_mfma_f32_16x16x32_bf16 v[36:39], a[20:23], v[76:79], v[36:39]
    v_fma_f32 v52, v100, v12, v52
    v_fma_f32 v53, v101, v12, v53
    v_mfma_f32_16x16x32_bf16 v[40:43], a[24:27], v[76:79], v[40:43]
    v_fma_f32 v54, v102, v12, v54
    v_fma_f32 v55, v103, v12, v55
    v_mfma_f32_16x16x32_bf16 v[44:47], a[28:31], v[76:79], v[44:47]
    v_mul_f32 v24, v48, v13
    v_mul_f32 v25, v49, v13
    s_waitcnt lgkmcnt(3)
    v_mfma_f32_16x16x32_bf16 v[32:35], a[32:35], v[80:83], v[32:35]
    ds_read_b128 v[72:75], v2 offset:38912
    s_add_u32 m0, s51, 0x14000
    s_add_u32 s66, s50, 0x14000
    buffer_load_dwordx4 v2, s[4:7], s66 offen offset:0 lds
    v_mfma_f32_16x16x32_bf16 v[36:39], a[36:39], v[80:83], v[36:39]
    v_mul_f32 v26, v50, v13
    v_mul_f32 v27, v51, v13
    v_mfma_f32_16x16x32_bf16 v[40:43], a[40:43], v[80:83], v[40:43]
    v_mul_f32 v28, v52, v13
    v_mul_f32 v29, v53, v13
    v_mfma_f32_16x16x32_bf16 v[44:47], a[44:47], v[80:83], v[44:47]
    v_mul_f32 v30, v54, v13
    v_mul_f32 v31, v55, v13
    s_waitcnt lgkmcnt(3)
    v_mfma_f32_16x16x32_bf16 v[32:35], a[48:51], v[84:87], v[32:35]
    ds_read_b128 v[76:79], v2 offset:39936
    s_add_u32 m0, s51, 0x14000
    s_add_u32 s66, s50, 0x14000
    buffer_load_dwordx4 v2, s[4:7], s66 offen offset:1024 lds
    v_mfma_f32_16x16x32_bf16 v[36:39], a[52:55], v[84:87], v[36:39]
    v_exp_f32 v24, v24
    v_mfma_f32_16x16x32_bf16 v[40:43], a[56:59], v[84:87], v[40:43]
    v_exp_f32 v25, v25
    v_mfma_f32_16x16x32_bf16 v[44:47], a[60:63], v[84:87], v[44:47]
    v_exp_f32 v26, v26
    s_waitcnt lgkmcnt(3)
    v_mfma_f32_16x16x32_bf16 v[32:35], a[64:67], v[64:67], v[32:35]
    ds_read_b128 v[80:83], v2 offset:40960
    s_add_u32 m0, s51, 0x14000
    s_add_u32 s66, s50, 0x14000
    buffer_load_dwordx4 v2, s[4:7], s66 offen offset:2048 lds
    v_mfma_f32_16x16x32_bf16 v[36:39], a[68:71], v[64:67], v[36:39]
    v_exp_f32 v27, v27
    v_mfma_f32_16x16x32_bf16 v[40:43], a[72:75], v[64:67], v[40:43]
    v_exp_f32 v28, v28
    v_mfma_f32_16x16x32_bf16 v[44:47], a[76:79], v[64:67], v[44:47]
    v_exp_f32 v29, v29
    s_waitcnt lgkmcnt(3)
    v_mfma_f32_16x16x32_bf16 v[32:35], a[80:83], v[68:71], v[32:35]
    ds_read_b128 v[84:87], v2 offset:41984
    s_add_u32 m0, s51, 0x14000
    s_add_u32 s66, s50, 0x14000
    buffer_load_dwordx4 v2, s[4:7], s66 offen offset:3072 lds
    v_mfma_f32_16x16x32_bf16 v[36:39], a[84:87], v[68:71], v[36:39]
    v_exp_f32 v30, v30
    v_mfma_f32_16x16x32_bf16 v[40:43], a[88:91], v[68:71], v[40:43]
    v_exp_f32 v31, v31
    v_mfma_f32_16x16x32_bf16 v[44:47], a[92:95], v[68:71], v[44:47]
    v_fma_f32 v56, v104, v12, v56
    v_fma_f32 v57, v105, v12, v57
    s_waitcnt lgkmcnt(3)
    v_mfma_f32_16x16x32_bf16 v[32:35], a[96:99], v[72:75], v[32:35]
    ds_read_b128 v[64:67], v2 offset:43008
    s_add_u32 m0, s51, 0x18000
    s_add_u32 s66, s50, 0x18000
    buffer_load_dwordx4 v2, s[4:7], s66 offen offset:0 lds
    v_mfma_f32_16x16x32_bf16 v[36:39], a[100:103], v[72:75], v[36:39]
    v_fma_f32 v58, v106, v12, v58
    v_fma_f32 v59, v107, v12, v59
    v_mfma_f32_16x16x32_bf16 v[40:43], a[104:107], v[72:75], v[40:43]
    v_fma_f32 v60, v108, v12, v60
    v_fma_f32 v61, v109, v12, v61
    v_mfma_f32_16x16x32_bf16 v[44:47], a[108:111], v[72:75], v[44:47]
    v_fma_f32 v62, v110, v12, v62
    v_fma_f32 v63, v111, v12, v63
    s_waitcnt lgkmcnt(3)
    v_mfma_f32_16x16x32_bf16 v[32:35], a[112:115], v[76:79], v[32:35]
    ds_read_b128 v[68:71], v2 offset:44032
    s_add_u32 m0, s51, 0x18000
    s_add_u32 s66, s50, 0x18000
    buffer_load_dwordx4 v2, s[4:7], s66 offen offset:1024 lds
    v_mfma_f32_16x16x32_bf16 v[36:39], a[116:119], v[76:79], v[36:39]
    v_fma_f32 v24, v24, v14, v14
    v_fma_f32 v25, v25, v14, v14
    v_mfma_f32_16x16x32_bf16 v[40:43], a[120:123], v[76:79], v[40:43]
    v_fma_f32 v26, v26, v14, v14
    v_fma_f32 v27, v27, v14, v14
    v_mfma_f32_16x16x32_bf16 v[44:47], a[124:127], v[76:79], v[44:47]
    v_fma_f32 v28, v28, v14, v14
    v_fma_f32 v29, v29, v14, v14
    s_waitcnt lgkmcnt(3)
    v_mfma_f32_16x16x32_bf16 v[32:35], a[128:131], v[80:83], v[32:35]
    ds_read_b128 v[72:75], v2 offset:45056
    s_add_u32 m0, s51, 0x18000
    s_add_u32 s66, s50, 0x18000
    buffer_load_dwordx4 v2, s[4:7], s66 offen offset:2048 lds
    v_mfma_f32_16x16x32_bf16 v[36:39], a[132:135], v[80:83], v[36:39]
    v_fma_f32 v30, v30, v14, v14
    v_fma_f32 v31, v31, v14, v14
    v_mfma_f32_16x16x32_bf16 v[40:43], a[136:139], v[80:83], v[40:43]
    v_rcp_f32 v24, v24
    v_mfma_f32_16x16x32_bf16 v[44:47], a[140:143], v[80:83], v[44:47]
    v_rcp_f32 v25, v25
    s_waitcnt lgkmcnt(3)
    v_mfma_f32_16x16x32_bf16 v[32:35], a[144:147], v[84:87], v[32:35]
    ds_read_b128 v[76:79], v2 offset:46080
    s_add_u32 m0, s51, 0x18000
    s_add_u32 s66, s50, 0x18000
    buffer_load_dwordx4 v2, s[4:7], s66 offen offset:3072 lds
    v_mfma_f32_16x16x32_bf16 v[36:39], a[148:151], v[84:87], v[36:39]
    v_rcp_f32 v26, v26
    v_mfma_f32_16x16x32_bf16 v[40:43], a[152:155], v[84:87], v[40:43]
    v_rcp_f32 v27, v27
    v_mfma_f32_16x16x32_bf16 v[44:47], a[156:159], v[84:87], v[44:47]
    v_rcp_f32 v28, v28
    s_waitcnt lgkmcnt(3)
    v_mfma_f32_16x16x32_bf16 v[32:35], a[160:163], v[64:67], v[32:35]
    ds_read_b128 v[80:83], v2 offset:47104
    s_add_u32 m0, s51, 0x1c000
    s_add_u32 s66, s50, 0x1c000
    buffer_load_dwordx4 v2, s[4:7], s66 offen offset:0 lds
    v_mfma_f32_16x16x32_bf16 v[36:39], a[164:167], v[64:67], v[36:39]
    v_rcp_f32 v29, v29
    v_mfma_f32_16x16x32_bf16 v[40:43], a[168:171], v[64:67], v[40:43]
    v_rcp_f32 v30, v30
    v_mfma_f32_16x16x32_bf16 v[44:47], a[172:175], v[64:67], v[44:47]
    v_rcp_f32 v31, v31
    s_waitcnt lgkmcnt(3)
    v_mfma_f32_16x16x32_bf16 v[32:35], a[176:179], v[68:71], v[32:35]
    ds_read_b128 v[84:87], v2 offset:48128
    s_add_u32 m0, s51, 0x1c000
    s_add_u32 s66, s50, 0x1c000
    buffer_load_dwordx4 v2, s[4:7], s66 offen offset:1024 lds
    v_mfma_f32_16x16x32_bf16 v[36:39], a[180:183], v[68:71], v[36:39]
    v_mul_f32 v48, v48, v56
    v_mul_f32 v49, v49, v57
    v_mfma_f32_16x16x32_bf16 v[40:43], a[184:187], v[68:71], v[40:43]
    v_mul_f32 v50, v50, v58
    v_mul_f32 v51, v51, v59
    v_mfma_f32_16x16x32_bf16 v[44:47], a[188:191], v[68:71], v[44:47]
    v_mul_f32 v52, v52, v60
    v_mul_f32 v53, v53, v61
    s_waitcnt lgkmcnt(3)
    v_mfma_f32_16x16x32_bf16 v[32:35], a[192:195], v[72:75], v[32:35]
    s_barrier
    ds_read_b128 v[64:67], v2 offset:49152
    s_add_u32 m0, s51, 0x1c000
    s_add_u32 s66, s50, 0x1c000
    buffer_load_dwordx4 v2, s[4:7], s66 offen offset:2048 lds
    v_mfma_f32_16x16x32_bf16 v[36:39], a[196:199], v[72:75], v[36:39]
    v_mul_f32 v54, v54, v62
    v_mul_f32 v55, v55, v63
    v_mfma_f32_16x16x32_bf16 v[40:43], a[200:203], v[72:75], v[40:43]
    v_mul_f32 v48, v48, v24
    v_mul_f32 v49, v49, v25
    v_mfma_f32_16x16x32_bf16 v[44:47], a[204:207], v[72:75], v[44:47]
    v_mul_f32 v50, v50, v26
    v_mul_f32 v51, v51, v27
    s_waitcnt lgkmcnt(3)
    v_mfma_f32_16x16x32_bf16 v[32:35], a[208:211], v[76:79], v[32:35]
    ds_read_b128 v[68:71], v2 offset:50176
    s_add_u32 m0, s51, 0x1c000
    s_add_u32 s66, s50, 0x1c000
    buffer_load_dwordx4 v2, s[4:7], s66 offen offset:3072 lds
    ds_read_b96 v[8:10], v7 offset:512
    v_mfma_f32_16x16x32_bf16 v[36:39], a[212:215], v[76:79], v[36:39]
    v_mul_f32 v52, v52, v28
    v_mul_f32 v53, v53, v29
    v_mfma_f32_16x16x32_bf16 v[40:43], a[216:219], v[76:79], v[40:43]
    v_mul_f32 v54, v54, v30
    v_mul_f32 v55, v55, v31
    v_mfma_f32_16x16x32_bf16 v[44:47], a[220:223], v[76:79], v[44:47]
    v_cvt_pk_bf16_f32 v56, v48, v49
    v_cvt_pk_bf16_f32 v57, v50, v51
    s_waitcnt lgkmcnt(4)
    v_mfma_f32_16x16x32_bf16 v[32:35], a[224:227], v[80:83], v[32:35]
    ds_read_b128 v[72:75], v2 offset:51200
    s_add_u32 s66, s56, 0x2000
    buffer_load_dwordx4 v[156:159], v2, s[4:7], s66 offen offset:3072
    v_mfma_f32_16x16x32_bf16 v[36:39], a[228:231], v[80:83], v[36:39]
    v_cvt_pk_bf16_f32 v58, v52, v53
    v_cvt_pk_bf16_f32 v59, v54, v55
    s_waitcnt vmcnt(16)
    s_add_u32 s66, s53, 0xe000
    buffer_store_dwordx4 v[56:59], v2, s[4:7], s66 offen sc1
    v_mov_b32 v15, 2
    s_mov_b64 exec, 1
    buffer_store_dword v15, off, s[4:7], s54 offset:0 sc1
    s_mov_b64 exec, -1
    v_mfma_f32_16x16x32_bf16 v[40:43], a[232:235], v[80:83], v[40:43]
    v_mfma_f32_16x16x32_bf16 v[44:47], a[236:239], v[80:83], v[44:47]
    s_waitcnt lgkmcnt(4)
    v_mfma_f32_16x16x32_bf16 v[32:35], a[240:243], v[84:87], v[32:35]
    ds_read_b128 v[76:79], v2 offset:52224
    s_add_u32 s66, s56, 0x3000
    buffer_load_dwordx4 v[160:163], v2, s[4:7], s66 offen offset:0
    v_mfma_f32_16x16x32_bf16 v[36:39], a[244:247], v[84:87], v[36:39]
    v_mfma_f32_16x16x32_bf16 v[40:43], a[248:251], v[84:87], v[40:43]
    v_mfma_f32_16x16x32_bf16 v[44:47], a[252:255], v[84:87], v[44:47]
    s_waitcnt lgkmcnt(4)
    v_mfma_f32_16x16x32_bf16 v[48:51], a[0:3], v[64:67], 0
    ds_read_b128 v[80:83], v2 offset:53248
    s_add_u32 s66, s56, 0x3000
    buffer_load_dwordx4 v[164:167], v2, s[4:7], s66 offen offset:1024
    v_mfma_f32_16x16x32_bf16 v[52:55], a[4:7], v[64:67], 0
    v_mfma_f32_16x16x32_bf16 v[56:59], a[8:11], v[64:67], 0
    s_waitcnt lgkmcnt(3)
    v_cmp_u_f32 vcc, v32, v10
    s_nop 5
    s_cbranch_vccnz L_slow4_55
L_back4_56:
    v_fma_f32 v32, v96, v8, v32
    v_fma_f32 v33, v97, v8, v33
    v_mfma_f32_16x16x32_bf16 v[60:63], a[12:15], v[64:67], 0
    v_fma_f32 v34, v98, v8, v34
    v_fma_f32 v35, v99, v8, v35
    v_mfma_f32_16x16x32_bf16 v[48:51], a[16:19], v[68:71], v[48:51]
    ds_read_b128 v[84:87], v2 offset:54272
    s_add_u32 s66, s56, 0x3000
    buffer_load_dwordx4 v[168:171], v2, s[4:7], s66 offen offset:2048
    v_mfma_f32_16x16x32_bf16 v[52:55], a[20:23], v[68:71], v[52:55]
    v_fma_f32 v36, v100, v8, v36
    v_fma_f32 v37, v101, v8, v37
    v_mfma_f32_16x16x32_bf16 v[56:59], a[24:27], v[68:71], v[56:59]
    v_fma_f32 v38, v102, v8, v38
    v_fma_f32 v39, v103, v8, v39
    v_mfma_f32_16x16x32_bf16 v[60:63], a[28:31], v[68:71], v[60:63]
    v_mul_f32 v24, v32, v9
    v_mul_f32 v25, v33, v9
    s_waitcnt lgkmcnt(3)
    v_mfma_f32_16x16x32_bf16 v[48:51], a[32:35], v[72:75], v[48:51]
    ds_read_b128 v[64:67], v2 offset:55296
    s_add_u32 s66, s56, 0x3000
    buffer_load_dwordx4 v[172:175], v2, s[4:7], s66 offen offset:3072
    v_mfma_f32_16x16x32_bf16 v[52:55], a[36:39], v[72:75], v[52:55]
    v_mul_f32 v26, v34, v9
    v_mul_f32 v27, v35, v9
    v_mfma_f32_16x16x32_bf16 v[56:59], a[40:43], v[72:75], v[56:59]
    v_mul_f32 v28, v36, v9
    v_mul_f32 v29, v37, v9
    v_mfma_f32_16x16x32_bf16 v[60:63], a[44:47], v[72:75], v[60:63]
    v_mul_f32 v30, v38, v9
    v_mul_f32 v31, v39, v9
    s_waitcnt lgkmcnt(3)
    v_mfma_f32_16x16x32_bf16 v[48:51], a[48:51], v[76:79], v[48:51]
    ds_read_b128 v[68:71], v2 offset:56320
    s_add_u32 s66, s56, 0x4000
    buffer_load_dwordx4 v[176:179], v2, s[4:7], s66 offen offset:0
    v_mfma_f32_16x16x32_bf16 v[52:55], a[52:55], v[76:79], v[52:55]
    v_exp_f32 v24, v24
    v_mfma_f32_16x16x32_bf16 v[56:59], a[56:59], v[76:79], v[56:59]
    v_exp_f32 v25, v25
    v_mfma_f32_16x16x32_bf16 v[60:63], a[60:63], v[76:79], v[60:63]
    v_exp_f32 v26, v26
    s_waitcnt lgkmcnt(3)
    v_mfma_f32_16x16x32_bf16 v[48:51], a[64:67], v[80:83], v[48:51]
    ds_read_b128 v[72:75], v2 offset:57344
    s_add_u32 s66, s56, 0x4000
    buffer_load_dwordx4 v[180:183], v2, s[4:7], s66 offen offset:1024
    v_mfma_f32_16x16x32_bf16 v[52:55], a[68:71], v[80:83], v[52:55]
    v_exp_f32 v27, v27
    v_mfma_f32_16x16x32_bf16 v[56:59], a[72:75], v[80:83], v[56:59]
    v_exp_f32 v28, v28
    v_mfma_f32_16x16x32_bf16 v[60:63], a[76:79], v[80:83], v[60:63]
    v_exp_f32 v29, v29
    s_waitcnt lgkmcnt(3)
    v_mfma_f32_16x16x32_bf16 v[48:51], a[80:83], v[84:87], v[48:51]
    ds_read_b128 v[76:79], v2 offset:58368
    s_add_u32 s66, s56, 0x4000
    buffer_load_dwordx4 v[184:187], v2, s[4:7], s66 offen offset:2048
    v_mfma_f32_16x16x32_bf16 v[52:55], a[84:87], v[84:87], v[52:55]
    v_exp_f32 v30, v30
    v_mfma_f32_16x16x32_bf16 v[56:59], a[88:91], v[84:87], v[56:59]
    v_exp_f32 v31, v31
    v_mfma_f32_16x16x32_bf16 v[60:63], a[92:95], v[84:87], v[60:63]
    v_fma_f32 v40, v104, v8, v40
    v_fma_f32 v41, v105, v8, v41
    s_waitcnt lgkmcnt(3)
    v_mfma_f32_16x16x32_bf16 v[48:51], a[96:99], v[64:67], v[48:51]
    ds_read_b128 v[80:83], v2 offset:59392
    s_add_u32 s66, s56, 0x4000
    buffer_load_dwordx4 v[188:191], v2, s[4:7], s66 offen offset:3072
    v_mfma_f32_16x16x32_bf16 v[52:55], a[100:103], v[64:67], v[52:55]
    v_fma_f32 v42, v106, v8, v42
    v_fma_f32 v43, v107, v8, v43
    v_mfma_f32_16x16x32_bf16 v[56:59], a[104:107], v[64:67], v[56:59]
    v_fma_f32 v44, v108, v8, v44
    v_fma_f32 v45, v109, v8, v45
    v_mfma_f32_16x16x32_bf16 v[60:63], a[108:111], v[64:67], v[60:63]
    v_fma_f32 v46, v110, v8, v46
    v_fma_f32 v47, v111, v8, v47
    s_waitcnt lgkmcnt(3)
    v_mfma_f32_16x16x32_bf16 v[48:51], a[112:115], v[68:71], v[48:51]
    ds_read_b128 v[84:87], v2 offset:60416
    s_add_u32 s66, s56, 0x5000
    buffer_load_dwordx4 v[192:195], v2, s[4:7], s66 offen offset:0
    v_mfma_f32_16x16x32_bf16 v[52:55], a[116:119], v[68:71], v[52:55]
    v_fma_f32 v24, v24, v10, v10
    v_fma_f32 v25, v25, v10, v10
    v_mfma_f32_16x16x32_bf16 v[56:59], a[120:123], v[68:71], v[56:59]
    v_fma_f32 v26, v26, v10, v10
    v_fma_f32 v27, v27, v10, v10
    v_mfma_f32_16x16x32_bf16 v[60:63], a[124:127], v[68:71], v[60:63]
    v_fma_f32 v28, v28, v10, v10
    v_fma_f32 v29, v29, v10, v10
    s_waitcnt lgkmcnt(3)
    v_mfma_f32_16x16x32_bf16 v[48:51], a[128:131], v[72:75], v[48:51]
    ds_read_b128 v[64:67], v2 offset:61440
    s_add_u32 s66, s56, 0x5000
    buffer_load_dwordx4 v[196:199], v2, s[4:7], s66 offen offset:1024
    v_mfma_f32_16x16x32_bf16 v[52:55], a[132:135], v[72:75], v[52:55]
    v_fma_f32 v30, v30, v10, v10
    v_fma_f32 v31, v31, v10, v10
    v_mfma_f32_16x16x32_bf16 v[56:59], a[136:139], v[72:75], v[56:59]
    v_rcp_f32 v24, v24
    v_mfma_f32_16x16x32_bf16 v[60:63], a[140:143], v[72:75], v[60:63]
    v_rcp_f32 v25, v25
    s_waitcnt lgkmcnt(3)
    v_mfma_f32_16x16x32_bf16 v[48:51], a[144:147], v[76:79], v[48:51]
    ds_read_b128 v[68:71], v2 offset:62464
    s_add_u32 s66, s56, 0x5000
    buffer_load_dwordx4 v[200:203], v2, s[4:7], s66 offen offset:2048
    v_mfma_f32_16x16x32_bf16 v[52:55], a[148:151], v[76:79], v[52:55]
    v_rcp_f32 v26, v26
    v_mfma_f32_16x16x32_bf16 v[56:59], a[152:155], v[76:79], v[56:59]
    v_rcp_f32 v27, v27
    v_mfma_f32_16x16x32_bf16 v[60:63], a[156:159], v[76:79], v[60:63]
    v_rcp_f32 v28, v28
    s_waitcnt lgkmcnt(3)
    v_mfma_f32_16x16x32_bf16 v[48:51], a[160:163], v[80:83], v[48:51]
    ds_read_b128 v[72:75], v2 offset:63488
    s_add_u32 s66, s56, 0x5000
    buffer_load_dwordx4 v[204:207], v2, s[4:7], s66 offen offset:3072
    v_mfma_f32_16x16x32_bf16 v[52:55], a[164:167], v[80:83], v[52:55]
    v_rcp_f32 v29, v29
    v_mfma_f32_16x16x32_bf16 v[56:59], a[168:171], v[80:83], v[56:59]
    v_rcp_f32 v30, v30
    v_mfma_f32_16x16x32_bf16 v[60:63], a[172:175], v[80:83], v[60:63]
    v_rcp_f32 v31, v31
    s_waitcnt lgkmcnt(3)
    v_mfma_f32_16x16x32_bf16 v[48:51], a[176:179], v[84:87], v[48:51]
    ds_read_b128 v[76:79], v2 offset:64512
    s_add_u32 s66, s56, 0x6000
    buffer_load_dwordx4 v[208:211], v2, s[4:7], s66 offen offset:0
    v_mfma_f32_16x16x32_bf16 v[52:55], a[180:183], v[84:87], v[52:55]
    v_mul_f32 v32, v32, v40
    v_mul_f32 v33, v33, v41
    v_mfma_f32_16x16x32_bf16 v[56:59], a[184:187], v[84:87], v[56:59]
    v_mul_f32 v34, v34, v42
    v_mul_f32 v35, v35, v43
    v_mfma_f32_16x16x32_bf16 v[60:63], a[188:191], v[84:87], v[60:63]
    v_mul_f32 v36, v36, v44
    v_mul_f32 v37, v37, v45
    s_waitcnt lgkmcnt(3)
    v_mfma_f32_16x16x32_bf16 v[48:51], a[192:195], v[64:67], v[48:51]
    s_waitcnt vmcnt(28)
    s_barrier
    ds_read_b128 v[80:83], v3 offset:0
    s_add_u32 s66, s56, 0x6000
    buffer_load_dwordx4 v[212:215], v2, s[4:7], s66 offen offset:1024
    v_mfma_f32_16x16x32_bf16 v[52:55], a[196:199], v[64:67], v[52:55]
    v_mul_f32 v38, v38, v46
    v_mul_f32 v39, v39, v47
    v_mfma_f32_16x16x32_bf16 v[56:59], a[200:203], v[64:67], v[56:59]
    v_mul_f32 v32, v32, v24
    v_mul_f32 v33, v33, v25
    v_mfma_f32_16x16x32_bf16 v[60:63], a[204:207], v[64:67], v[60:63]
    v_mul_f32 v34, v34, v26
    v_mul_f32 v35, v35, v27
    s_waitcnt lgkmcnt(3)
    v_mfma_f32_16x16x32_bf16 v[48:51], a[208:211], v[68:71], v[48:51]
    ds_read_b128 v[84:87], v3 offset:1024
    s_add_u32 s66, s56, 0x6000
    buffer_load_dwordx4 v[216:219], v2, s[4:7], s66 offen offset:2048
    ds_read_b96 v[12:14], v7 offset:768
    v_mfma_f32_16x16x32_bf16 v[52:55], a[212:215], v[68:71], v[52:55]
    v_mul_f32 v36, v36, v28
    v_mul_f32 v37, v37, v29
    v_mfma_f32_16x16x32_bf16 v[56:59], a[216:219], v[68:71], v[56:59]
    v_mul_f32 v38, v38, v30
    v_mul_f32 v39, v39, v31
    v_mfma_f32_16x16x32_bf16 v[60:63], a[220:223], v[68:71], v[60:63]
    v_cvt_pk_bf16_f32 v40, v32, v33
    v_cvt_pk_bf16_f32 v41, v34, v35
    s_waitcnt lgkmcnt(4)
    v_mfma_f32_16x16x32_bf16 v[48:51], a[224:227], v[72:75], v[48:51]
    ds_read_b128 v[64:67], v3 offset:2048
    s_add_u32 s66, s56, 0x6000
    buffer_load_dwordx4 v[220:223], v2, s[4:7], s66 offen offset:3072
    v_mfma_f32_16x16x32_bf16 v[52:55], a[228:231], v[72:75], v[52:55]
    v_cvt_pk_bf16_f32 v42, v36, v37
    v_cvt_pk_bf16_f32 v43, v38, v39
    s_waitcnt vmcnt(17)
    s_add_u32 s66, s53, 0x1c000
    buffer_store_dwordx4 v[40:43], v2, s[4:7], s66 offen sc1
    v_mov_b32 v15, 3
    s_mov_b64 exec, 1
    buffer_store_dword v15, off, s[4:7], s54 offset:0 sc1
    s_mov_b64 exec, -1
    v_mfma_f32_16x16x32_bf16 v[56:59], a[232:235], v[72:75], v[56:59]
    ds_read2st64_b32 v[88:89], v4 offset0:8 offset1:9
    ds_read2st64_b32 v[90:91], v4 offset0:24 offset1:25
    ds_read2st64_b32 v[92:93], v4 offset0:40 offset1:41
    ds_read2st64_b32 v[94:95], v4 offset0:56 offset1:57
    v_mfma_f32_16x16x32_bf16 v[60:63], a[236:239], v[72:75], v[60:63]
    s_waitcnt lgkmcnt(8)
    v_mfma_f32_16x16x32_bf16 v[48:51], a[240:243], v[76:79], v[48:51]
    ds_read_b128 v[68:71], v3 offset:3072
    s_add_u32 s66, s56, 0x7000
    buffer_load_dwordx4 v[224:227], v2, s[4:7], s66 offen offset:0
    v_mfma_f32_16x16x32_bf16 v[52:55], a[244:247], v[76:79], v[52:55]
    s_waitcnt lgkmcnt(1)
    v_add_f32 v88, v88, v89
    v_add_f32 v90, v90, v91
    v_mfma_f32_16x16x32_bf16 v[56:59], a[248:251], v[76:79], v[56:59]
    v_add_f32 v92, v92, v93
    v_add_f32 v94, v94, v95
    v_mfma_f32_16x16x32_bf16 v[60:63], a[252:255], v[76:79], v[60:63]
    v_add_f32 v88, v88, v90
    v_add_f32 v92, v92, v94
    v_mfma_f32_16x16x32_bf16 v[32:35], a[0:3], v[80:83], 0
    ds_read_b128 v[72:75], v3 offset:4096
    s_add_u32 s66, s56, 0x7000
    buffer_load_dwordx4 v[228:231], v2, s[4:7], s66 offen offset:1024
    v_add_f32 v88, v88, v92
    v_mfma_f32_16x16x32_bf16 v[36:39], a[4:7], v[80:83], 0
    v_mov_b32 v89, v88
    v_mfma_f32_16x16x32_bf16 v[40:43], a[8:11], v[80:83], 0
    s_nop 0
    v_permlane16_swap_b32 v88, v89
    v_mfma_f32_16x16x32_bf16 v[44:47], a[12:15], v[80:83], 0
    v_add_f32 v88, v88, v89
    v_mov_b32 v89, v88
    v_mfma_f32_16x16x32_bf16 v[32:35], a[16:19], v[84:87], v[32:35]
    ds_read_b128 v[76:79], v3 offset:5120
    s_add_u32 s66, s56, 0x7000
    buffer_load_dwordx4 v[232:235], v2, s[4:7], s66 offen offset:2048
    v_permlane32_swap_b32 v88, v89
    v_mfma_f32_16x16x32_bf16 v[36:39], a[20:23], v[84:87], v[36:39]
    v_mul_f32 v92, 0xbb000000, v88
    v_mul_f32 v94, 0x3b000000, v89
    v_mfma_f32_16x16x32_bf16 v[40:43], a[24:27], v[84:87], v[40:43]
    v_add_f32 v94, 0x3727c5ac, v94
    v_fma_f32 v94, -v92, v92, v94
    v_mfma_f32_16x16x32_bf16 v[44:47], a[28:31], v[84:87], v[44:47]
    v_rsq_f32 v93, v94
    v_mfma_f32_16x16x32_bf16 v[32:35], a[32:35], v[64:67], v[32:35]
    ds_read_b128 v[80:83], v3 offset:6144
    s_add_u32 s66, s56, 0x7000
    buffer_load_dwordx4 v[236:239], v2, s[4:7], s66 offen offset:3072
    v_mul_f32 v93, 0xbfb8aa3b, v93
    v_mfma_f32_16x16x32_bf16 v[36:39], a[36:39], v[64:67], v[36:39]
    ds_write_b96 v6, v[92:94] offset:1024
    v_cmp_u_f32 vcc, v48, v14
    s_nop 5
    s_cbranch_vccnz L_slow4_58
L_back4_59:
    v_fma_f32 v48, v96, v12, v48
    v_mfma_f32_16x16x32_bf16 v[40:43], a[40:43], v[64:67], v[40:43]
    v_fma_f32 v49, v97, v12, v49
    v_fma_f32 v50, v98, v12, v50
    v_mfma_f32_16x16x32_bf16 v[44:47], a[44:47], v[64:67], v[44:47]
    v_fma_f32 v51, v99, v12, v51
    v_fma_f32 v52, v100, v12, v52
    s_waitcnt lgkmcnt(4)
    v_mfma_f32_16x16x32_bf16 v[32:35], a[48:51], v[68:71], v[32:35]
    ds_read_b128 v[84:87], v3 offset:7168
    s_add_u32 s66, s56, 0x8000
    buffer_load_dwordx4 v[240:243], v2, s[4:7], s66 offen offset:0
    v_fma_f32 v53, v101, v12, v53
    v_mfma_f32_16x16x32_bf16 v[36:39], a[52:55], v[68:71], v[36:39]
    v_fma_f32 v54, v102, v12, v54
    v_fma_f32 v55, v103, v12, v55
    v_mfma_f32_16x16x32_bf16 v[40:43], a[56:59], v[68:71], v[40:43]
    v_mul_f32 v24, v48, v13
    v_mul_f32 v25, v49, v13
    v_mfma_f32_16x16x32_bf16 v[44:47], a[60:63], v[68:71], v[44:47]
    v_mul_f32 v26, v50, v13
    v_mul_f32 v27, v51, v13
    s_waitcnt lgkmcnt(4)
    v_mfma_f32_16x16x32_bf16 v[32:35], a[64:67], v[72:75], v[32:35]
    ds_read_b128 v[64:67], v3 offset:8192
    s_add_u32 s66, s56, 0x8000
    buffer_load_dwordx4 v[244:247], v2, s[4:7], s66 offen offset:1024
    v_mul_f32 v28, v52, v13
    v_mfma_f32_16x16x32_bf16 v[36:39], a[68:71], v[72:75], v[36:39]
    v_mul_f32 v29, v53, v13
    v_mul_f32 v30, v54, v13
    v_mfma_f32_16x16x32_bf16 v[40:43], a[72:75], v[72:75], v[40:43]
    v_mul_f32 v31, v55, v13
    v_mfma_f32_16x16x32_bf16 v[44:47], a[76:79], v[72:75], v[44:47]
    v_exp_f32 v24, v24
    s_waitcnt lgkmcnt(4)
    v_mfma_f32_16x16x32_bf16 v[32:35], a[80:83], v[76:79], v[32:35]
    ds_read_b128 v[68:71], v3 offset:9216
    s_add_u32 s66, s56, 0x8000
    buffer_load_dwordx4 v[248:251], v2, s[4:7], s66 offen offset:2048
    v_mfma_f32_16x16x32_bf16 v[36:39], a[84:87], v[76:79], v[36:39]
    v_exp_f32 v25, v25
    v_mfma_f32_16x16x32_bf16 v[40:43], a[88:91], v[76:79], v[40:43]
    v_exp_f32 v26, v26
    v_mfma_f32_16x16x32_bf16 v[44:47], a[92:95], v[76:79], v[44:47]
    v_exp_f32 v27, v27
    s_waitcnt lgkmcnt(4)
    v_mfma_f32_16x16x32_bf16 v[32:35], a[96:99], v[80:83], v[32:35]
    ds_read_b128 v[72:75], v3 offset:10240
    s_add_u32 s66, s56, 0x8000
    buffer_load_dwordx4 v[252:255], v2, s[4:7], s66 offen offset:3072
    v_mfma_f32_16x16x32_bf16 v[36:39], a[100:103], v[80:83], v[36:39]
    v_exp_f32 v28, v28
    v_mfma_f32_16x16x32_bf16 v[40:43], a[104:107], v[80:83], v[40:43]
    v_exp_f32 v29, v29
    v_mfma_f32_16x16x32_bf16 v[44:47], a[108:111], v[80:83], v[44:47]
    v_exp_f32 v30, v30
    s_waitcnt lgkmcnt(3)
    v_mfma_f32_16x16x32_bf16 v[32:35], a[112:115], v[84:87], v[32:35]
    ds_read_b128 v[76:79], v3 offset:11264
    s_add_u32 m0, s51, 0x0
    s_add_u32 s66, s56, 0x9000
    buffer_load_dwordx4 v2, s[4:7], s66 offen offset:0 lds
    v_mfma_f32_16x16x32_bf16 v[36:39], a[116:119], v[84:87], v[36:39]
    v_exp_f32 v31, v31
    v_mfma_f32_16x16x32_bf16 v[40:43], a[120:123], v[84:87], v[40:43]
    v_fma_f32 v56, v104, v12, v56
    v_fma_f32 v57, v105, v12, v57
    v_mfma_f32_16x16x32_bf16 v[44:47], a[124:127], v[84:87], v[44:47]
    v_fma_f32 v58, v106, v12, v58
    v_fma_f32 v59, v107, v12, v59
    s_waitcnt lgkmcnt(3)
    v_mfma_f32_16x16x32_bf16 v[32:35], a[128:131], v[64:67], v[32:35]
    ds_read_b128 v[80:83], v3 offset:12288
    s_add_u32 m0, s51, 0x0
    s_add_u32 s66, s56, 0x9000
    buffer_load_dwordx4 v2, s[4:7], s66 offen offset:1024 lds
    v_fma_f32 v60, v108, v12, v60
    v_mfma_f32_16x16x32_bf16 v[36:39], a[132:135], v[64:67], v[36:39]
    v_fma_f32 v61, v109, v12, v61
    v_fma_f32 v62, v110, v12, v62
    v_mfma_f32_16x16x32_bf16 v[40:43], a[136:139], v[64:67], v[40:43]
    v_fma_f32 v63, v111, v12, v63
    v_fma_f32 v24, v24, v14, v14
    v_mfma_f32_16x16x32_bf16 v[44:47], a[140:143], v[64:67], v[44:47]
    v_fma_f32 v25, v25, v14, v14
    v_fma_f32 v26, v26, v14, v14
    s_waitcnt lgkmcnt(3)
    v_mfma_f32_16x16x32_bf16 v[32:35], a[144:147], v[68:71], v[32:35]
    ds_read_b128 v[84:87], v3 offset:13312
    s_add_u32 m0, s51, 0x0
    s_add_u32 s66, s56, 0x9000
    buffer_load_dwordx4 v2, s[4:7], s66 offen offset:2048 lds
    v_fma_f32 v27, v27, v14, v14
    v_mfma_f32_16x16x32_bf16 v[36:39], a[148:151], v[68:71], v[36:39]
    v_fma_f32 v28, v28, v14, v14
    v_fma_f32 v29, v29, v14, v14
    v_mfma_f32_16x16x32_bf16 v[40:43], a[152:155], v[68:71], v[40:43]
    v_fma_f32 v30, v30, v14, v14
    v_fma_f32 v31, v31, v14, v14
    v_mfma_f32_16x16x32_bf16 v[44:47], a[156:159], v[68:71], v[44:47]
    v_rcp_f32 v24, v24
    s_waitcnt lgkmcnt(3)
    v_mfma_f32_16x16x32_bf16 v[32:35], a[160:163], v[72:75], v[32:35]
    ds_read_b128 v[64:67], v3 offset:14336
    s_add_u32 m0, s51, 0x0
    s_add_u32 s66, s56, 0x9000
    buffer_load_dwordx4 v2, s[4:7], s66 offen offset:3072 lds
    v_mfma_f32_16x16x32_bf16 v[36:39], a[164:167], v[72:75], v[36:39]
    v_rcp_f32 v25, v25
    v_mfma_f32_16x16x32_bf16 v[40:43], a[168:171], v[72:75], v[40:43]
    v_rcp_f32 v26, v26
    v_mfma_f32_16x16x32_bf16 v[44:47], a[172:175], v[72:75], v[44:47]
    v_rcp_f32 v27, v27
    s_waitcnt lgkmcnt(3)
    v_mfma_f32_16x16x32_bf16 v[32:35], a[176:179], v[76:79], v[32:35]
    ds_read_b128 v[68:71], v3 offset:15360
    s_add_u32 m0, s51, 0x4000
    s_add_u32 s66, s56, 0xa000
    buffer_load_dwordx4 v2, s[4:7], s66 offen offset:0 lds
    v_mfma_f32_16x16x32_bf16 v[36:39], a[180:183], v[76:79], v[36:39]
    v_rcp_f32 v28, v28
    v_mfma_f32_16x16x32_bf16 v[40:43], a[184:187], v[76:79], v[40:43]
    v_rcp_f32 v29, v29
    v_mfma_f32_16x16x32_bf16 v[44:47], a[188:191], v[76:79], v[44:47]
    v_rcp_f32 v30, v30
    s_waitcnt lgkmcnt(3)
    v_mfma_f32_16x16x32_bf16 v[32:35], a[192:195], v[80:83], v[32:35]
    s_barrier
    ds_read_b128 v[72:75], v3 offset:16384
    s_add_u32 m0, s51, 0x4000
    s_add_u32 s66, s56, 0xa000
    buffer_load_dwordx4 v2, s[4:7], s66 offen offset:1024 lds
    v_mfma_f32_16x16x32_bf16 v[36:39], a[196:199], v[80:83], v[36:39]
    v_rcp_f32 v31, v31
    v_mfma_f32_16x16x32_bf16 v[40:43], a[200:203], v[80:83], v[40:43]
    v_mul_f32 v48, v48, v56
    v_mul_f32 v49, v49, v57
    v_mfma_f32_16x16x32_bf16 v[44:47], a[204:207], v[80:83], v[44:47]
    v_mul_f32 v50, v50, v58
    v_mul_f32 v51, v51, v59
    s_waitcnt lgkmcnt(3)
    v_mfma_f32_16x16x32_bf16 v[32:35], a[208:211], v[84:87], v[32:35]
    ds_read_b128 v[76:79], v3 offset:17408
    s_add_u32 m0, s51, 0x4000
    s_add_u32 s66, s56, 0xa000
    buffer_load_dwordx4 v2, s[4:7], s66 offen offset:2048 lds
    ds_read_b96 v[8:10], v7 offset:1024
    v_mul_f32 v52, v52, v60
    v_mfma_f32_16x16x32_bf16 v[36:39], a[212:215], v[84:87], v[36:39]
    v_mul_f32 v53, v53, v61
    v_mul_f32 v54, v54, v62
    v_mfma_f32_16x16x32_bf16 v[40:43], a[216:219], v[84:87], v[40:43]
    v_mul_f32 v55, v55, v63
    v_mul_f32 v48, v48, v24
    v_mfma_f32_16x16x32_bf16 v[44:47], a[220:223], v[84:87], v[44:47]
    v_mul_f32 v49, v49, v25
    v_mul_f32 v50, v50, v26
    s_waitcnt lgkmcnt(4)
    v_mfma_f32_16x16x32_bf16 v[32:35], a[224:227], v[64:67], v[32:35]
    ds_read_b128 v[80:83], v3 offset:18432
    s_add_u32 m0, s51, 0x4000
    s_add_u32 s66, s56, 0xa000
    buffer_load_dwordx4 v2, s[4:7], s66 offen offset:3072 lds
    v_mul_f32 v51, v51, v27
    v_mfma_f32_16x16x32_bf16 v[36:39], a[228:231], v[64:67], v[36:39]
    v_mul_f32 v52, v52, v28
    v_mul_f32 v53, v53, v29
    v_mfma_f32_16x16x32_bf16 v[40:43], a[232:235], v[64:67], v[40:43]
    v_mul_f32 v54, v54, v30
    v_mul_f32 v55, v55, v31
    v_mfma_f32_16x16x32_bf16 v[44:47], a[236:239], v[64:67], v[44:47]
    v_cvt_pk_bf16_f32 v56, v48, v49
    v_cvt_pk_bf16_f32 v57, v50, v51
    s_waitcnt lgkmcnt(4)
    v_mfma_f32_16x16x32_bf16 v[32:35], a[240:243], v[68:71], v[32:35]
    ds_read_b128 v[84:87], v3 offset:19456
    s_add_u32 m0, s51, 0x8000
    s_add_u32 s66, s56, 0xb000
    buffer_load_dwordx4 v2, s[4:7], s66 offen offset:0 lds
    v_cvt_pk_bf16_f32 v58, v52, v53
    v_mfma_f32_16x16x32_bf16 v[36:39], a[244:247], v[68:71], v[36:39]
    v_cvt_pk_bf16_f32 v59, v54, v55
    s_waitcnt vmcnt(18)
    s_add_u32 s66, s53, 0x2a000
    buffer_store_dwordx4 v[56:59], v2, s[4:7], s66 offen sc1
    v_mov_b32 v15, 4
    s_mov_b64 exec, 1
    buffer_store_dword v15, off, s[4:7], s54 offset:0 sc1
    s_mov_b64 exec, -1
    v_mfma_f32_16x16x32_bf16 v[40:43], a[248:251], v[68:71], v[40:43]
    v_mfma_f32_16x16x32_bf16 v[44:47], a[252:255], v[68:71], v[44:47]
    s_waitcnt lgkmcnt(4)
    v_mfma_f32_16x16x32_bf16 v[48:51], a[0:3], v[72:75], 0
    ds_read_b128 v[64:67], v3 offset:20480
    s_add_u32 m0, s51, 0x8000
    s_add_u32 s66, s56, 0xb000
    buffer_load_dwordx4 v2, s[4:7], s66 offen offset:1024 lds
    v_mfma_f32_16x16x32_bf16 v[52:55], a[4:7], v[72:75], 0
    v_mfma_f32_16x16x32_bf16 v[56:59], a[8:11], v[72:75], 0
    s_waitcnt lgkmcnt(3)
    v_fma_f32 v32, v96, v8, v32
    v_fma_f32 v33, v97, v8, v33
    v_mfma_f32_16x16x32_bf16 v[60:63], a[12:15], v[72:75], 0
    v_fma_f32 v34, v98, v8, v34
    v_fma_f32 v35, v99, v8, v35
    v_mfma_f32_16x16x32_bf16 v[48:51], a[16:19], v[76:79], v[48:51]
    ds_read_b128 v[68:71], v3 offset:21504
    s_add_u32 m0, s51, 0x8000
    s_add_u32 s66, s56, 0xb000
    buffer_load_dwordx4 v2, s[4:7], s66 offen offset:2048 lds
    v_mfma_f32_16x16x32_bf16 v[52:55], a[20:23], v[76:79], v[52:55]
    v_fma_f32 v36, v100, v8, v36
    v_fma_f32 v37, v101, v8, v37
    v_mfma_f32_16x16x32_bf16 v[56:59], a[24:27], v[76:79], v[56:59]
    v_fma_f32 v38, v102, v8, v38
    v_fma_f32 v39, v103, v8, v39
    v_mfma_f32_16x16x32_bf16 v[60:63], a[28:31], v[76:79], v[60:63]
    v_mul_f32 v24, v32, v9
    v_mul_f32 v25, v33, v9
    s_waitcnt lgkmcnt(3)
    v_mfma_f32_16x16x32_bf16 v[48:51], a[32:35], v[80:83], v[48:51]
    ds_read_b128 v[72:75], v3 offset:22528
    s_add_u32 m0, s51, 0x8000
    s_add_u32 s66, s56, 0xb000
    buffer_load_dwordx4 v2, s[4:7], s66 offen offset:3072 lds
    v_mfma_f32_16x16x32_bf16 v[52:55], a[36:39], v[80:83], v[52:55]
    v_mul_f32 v26, v34, v9
    v_mul_f32 v27, v35, v9
    v_mfma_f32_16x16x32_bf16 v[56:59], a[40:43], v[80:83], v[56:59]
    v_mul_f32 v28, v36, v9
    v_mul_f32 v29, v37, v9
    v_mfma_f32_16x16x32_bf16 v[60:63], a[44:47], v[80:83], v[60:63]
    v_mul_f32 v30, v38, v9
    v_mul_f32 v31, v39, v9
    s_waitcnt lgkmcnt(3)
    v_mfma_f32_16x16x32_bf16 v[48:51], a[48:51], v[84:87], v[48:51]
    ds_read_b128 v[76:79], v3 offset:23552
    s_add_u32 m0, s51, 0xc000
    s_add_u32 s66, s56, 0xc000
    buffer_load_dwordx4 v2, s[4:7], s66 offen offset:0 lds
    v_mfma_f32_16x16x32_bf16 v[52:55], a[52:55], v[84:87], v[52:55]
    v_exp_f32 v24, v24
    v_mfma_f32_16x16x32_bf16 v[56:59], a[56:59], v[84:87], v[56:59]
    v_exp_f32 v25, v25
    v_mfma_f32_16x16x32_bf16 v[60:63], a[60:63], v[84:87], v[60:63]
    v_exp_f32 v26, v26
    s_waitcnt lgkmcnt(3)
    v_mfma_f32_16x16x32_bf16 v[48:51], a[64:67], v[64:67], v[48:51]
    ds_read_b128 v[80:83], v3 offset:24576
    s_add_u32 m0, s51, 0xc000
    s_add_u32 s66, s56, 0xc000
    buffer_load_dwordx4 v2, s[4:7], s66 offen offset:1024 lds
    v_mfma_f32_16x16x32_bf16 v[52:55], a[68:71], v[64:67], v[52:55]
    v_exp_f32 v27, v27
    v_mfma_f32_16x16x32_bf16 v[56:59], a[72:75], v[64:67], v[56:59]
    v_exp_f32 v28, v28
    v_mfma_f32_16x16x32_bf16 v[60:63], a[76:79], v[64:67], v[60:63]
    v_exp_f32 v29, v29
    s_waitcnt lgkmcnt(3)
    v_mfma_f32_16x16x32_bf16 v[48:51], a[80:83], v[68:71], v[48:51]
    ds_read_b128 v[84:87], v3 offset:25600
    s_add_u32 m0, s51, 0xc000
    s_add_u32 s66, s56, 0xc000
    buffer_load_dwordx4 v2, s[4:7], s66 offen offset:2048 lds
    v_mfma_f32_16x16x32_bf16 v[52:55], a[84:87], v[68:71], v[52:55]
    v_exp_f32 v30, v30
    v_mfma_f32_16x16x32_bf16 v[56:59], a[88:91], v[68:71], v[56:59]
    v_exp_f32 v31, v31
    v_mfma_f32_16x16x32_bf16 v[60:63], a[92:95], v[68:71], v[60:63]
    v_fma_f32 v40, v104, v8, v40
    v_fma_f32 v41, v105, v8, v41
    s_waitcnt lgkmcnt(3)
    v_mfma_f32_16x16x32_bf16 v[48:51], a[96:99], v[72:75], v[48:51]
    ds_read_b128 v[64:67], v3 offset:26624
    s_add_u32 m0, s51, 0xc000
    s_add_u32 s66, s56, 0xc000
    buffer_load_dwordx4 v2, s[4:7], s66 offen offset:3072 lds
    v_mfma_f32_16x16x32_bf16 v[52:55], a[100:103], v[72:75], v[52:55]
    v_fma_f32 v42, v106, v8, v42
    v_fma_f32 v43, v107, v8, v43
    v_mfma_f32_16x16x32_bf16 v[56:59], a[104:107], v[72:75], v[56:59]
    v_fma_f32 v44, v108, v8, v44
    v_fma_f32 v45, v109, v8, v45
    v_mfma_f32_16x16x32_bf16 v[60:63], a[108:111], v[72:75], v[60:63]
    v_fma_f32 v46, v110, v8, v46
    v_fma_f32 v47, v111, v8, v47
    s_waitcnt lgkmcnt(3)
    v_mfma_f32_16x16x32_bf16 v[48:51], a[112:115], v[76:79], v[48:51]
    ds_read_b128 v[68:71], v3 offset:27648
    v_mfma_f32_16x16x32_bf16 v[52:55], a[116:119], v[76:79], v[52:55]
    v_fma_f32 v24, v24, v10, v10
    v_fma_f32 v25, v25, v10, v10
    v_mfma_f32_16x16x32_bf16 v[56:59], a[120:123], v[76:79], v[56:59]
    v_fma_f32 v26, v26, v10, v10
    v_fma_f32 v27, v27, v10, v10
    v_mfma_f32_16x16x32_bf16 v[60:63], a[124:127], v[76:79], v[60:63]
    v_fma_f32 v28, v28, v10, v10
    v_fma_f32 v29, v29, v10, v10
    s_waitcnt lgkmcnt(3)
    v_mfma_f32_16x16x32_bf16 v[48:51], a[128:131], v[80:83], v[48:51]
    ds_read_b128 v[72:75], v3 offset:28672
    v_mfma_f32_16x16x32_bf16 v[52:55], a[132:135], v[80:83], v[52:55]
    v_fma_f32 v30, v30, v10, v10
    v_fma_f32 v31, v31, v10, v10
    v_mfma_f32_16x16x32_bf16 v[56:59], a[136:139], v[80:83], v[56:59]
    v_rcp_f32 v24, v24
    v_mfma_f32_16x16x32_bf16 v[60:63], a[140:143], v[80:83], v[60:63]
    v_rcp_f32 v25, v25
    s_waitcnt lgkmcnt(3)
    v_mfma_f32_16x16x32_bf16 v[48:51], a[144:147], v[84:87], v[48:51]
    ds_read_b128 v[76:79], v3 offset:29696
    v_mfma_f32_16x16x32_bf16 v[52:55], a[148:151], v[84:87], v[52:55]
    v_rcp_f32 v26, v26
    v_mfma_f32_16x16x32_bf16 v[56:59], a[152:155], v[84:87], v[56:59]
    v_rcp_f32 v27, v27
    v_mfma_f32_16x16x32_bf16 v[60:63], a[156:159], v[84:87], v[60:63]
    v_rcp_f32 v28, v28
    s_waitcnt lgkmcnt(3)
    v_mfma_f32_16x16x32_bf16 v[48:51], a[160:163], v[64:67], v[48:51]
    ds_read_b128 v[80:83], v3 offset:30720
    v_min_u32 v5, 52, v5
    v_add_u32 v4, 0x10000, v11
    s_add_u32 s67, s19, 2
    s_add_u32 s68, s19, 4
    v_mfma_f32_16x16x32_bf16 v[52:55], a[164:167], v[64:67], v[52:55]
    v_rcp_f32 v29, v29
    v_mfma_f32_16x16x32_bf16 v[56:59], a[168:171], v[64:67], v[56:59]
    v_rcp_f32 v30, v30
    v_mfma_f32_16x16x32_bf16 v[60:63], a[172:175], v[64:67], v[60:63]
    v_rcp_f32 v31, v31
    s_waitcnt lgkmcnt(3)
    v_mfma_f32_16x16x32_bf16 v[48:51], a[176:179], v[68:71], v[48:51]
    ds_read_b128 v[84:87], v3 offset:31744
    v_mfma_f32_16x16x32_bf16 v[52:55], a[180:183], v[68:71], v[52:55]
    v_mul_f32 v32, v32, v40
    v_mul_f32 v33, v33, v41
    v_mfma_f32_16x16x32_bf16 v[56:59], a[184:187], v[68:71], v[56:59]
    v_mul_f32 v34, v34, v42
    v_mul_f32 v35, v35, v43
    v_mfma_f32_16x16x32_bf16 v[60:63], a[188:191], v[68:71], v[60:63]
    v_mul_f32 v36, v36, v44
    v_mul_f32 v37, v37, v45
    s_waitcnt lgkmcnt(3)
    v_mfma_f32_16x16x32_bf16 v[48:51], a[192:195], v[72:75], v[48:51]
    s_barrier
    ds_read_b128 v[64:67], v3 offset:32768
    v_mfma_f32_16x16x32_bf16 v[52:55], a[196:199], v[72:75], v[52:55]
    v_mul_f32 v38, v38, v46
    v_mul_f32 v39, v39, v47
    v_mfma_f32_16x16x32_bf16 v[56:59], a[200:203], v[72:75], v[56:59]
    v_mul_f32 v32, v32, v24
    v_mul_f32 v33, v33, v25
    v_mfma_f32_16x16x32_bf16 v[60:63], a[204:207], v[72:75], v[60:63]
    v_mul_f32 v34, v34, v26
    v_mul_f32 v35, v35, v27
    s_waitcnt lgkmcnt(3)
    v_mfma_f32_16x16x32_bf16 v[48:51], a[208:211], v[76:79], v[48:51]
    ds_read_b128 v[68:71], v3 offset:33792
    s_add_u32 m0, s51, 0x10000
    s_add_u32 s66, s56, 0xd000
    buffer_load_dwordx4 v2, s[4:7], s66 offen offset:0 lds
    ds_read_b96 v[12:14], v7 offset:1280
    v_mfma_f32_16x16x32_bf16 v[52:55], a[212:215], v[76:79], v[52:55]
    v_mul_f32 v36, v36, v28
    v_mul_f32 v37, v37, v29
    v_mfma_f32_16x16x32_bf16 v[56:59], a[216:219], v[76:79], v[56:59]
    v_mul_f32 v38, v38, v30
    v_mul_f32 v39, v39, v31
    v_mfma_f32_16x16x32_bf16 v[60:63], a[220:223], v[76:79], v[60:63]
    v_cvt_pk_bf16_f32 v40, v32, v33
    v_cvt_pk_bf16_f32 v41, v34, v35
    s_waitcnt lgkmcnt(4)
    v_mfma_f32_16x16x32_bf16 v[48:51], a[224:227], v[80:83], v[48:51]
    ds_read_b128 v[72:75], v3 offset:34816
    s_add_u32 m0, s51, 0x10000
    s_add_u32 s66, s56, 0xd000
    buffer_load_dwordx4 v2, s[4:7], s66 offen offset:1024 lds
    v_mfma_f32_16x16x32_bf16 v[52:55], a[228:231], v[80:83], v[52:55]
    v_cvt_pk_bf16_f32 v42, v36, v37
    v_cvt_pk_bf16_f32 v43, v38, v39
    s_waitcnt vmcnt(10)
    s_add_u32 s66, s53, 0x38000
    buffer_store_dwordx4 v[40:43], v2, s[4:7], s66 offen sc1
    v_mov_b32 v15, 5
    s_mov_b64 exec, 1
    buffer_store_dword v15, off, s[4:7], s54 offset:0 sc1
    s_mov_b64 exec, -1
    v_mfma_f32_16x16x32_bf16 v[56:59], a[232:235], v[80:83], v[56:59]
    v_mfma_f32_16x16x32_bf16 v[60:63], a[236:239], v[80:83], v[60:63]
    s_waitcnt lgkmcnt(4)
    v_mfma_f32_16x16x32_bf16 v[48:51], a[240:243], v[84:87], v[48:51]
    ds_read_b128 v[76:79], v3 offset:35840
    s_add_u32 m0, s51, 0x10000
    s_add_u32 s66, s56, 0xd000
    buffer_load_dwordx4 v2, s[4:7], s66 offen offset:2048 lds
    v_mfma_f32_16x16x32_bf16 v[52:55], a[244:247], v[84:87], v[52:55]
    v_mfma_f32_16x16x32_bf16 v[56:59], a[248:251], v[84:87], v[56:59]
    v_mfma_f32_16x16x32_bf16 v[60:63], a[252:255], v[84:87], v[60:63]
    s_waitcnt lgkmcnt(4)
    v_mfma_f32_16x16x32_bf16 v[32:35], a[0:3], v[64:67], 0
    ds_read_b128 v[80:83], v3 offset:36864
    s_add_u32 m0, s51, 0x10000
    s_add_u32 s66, s56, 0xd000
    buffer_load_dwordx4 v2, s[4:7], s66 offen offset:3072 lds
    v_mfma_f32_16x16x32_bf16 v[36:39], a[4:7], v[64:67], 0
    v_mfma_f32_16x16x32_bf16 v[40:43], a[8:11], v[64:67], 0
    s_waitcnt lgkmcnt(3)
    v_fma_f32 v48, v96, v12, v48
    v_fma_f32 v49, v97, v12, v49
    v_mfma_f32_16x16x32_bf16 v[44:47], a[12:15], v[64:67], 0
    v_fma_f32 v50, v98, v12, v50
    v_fma_f32 v51, v99, v12, v51
    v_mfma_f32_16x16x32_bf16 v[32:35], a[16:19], v[68:71], v[32:35]
    ds_read_b128 v[84:87], v3 offset:37888
    v_mfma_f32_16x16x32_bf16 v[36:39], a[20:23], v[68:71], v[36:39]
    v_fma_f32 v52, v100, v12, v52
    v_fma_f32 v53, v101, v12, v53
    v_mfma_f32_16x16x32_bf16 v[40:43], a[24:27], v[68:71], v[40:43]
    v_fma_f32 v54, v102, v12, v54
    v_fma_f32 v55, v103, v12, v55
    v_mfma_f32_16x16x32_bf16 v[44:47], a[28:31], v[68:71], v[44:47]
    v_mul_f32 v24, v48, v13
    v_mul_f32 v25, v49, v13
    s_waitcnt lgkmcnt(3)
    v_mfma_f32_16x16x32_bf16 v[32:35], a[32:35], v[72:75], v[32:35]
    ds_read_b128 v[64:67], v3 offset:38912
    buffer_load_dword v0, v5, s[4:7], s57 offen offset:0 sc1
    v_mfma_f32_16x16x32_bf16 v[36:39], a[36:39], v[72:75], v[36:39]
    v_mul_f32 v26, v50, v13
    v_mul_f32 v27, v51, v13
    v_mfma_f32_16x16x32_bf16 v[40:43], a[40:43], v[72:75], v[40:43]
    v_mul_f32 v28, v52, v13
    v_mul_f32 v29, v53, v13
    v_mfma_f32_16x16x32_bf16 v[44:47], a[44:47], v[72:75], v[44:47]
    v_mul_f32 v30, v54, v13
    v_mul_f32 v31, v55, v13
    s_waitcnt lgkmcnt(3)
    v_mfma_f32_16x16x32_bf16 v[32:35], a[48:51], v[76:79], v[32:35]
    ds_read_b128 v[68:71], v3 offset:39936
    v_mfma_f32_16x16x32_bf16 v[36:39], a[52:55], v[76:79], v[36:39]
    v_exp_f32 v24, v24
    v_mfma_f32_16x16x32_bf16 v[40:43], a[56:59], v[76:79], v[40:43]
    v_exp_f32 v25, v25
    v_mfma_f32_16x16x32_bf16 v[44:47], a[60:63], v[76:79], v[44:47]
    v_exp_f32 v26, v26
    s_waitcnt lgkmcnt(3)
    v_mfma_f32_16x16x32_bf16 v[32:35], a[64:67], v[80:83], v[32:35]
    ds_read_b128 v[72:75], v3 offset:40960
    v_mfma_f32_16x16x32_bf16 v[36:39], a[68:71], v[80:83], v[36:39]
    v_exp_f32 v27, v27
    v_mfma_f32_16x16x32_bf16 v[40:43], a[72:75], v[80:83], v[40:43]
    v_exp_f32 v28, v28
    v_mfma_f32_16x16x32_bf16 v[44:47], a[76:79], v[80:83], v[44:47]
    v_exp_f32 v29, v29
    s_waitcnt lgkmcnt(3)
    v_mfma_f32_16x16x32_bf16 v[32:35], a[80:83], v[84:87], v[32:35]
    ds_read_b128 v[76:79], v3 offset:41984
    v_mfma_f32_16x16x32_bf16 v[36:39], a[84:87], v[84:87], v[36:39]
    v_exp_f32 v30, v30
    v_mfma_f32_16x16x32_bf16 v[40:43], a[88:91], v[84:87], v[40:43]
    v_exp_f32 v31, v31
    v_mfma_f32_16x16x32_bf16 v[44:47], a[92:95], v[84:87], v[44:47]
    v_fma_f32 v56, v104, v12, v56
    v_fma_f32 v57, v105, v12, v57
    s_waitcnt lgkmcnt(3)
    v_mfma_f32_16x16x32_bf16 v[32:35], a[96:99], v[64:67], v[32:35]
    ds_read_b128 v[80:83], v3 offset:43008
    v_mfma_f32_16x16x32_bf16 v[36:39], a[100:103], v[64:67], v[36:39]
    v_fma_f32 v58, v106, v12, v58
    v_fma_f32 v59, v107, v12, v59
    v_mfma_f32_16x16x32_bf16 v[40:43], a[104:107], v[64:67], v[40:43]
    v_fma_f32 v60, v108, v12, v60
    v_fma_f32 v61, v109, v12, v61
    v_mfma_f32_16x16x32_bf16 v[44:47], a[108:111], v[64:67], v[44:47]
    v_fma_f32 v62, v110, v12, v62
    v_fma_f32 v63, v111, v12, v63
    s_waitcnt lgkmcnt(3)
    v_mfma_f32_16x16x32_bf16 v[32:35], a[112:115], v[68:71], v[32:35]
    ds_read_b128 v[84:87], v3 offset:44032
    v_mfma_f32_16x16x32_bf16 v[36:39], a[116:119], v[68:71], v[36:39]
    v_fma_f32 v24, v24, v14, v14
    v_fma_f32 v25, v25, v14, v14
    v_mfma_f32_16x16x32_bf16 v[40:43], a[120:123], v[68:71], v[40:43]
    v_fma_f32 v26, v26, v14, v14
    v_fma_f32 v27, v27, v14, v14
    v_mfma_f32_16x16x32_bf16 v[44:47], a[124:127], v[68:71], v[44:47]
    v_fma_f32 v28, v28, v14, v14
    v_fma_f32 v29, v29, v14, v14
    s_waitcnt lgkmcnt(3)
    v_mfma_f32_16x16x32_bf16 v[32:35], a[128:131], v[72:75], v[32:35]
    ds_read_b128 v[64:67], v3 offset:45056
    v_mfma_f32_16x16x32_bf16 v[36:39], a[132:135], v[72:75], v[36:39]
    v_fma_f32 v30, v30, v14, v14
    v_fma_f32 v31, v31, v14, v14
    v_mfma_f32_16x16x32_bf16 v[40:43], a[136:139], v[72:75], v[40:43]
    v_rcp_f32 v24, v24
    v_mfma_f32_16x16x32_bf16 v[44:47], a[140:143], v[72:75], v[44:47]
    v_rcp_f32 v25, v25
    s_waitcnt lgkmcnt(3)
    v_mfma_f32_16x16x32_bf16 v[32:35], a[144:147], v[76:79], v[32:35]
    ds_read_b128 v[68:71], v3 offset:46080
    v_mfma_f32_16x16x32_bf16 v[36:39], a[148:151], v[76:79], v[36:39]
    v_rcp_f32 v26, v26
    v_mfma_f32_16x16x32_bf16 v[40:43], a[152:155], v[76:79], v[40:43]
    v_rcp_f32 v27, v27
    v_mfma_f32_16x16x32_bf16 v[44:47], a[156:159], v[76:79], v[44:47]
    v_rcp_f32 v28, v28
    s_waitcnt lgkmcnt(3)
    v_mfma_f32_16x16x32_bf16 v[32:35], a[160:163], v[80:83], v[32:35]
    ds_read_b128 v[72:75], v3 offset:47104
    v_mfma_f32_16x16x32_bf16 v[36:39], a[164:167], v[80:83], v[36:39]
    v_rcp_f32 v29, v29
    v_mfma_f32_16x16x32_bf16 v[40:43], a[168:171], v[80:83], v[40:43]
    v_rcp_f32 v30, v30
    v_mfma_f32_16x16x32_bf16 v[44:47], a[172:175], v[80:83], v[44:47]
    v_rcp_f32 v31, v31
    s_waitcnt lgkmcnt(3)
    v_mfma_f32_16x16x32_bf16 v[32:35], a[176:179], v[84:87], v[32:35]
    ds_read_b128 v[76:79], v3 offset:48128
    v_mfma_f32_16x16x32_bf16 v[36:39], a[180:183], v[84:87], v[36:39]
    v_mul_f32 v48, v48, v56
    v_mul_f32 v49, v49, v57
    v_mfma_f32_16x16x32_bf16 v[40:43], a[184:187], v[84:87], v[40:43]
    v_mul_f32 v50, v50, v58
    v_mul_f32 v51, v51, v59
    v_mfma_f32_16x16x32_bf16 v[44:47], a[188:191], v[84:87], v[44:47]
    v_mul_f32 v52, v52, v60
    v_mul_f32 v53, v53, v61
    s_waitcnt lgkmcnt(3)
    v_mfma_f32_16x16x32_bf16 v[32:35], a[192:195], v[64:67], v[32:35]
    s_barrier
    ds_read_b128 v[80:83], v3 offset:49152
    v_mfma_f32_16x16x32_bf16 v[36:39], a[196:199], v[64:67], v[36:39]
    v_mul_f32 v54, v54, v62
    v_mul_f32 v55, v55, v63
    v_mfma_f32_16x16x32_bf16 v[40:43], a[200:203], v[64:67], v[40:43]
    v_mul_f32 v48, v48, v24
    v_mul_f32 v49, v49, v25
    v_mfma_f32_16x16x32_bf16 v[44:47], a[204:207], v[64:67], v[44:47]
    v_mul_f32 v50, v50, v26
    v_mul_f32 v51, v51, v27
    s_waitcnt lgkmcnt(3)
    v_mfma_f32_16x16x32_bf16 v[32:35], a[208:211], v[68:71], v[32:35]
    ds_read_b128 v[84:87], v3 offset:50176
    ds_read_b96 v[8:10], v7 offset:1536
    v_mfma_f32_16x16x32_bf16 v[36:39], a[212:215], v[68:71], v[36:39]
    v_mul_f32 v52, v52, v28
    v_mul_f32 v53, v53, v29
    v_mfma_f32_16x16x32_bf16 v[40:43], a[216:219], v[68:71], v[40:43]
    v_mul_f32 v54, v54, v30
    v_mul_f32 v55, v55, v31
    v_mfma_f32_16x16x32_bf16 v[44:47], a[220:223], v[68:71], v[44:47]
    v_cvt_pk_bf16_f32 v88, v48, v49
    v_cvt_pk_bf16_f32 v89, v50, v51
    s_waitcnt lgkmcnt(4)
    v_mfma_f32_16x16x32_bf16 v[32:35], a[224:227], v[72:75], v[32:35]
    ds_read_b128 v[64:67], v3 offset:51200
    buffer_load_dword v15, v5, s[4:7], s57 offen offset:0 sc1
    v_mfma_f32_16x16x32_bf16 v[36:39], a[228:231], v[72:75], v[36:39]
    v_cvt_pk_bf16_f32 v90, v52, v53
    v_cvt_pk_bf16_f32 v91, v54, v55
    v_mfma_f32_16x16x32_bf16 v[40:43], a[232:235], v[72:75], v[40:43]
    v_mfma_f32_16x16x32_bf16 v[44:47], a[236:239], v[72:75], v[44:47]
    s_waitcnt lgkmcnt(4)
    v_mfma_f32_16x16x32_bf16 v[32:35], a[240:243], v[76:79], v[32:35]
    ds_read_b128 v[68:71], v3 offset:52224
    v_mfma_f32_16x16x32_bf16 v[36:39], a[244:247], v[76:79], v[36:39]
    v_mfma_f32_16x16x32_bf16 v[40:43], a[248:251], v[76:79], v[40:43]
    v_mfma_f32_16x16x32_bf16 v[44:47], a[252:255], v[76:79], v[44:47]
    s_waitcnt lgkmcnt(4)
    v_mfma_f32_16x16x32_bf16 v[48:51], a[0:3], v[80:83], 0
    ds_read_b128 v[72:75], v3 offset:53248
    s_waitcnt vmcnt(1)
    v_cmp_gt_u32 vcc, s67, v0
    s_cmp_eq_u64 vcc, 0
    s_nop 3
    s_cbranch_scc1 L_pok_61
    s_mov_b32 s39, 20000
L_poll_62:
    buffer_load_dword v0, v5, s[4:7], s57 offen offset:0 sc1
    s_waitcnt vmcnt(0)
    v_cmp_gt_u32 vcc, s67, v0
    s_sub_u32 s39, s39, 1
    s_nop 3
    s_cbranch_scc1 L_pollx_63
    s_cmp_lg_u64 vcc, 0
    s_cbranch_scc1 L_poll_62
L_pollx_63:
L_pok_61:
    v_mfma_f32_16x16x32_bf16 v[52:55], a[4:7], v[80:83], 0
    v_mfma_f32_16x16x32_bf16 v[56:59], a[8:11], v[80:83], 0
    s_waitcnt lgkmcnt(3)
    v_fma_f32 v32, v96, v8, v32
    v_fma_f32 v33, v97, v8, v33
    v_mfma_f32_16x16x32_bf16 v[60:63], a[12:15], v[80:83], 0
    v_fma_f32 v34, v98, v8, v34
    v_fma_f32 v35, v99, v8, v35
    v_mfma_f32_16x16x32_bf16 v[48:51], a[16:19], v[84:87], v[48:51]
    ds_read_b128 v[76:79], v3 offset:54272
    s_add_u32 s66, s58, 0x0
    buffer_load_dwordx4 a[0:3], v2, s[4:7], s66 offen offset:0
    s_add_u32 s66, s58, 0x0
    buffer_load_dwordx4 a[4:7], v2, s[4:7], s66 offen offset:1024
    v_mfma_f32_16x16x32_bf16 v[52:55], a[20:23], v[84:87], v[52:55]
    v_fma_f32 v36, v100, v8, v36
    v_fma_f32 v37, v101, v8, v37
    v_mfma_f32_16x16x32_bf16 v[56:59], a[24:27], v[84:87], v[56:59]
    v_fma_f32 v38, v102, v8, v38
    v_fma_f32 v39, v103, v8, v39
    v_mfma_f32_16x16x32_bf16 v[60:63], a[28:31], v[84:87], v[60:63]
    v_mul_f32 v24, v32, v9
    v_mul_f32 v25, v33, v9
    s_waitcnt lgkmcnt(3)
    v_mfma_f32_16x16x32_bf16 v[48:51], a[32:35], v[64:67], v[48:51]
    ds_read_b128 v[80:83], v3 offset:55296
    s_add_u32 s66, s58, 0x0
    buffer_load_dwordx4 a[8:11], v2, s[4:7], s66 offen offset:2048
    s_add_u32 s66, s58, 0x0
    buffer_load_dwordx4 a[12:15], v2, s[4:7], s66 offen offset:3072
    v_mfma_f32_16x16x32_bf16 v[52:55], a[36:39], v[64:67], v[52:55]
    v_mul_f32 v26, v34, v9
    v_mul_f32 v27, v35, v9
    v_mfma_f32_16x16x32_bf16 v[56:59], a[40:43], v[64:67], v[56:59]
    v_mul_f32 v28, v36, v9
    v_mul_f32 v29, v37, v9
    v_mfma_f32_16x16x32_bf16 v[60:63], a[44:47], v[64:67], v[60:63]
    v_mul_f32 v30, v38, v9
    v_mul_f32 v31, v39, v9
    s_waitcnt lgkmcnt(3)
    v_mfma_f32_16x16x32_bf16 v[48:51], a[48:51], v[68:71], v[48:51]
    ds_read_b128 v[84:87], v3 offset:56320
    s_add_u32 s66, s58, 0x1000
    buffer_load_dwordx4 a[16:19], v2, s[4:7], s66 offen offset:0
    s_add_u32 s66, s58, 0x1000
    buffer_load_dwordx4 a[20:23], v2, s[4:7], s66 offen offset:1024
    v_mfma_f32_16x16x32_bf16 v[52:55], a[52:55], v[68:71], v[52:55]
    v_exp_f32 v24, v24
    v_mfma_f32_16x16x32_bf16 v[56:59], a[56:59], v[68:71], v[56:59]
    v_exp_f32 v25, v25
    v_mfma_f32_16x16x32_bf16 v[60:63], a[60:63], v[68:71], v[60:63]
    v_exp_f32 v26, v26
    s_waitcnt lgkmcnt(3)
    v_mfma_f32_16x16x32_bf16 v[48:51], a[64:67], v[72:75], v[48:51]
    ds_read_b128 v[64:67], v3 offset:57344
    s_add_u32 s66, s58, 0x1000
    buffer_load_dwordx4 a[24:27], v2, s[4:7], s66 offen offset:2048
    s_add_u32 s66, s58, 0x1000
    buffer_load_dwordx4 a[28:31], v2, s[4:7], s66 offen offset:3072
    v_mfma_f32_16x16x32_bf16 v[52:55], a[68:71], v[72:75], v[52:55]
    v_exp_f32 v27, v27
    v_mfma_f32_16x16x32_bf16 v[56:59], a[72:75], v[72:75], v[56:59]
    v_exp_f32 v28, v28
    v_mfma_f32_16x16x32_bf16 v[60:63], a[76:79], v[72:75], v[60:63]
    v_exp_f32 v29, v29
    s_waitcnt lgkmcnt(3)
    v_mfma_f32_16x16x32_bf16 v[48:51], a[80:83], v[76:79], v[48:51]
    ds_read_b128 v[68:71], v3 offset:58368
    s_add_u32 s66, s58, 0x2000
    buffer_load_dwordx4 a[32:35], v2, s[4:7], s66 offen offset:0
    s_add_u32 s66, s58, 0x2000
    buffer_load_dwordx4 a[36:39], v2, s[4:7], s66 offen offset:1024
    ds_read_b128 a[56:59], v11 offset:0
    ds_read_b128 a[60:63], v11 offset:1024
    v_mfma_f32_16x16x32_bf16 v[52:55], a[84:87], v[76:79], v[52:55]
    v_exp_f32 v30, v30
    v_mfma_f32_16x16x32_bf16 v[56:59], a[88:91], v[76:79], v[56:59]
    v_exp_f32 v31, v31
    v_mfma_f32_16x16x32_bf16 v[60:63], a[92:95], v[76:79], v[60:63]
    v_fma_f32 v40, v104, v8, v40
    v_fma_f32 v41, v105, v8, v41
    s_waitcnt lgkmcnt(5)
    v_mfma_f32_16x16x32_bf16 v[48:51], a[96:99], v[80:83], v[48:51]
    ds_read_b128 v[72:75], v3 offset:59392
    s_add_u32 s66, s58, 0x2000
    buffer_load_dwordx4 a[40:43], v2, s[4:7], s66 offen offset:2048
    s_add_u32 s66, s58, 0x2000
    buffer_load_dwordx4 a[44:47], v2, s[4:7], s66 offen offset:3072
    ds_read_b128 a[64:67], v11 offset:2048
    ds_read_b128 a[68:71], v11 offset:3072
    v_mfma_f32_16x16x32_bf16 v[52:55], a[100:103], v[80:83], v[52:55]
    v_fma_f32 v42, v106, v8, v42
    v_fma_f32 v43, v107, v8, v43
    v_mfma_f32_16x16x32_bf16 v[56:59], a[104:107], v[80:83], v[56:59]
    v_fma_f32 v44, v108, v8, v44
    v_fma_f32 v45, v109, v8, v45
    v_mfma_f32_16x16x32_bf16 v[60:63], a[108:111], v[80:83], v[60:63]
    v_fma_f32 v46, v110, v8, v46
    v_fma_f32 v47, v111, v8, v47
    s_waitcnt lgkmcnt(7)
    v_mfma_f32_16x16x32_bf16 v[48:51], a[112:115], v[84:87], v[48:51]
    ds_read_b128 v[76:79], v3 offset:60416
    s_add_u32 s66, s58, 0x3000
    buffer_load_dwordx4 a[48:51], v2, s[4:7], s66 offen offset:0
    s_add_u32 s66, s58, 0x3000
    buffer_load_dwordx4 a[52:55], v2, s[4:7], s66 offen offset:1024
    ds_read_b128 a[72:75], v11 offset:16384
    ds_read_b128 a[76:79], v11 offset:17408
    v_mfma_f32_16x16x32_bf16 v[52:55], a[116:119], v[84:87], v[52:55]
    v_fma_f32 v24, v24, v10, v10
    v_fma_f32 v25, v25, v10, v10
    v_mfma_f32_16x16x32_bf16 v[56:59], a[120:123], v[84:87], v[56:59]
    v_fma_f32 v26, v26, v10, v10
    v_fma_f32 v27, v27, v10, v10
    v_mfma_f32_16x16x32_bf16 v[60:63], a[124:127], v[84:87], v[60:63]
    v_fma_f32 v28, v28, v10, v10
    v_fma_f32 v29, v29, v10, v10
    s_waitcnt lgkmcnt(9)
    v_mfma_f32_16x16x32_bf16 v[48:51], a[128:131], v[64:67], v[48:51]
    ds_read_b128 v[80:83], v3 offset:61440
    ds_read_b128 a[80:83], v11 offset:18432
    ds_read_b128 a[84:87], v11 offset:19456
    v_mfma_f32_16x16x32_bf16 v[52:55], a[132:135], v[64:67], v[52:55]
    v_fma_f32 v30, v30, v10, v10
    v_fma_f32 v31, v31, v10, v10
    v_mfma_f32_16x16x32_bf16 v[56:59], a[136:139], v[64:67], v[56:59]
    v_rcp_f32 v24, v24
    v_mfma_f32_16x16x32_bf16 v[60:63], a[140:143], v[64:67], v[60:63]
    v_rcp_f32 v25, v25
    s_waitcnt lgkmcnt(11)
    v_mfma_f32_16x16x32_bf16 v[48:51], a[144:147], v[68:71], v[48:51]
    ds_read_b128 v[84:87], v3 offset:62464
    s_waitcnt vmcnt(14)
    v_cmp_gt_u32 vcc, s68, v15
    s_cmp_eq_u64 vcc, 0
    s_nop 3
    s_cbranch_scc1 L_pok_64
    s_mov_b32 s39, 20000
L_poll_65:
    buffer_load_dword v15, v5, s[4:7], s57 offen offset:0 sc1
    s_waitcnt vmcnt(0)
    v_cmp_gt_u32 vcc, s68, v15
    s_sub_u32 s39, s39, 1
    s_nop 3
    s_cbranch_scc1 L_pollx_66
    s_cmp_lg_u64 vcc, 0
    s_cbranch_scc1 L_poll_65
L_pollx_66:
L_pok_64:
    s_add_u32 s66, s58, 0x1c000
    buffer_load_dwordx4 a[136:139], v2, s[4:7], s66 offen offset:0
    s_add_u32 s66, s58, 0x1c000
    buffer_load_dwordx4 a[140:143], v2, s[4:7], s66 offen offset:1024
    ds_read_b128 a[88:91], v11 offset:32768
    ds_read_b128 a[92:95], v11 offset:33792
    v_mfma_f32_16x16x32_bf16 v[52:55], a[148:151], v[68:71], v[52:55]
    v_rcp_f32 v26, v26
    v_mfma_f32_16x16x32_bf16 v[56:59], a[152:155], v[68:71], v[56:59]
    v_rcp_f32 v27, v27
    v_mfma_f32_16x16x32_bf16 v[60:63], a[156:159], v[68:71], v[60:63]
    v_rcp_f32 v28, v28
    s_waitcnt lgkmcnt(11)
    v_mfma_f32_16x16x32_bf16 v[48:51], a[160:163], v[72:75], v[48:51]
    ds_read_b128 v[64:67], v3 offset:63488
    s_add_u32 s66, s58, 0x1c000
    buffer_load_dwordx4 a[144:147], v2, s[4:7], s66 offen offset:2048
    s_add_u32 s66, s58, 0x1c000
    buffer_load_dwordx4 a[148:151], v2, s[4:7], s66 offen offset:3072
    ds_read_b128 a[96:99], v11 offset:34816
    ds_read_b128 a[100:103], v11 offset:35840
    v_mfma_f32_16x16x32_bf16 v[52:55], a[164:167], v[72:75], v[52:55]
    v_rcp_f32 v29, v29
    v_mfma_f32_16x16x32_bf16 v[56:59], a[168:171], v[72:75], v[56:59]
    v_rcp_f32 v30, v30
    v_mfma_f32_16x16x32_bf16 v[60:63], a[172:175], v[72:75], v[60:63]
    v_rcp_f32 v31, v31
    s_waitcnt lgkmcnt(11)
    v_mfma_f32_16x16x32_bf16 v[48:51], a[176:179], v[76:79], v[48:51]
    ds_read_b128 v[68:71], v3 offset:64512
    s_add_u32 s66, s58, 0x1d000
    buffer_load_dwordx4 a[152:155], v2, s[4:7], s66 offen offset:0
    s_add_u32 s66, s58, 0x1d000
    buffer_load_dwordx4 a[156:159], v2, s[4:7], s66 offen offset:1024
    ds_read_b128 a[104:107], v11 offset:49152
    ds_read_b128 a[108:111], v11 offset:50176
    v_mfma_f32_16x16x32_bf16 v[52:55], a[180:183], v[76:79], v[52:55]
    v_mul_f32 v32, v32, v40
    v_mul_f32 v33, v33, v41
    v_mfma_f32_16x16x32_bf16 v[56:59], a[184:187], v[76:79], v[56:59]
    v_mul_f32 v34, v34, v42
    v_mul_f32 v35, v35, v43
    v_mfma_f32_16x16x32_bf16 v[60:63], a[188:191], v[76:79], v[60:63]
    v_mul_f32 v36, v36, v44
    v_mul_f32 v37, v37, v45
    s_waitcnt lgkmcnt(11)
    v_mfma_f32_16x16x32_bf16 v[48:51], a[192:195], v[80:83], v[48:51]
    s_add_u32 s66, s58, 0x1d000
    buffer_load_dwordx4 a[160:163], v2, s[4:7], s66 offen offset:2048
    s_add_u32 s66, s58, 0x1d000
    buffer_load_dwordx4 a[164:167], v2, s[4:7], s66 offen offset:3072
    ds_read_b128 a[112:115], v11 offset:51200
    ds_read_b128 a[116:119], v11 offset:52224
    v_mfma_f32_16x16x32_bf16 v[52:55], a[196:199], v[80:83], v[52:55]
    v_mul_f32 v38, v38, v46
    v_mul_f32 v39, v39, v47
    v_mfma_f32_16x16x32_bf16 v[56:59], a[200:203], v[80:83], v[56:59]
    v_mul_f32 v32, v32, v24
    v_mul_f32 v33, v33, v25
    v_mfma_f32_16x16x32_bf16 v[60:63], a[204:207], v[80:83], v[60:63]
    v_mul_f32 v34, v34, v26
    v_mul_f32 v35, v35, v27
    s_waitcnt lgkmcnt(10)
    v_mfma_f32_16x16x32_bf16 v[48:51], a[208:211], v[84:87], v[48:51]
    s_add_u32 s66, s58, 0x1e000
    buffer_load_dwordx4 a[168:171], v2, s[4:7], s66 offen offset:0
    s_add_u32 s66, s58, 0x1e000
    buffer_load_dwordx4 a[172:175], v2, s[4:7], s66 offen offset:1024
    ds_read_b128 a[120:123], v4 offset:0
    ds_read_b128 a[124:127], v4 offset:1024
    ds_read_b96 v[12:14], v7 offset:1792
    v_mfma_f32_16x16x32_bf16 v[52:55], a[212:215], v[84:87], v[52:55]
    v_mul_f32 v36, v36, v28
    v_mul_f32 v37, v37, v29
    v_mfma_f32_16x16x32_bf16 v[56:59], a[216:219], v[84:87], v[56:59]
    v_mul_f32 v38, v38, v30
    v_mul_f32 v39, v39, v31
    v_mfma_f32_16x16x32_bf16 v[60:63], a[220:223], v[84:87], v[60:63]
    v_cvt_pk_bf16_f32 v40, v32, v33
    v_cvt_pk_bf16_f32 v41, v34, v35
    s_waitcnt lgkmcnt(10)
    v_mfma_f32_16x16x32_bf16 v[48:51], a[224:227], v[64:67], v[48:51]
    s_add_u32 s66, s58, 0x1e000
    buffer_load_dwordx4 a[176:179], v2, s[4:7], s66 offen offset:2048
    s_add_u32 s66, s58, 0x1e000
    buffer_load_dwordx4 a[180:183], v2, s[4:7], s66 offen offset:3072
    ds_read_b128 a[128:131], v4 offset:2048
    ds_read_b128 a[132:135], v4 offset:3072
    v_mfma_f32_16x16x32_bf16 v[52:55], a[228:231], v[64:67], v[52:55]
    v_cvt_pk_bf16_f32 v42, v36, v37
    v_cvt_pk_bf16_f32 v43, v38, v39
    v_mfma_f32_16x16x32_bf16 v[56:59], a[232:235], v[64:67], v[56:59]
    v_mfma_f32_16x16x32_bf16 v[60:63], a[236:239], v[64:67], v[60:63]
    s_waitcnt lgkmcnt(9)
    v_mfma_f32_16x16x32_bf16 v[48:51], a[240:243], v[68:71], v[48:51]
    s_add_u32 s66, s58, 0x1f000
    buffer_load_dwordx4 a[184:187], v2, s[4:7], s66 offen offset:0
    s_add_u32 s66, s58, 0x1f000
    buffer_load_dwordx4 a[188:191], v2, s[4:7], s66 offen offset:1024
    v_mfma_f32_16x16x32_bf16 v[52:55], a[244:247], v[68:71], v[52:55]
    v_mfma_f32_16x16x32_bf16 v[56:59], a[248:251], v[68:71], v[56:59]
    v_mfma_f32_16x16x32_bf16 v[60:63], a[252:255], v[68:71], v[60:63]
    s_add_u32 s66, s53, 0x46000
    buffer_store_dwordx4 v[88:91], v2, s[4:7], s66 offen sc1
    s_add_u32 s66, s53, 0x54000
    buffer_store_dwordx4 v[40:43], v2, s[4:7], s66 offen sc1
    s_waitcnt lgkmcnt(2)
    v_pk_fma_f32 v[48:49], v[96:97], v[12:13], v[48:49] op_sel:[0,0,0] op_sel_hi:[1,0,1]
    v_pk_fma_f32 v[50:51], v[98:99], v[12:13], v[50:51] op_sel:[0,0,0] op_sel_hi:[1,0,1]
    v_pk_fma_f32 v[52:53], v[100:101], v[12:13], v[52:53] op_sel:[0,0,0] op_sel_hi:[1,0,1]
    v_pk_fma_f32 v[54:55], v[102:103], v[12:13], v[54:55] op_sel:[0,0,0] op_sel_hi:[1,0,1]
    v_pk_mul_f32 v[24:25], v[48:49], v[12:13] op_sel:[0,1] op_sel_hi:[1,1]
    v_pk_mul_f32 v[26:27], v[50:51], v[12:13] op_sel:[0,1] op_sel_hi:[1,1]
    v_pk_mul_f32 v[28:29], v[52:53], v[12:13] op_sel:[0,1] op_sel_hi:[1,1]
    v_pk_mul_f32 v[30:31], v[54:55], v[12:13] op_sel:[0,1] op_sel_hi:[1,1]
    v_exp_f32 v24, v24
    v_pk_fma_f32 v[56:57], v[104:105], v[12:13], v[56:57] op_sel:[0,0,0] op_sel_hi:[1,0,1]
    v_exp_f32 v25, v25
    v_exp_f32 v26, v26
    v_pk_fma_f32 v[58:59], v[106:107], v[12:13], v[58:59] op_sel:[0,0,0] op_sel_hi:[1,0,1]
    v_exp_f32 v27, v27
    v_exp_f32 v28, v28
    v_pk_fma_f32 v[60:61], v[108:109], v[12:13], v[60:61] op_sel:[0,0,0] op_sel_hi:[1,0,1]
    v_exp_f32 v29, v29
    v_exp_f32 v30, v30
    v_pk_fma_f32 v[62:63], v[110:111], v[12:13], v[62:63] op_sel:[0,0,0] op_sel_hi:[1,0,1]
    v_exp_f32 v31, v31
    v_pk_fma_f32 v[24:25], v[24:25], v[14:15], v[14:15] op_sel:[0,0,0] op_sel_hi:[1,0,0]
    v_pk_fma_f32 v[26:27], v[26:27], v[14:15], v[14:15] op_sel:[0,0,0] op_sel_hi:[1,0,0]
    v_pk_fma_f32 v[28:29], v[28:29], v[14:15], v[14:15] op_sel:[0,0,0] op_sel_hi:[1,0,0]
    v_pk_fma_f32 v[30:31], v[30:31], v[14:15], v[14:15] op_sel:[0,0,0] op_sel_hi:[1,0,0]
    v_rcp_f32 v24, v24
    v_pk_mul_f32 v[48:49], v[48:49], v[56:57] op_sel:[0,0] op_sel_hi:[1,1]
    v_rcp_f32 v25, v25
    v_rcp_f32 v26, v26
    v_pk_mul_f32 v[50:51], v[50:51], v[58:59] op_sel:[0,0] op_sel_hi:[1,1]
    v_rcp_f32 v27, v27
    v_rcp_f32 v28, v28
    v_pk_mul_f32 v[52:53], v[52:53], v[60:61] op_sel:[0,0] op_sel_hi:[1,1]
    v_rcp_f32 v29, v29
    v_rcp_f32 v30, v30
    v_pk_mul_f32 v[54:55], v[54:55], v[62:63] op_sel:[0,0] op_sel_hi:[1,1]
    v_rcp_f32 v31, v31
    v_pk_mul_f32 v[48:49], v[48:49], v[24:25] op_sel:[0,0] op_sel_hi:[1,1]
    v_pk_mul_f32 v[50:51], v[50:51], v[26:27] op_sel:[0,0] op_sel_hi:[1,1]
    v_pk_mul_f32 v[52:53], v[52:53], v[28:29] op_sel:[0,0] op_sel_hi:[1,1]
    v_pk_mul_f32 v[54:55], v[54:55], v[30:31] op_sel:[0,0] op_sel_hi:[1,1]
    v_cvt_pk_bf16_f32 v56, v48, v49
    v_cvt_pk_bf16_f32 v57, v50, v51
    v_cvt_pk_bf16_f32 v58, v52, v53
    v_cvt_pk_bf16_f32 v59, v54, v55
    s_add_u32 s66, s53, 0x62000
    buffer_store_dwordx4 v[56:59], v2, s[4:7], s66 offen sc1
    v_mov_b32 v15, 8
    s_mov_b64 exec, 1
    buffer_store_dword v15, off, s[4:7], s54 offset:0 sc1
    s_mov_b64 exec, -1
    s_lshl_b32 s32, s3, 11
    s_add_u32 s32, s32, 98304
    v_add_u32 v3, s32, v2
    s_lshl_b32 s32, s3, 13
    s_add_u32 s32, s32, 98304
    v_add_u32 v4, s32, v2
    v_and_b32 v6, 15, v1
    v_lshlrev_b32 v6, 10, v6
    v_bfe_u32 v7, v1, 4, 1
    v_lshl_add_u32 v6, v7, 5, v6
    v_lshrrev_b32 v7, 5, v1
    v_lshl_add_u32 v6, v7, 4, v6
    s_lshl_b32 s32, s18, 3
    s_add_u32 s32, s32, s19
    s_and_b32 s33, s3, 2
    s_add_u32 s32, s32, s33
    s_lshl_b32 s32, s32, 14
    s_lshl_b32 s33, s20, 7
    s_add_u32 s32, s32, s33
    s_and_b32 s33, s3, 1
    s_lshl_b32 s33, s33, 6
    s_add_u32 s64, s32, s33
    s_waitcnt vmcnt(31)
    v_mfma_f32_16x16x32_bf16 v[64:67], v[112:115], a[0:3], 0
    v_mfma_f32_16x16x32_bf16 v[68:71], v[116:119], a[0:3], 0
    v_mfma_f32_16x16x32_bf16 v[72:75], v[120:123], a[0:3], 0
    v_mfma_f32_16x16x32_bf16 v[76:79], v[124:127], a[0:3], 0
    s_waitcnt vmcnt(30)
    v_mfma_f32_16x16x32_bf16 v[64:67], v[128:131], a[4:7], v[64:67]
    v_mfma_f32_16x16x32_bf16 v[68:71], v[132:135], a[4:7], v[68:71]
    v_mfma_f32_16x16x32_bf16 v[72:75], v[136:139], a[4:7], v[72:75]
    v_mfma_f32_16x16x32_bf16 v[76:79], v[140:143], a[4:7], v[76:79]
    s_waitcnt vmcnt(29)
    v_mfma_f32_16x16x32_bf16 v[64:67], v[144:147], a[8:11], v[64:67]
    v_mfma_f32_16x16x32_bf16 v[68:71], v[148:151], a[8:11], v[68:71]
    v_mfma_f32_16x16x32_bf16 v[72:75], v[152:155], a[8:11], v[72:75]
    v_mfma_f32_16x16x32_bf16 v[76:79], v[156:159], a[8:11], v[76:79]
    s_waitcnt vmcnt(28)
    v_mfma_f32_16x16x32_bf16 v[64:67], v[160:163], a[12:15], v[64:67]
    v_mfma_f32_16x16x32_bf16 v[68:71], v[164:167], a[12:15], v[68:71]
    v_mfma_f32_16x16x32_bf16 v[72:75], v[168:171], a[12:15], v[72:75]
    v_mfma_f32_16x16x32_bf16 v[76:79], v[172:175], a[12:15], v[76:79]
    s_waitcnt vmcnt(27)
    v_mfma_f32_16x16x32_bf16 v[64:67], v[176:179], a[16:19], v[64:67]
    v_mfma_f32_16x16x32_bf16 v[68:71], v[180:183], a[16:19], v[68:71]
    v_mfma_f32_16x16x32_bf16 v[72:75], v[184:187], a[16:19], v[72:75]
    v_mfma_f32_16x16x32_bf16 v[76:79], v[188:191], a[16:19], v[76:79]
    s_waitcnt vmcnt(26)
    v_mfma_f32_16x16x32_bf16 v[64:67], v[192:195], a[20:23], v[64:67]
    v_mfma_f32_16x16x32_bf16 v[68:71], v[196:199], a[20:23], v[68:71]
    v_mfma_f32_16x16x32_bf16 v[72:75], v[200:203], a[20:23], v[72:75]
    v_mfma_f32_16x16x32_bf16 v[76:79], v[204:207], a[20:23], v[76:79]
    s_waitcnt vmcnt(25)
    v_mfma_f32_16x16x32_bf16 v[64:67], v[208:211], a[24:27], v[64:67]
    v_mfma_f32_16x16x32_bf16 v[68:71], v[212:215], a[24:27], v[68:71]
    v_mfma_f32_16x16x32_bf16 v[72:75], v[216:219], a[24:27], v[72:75]
    v_mfma_f32_16x16x32_bf16 v[76:79], v[220:223], a[24:27], v[76:79]
    s_waitcnt vmcnt(24)
    v_mfma_f32_16x16x32_bf16 v[64:67], v[224:227], a[28:31], v[64:67]
    v_mfma_f32_16x16x32_bf16 v[68:71], v[228:231], a[28:31], v[68:71]
    v_mfma_f32_16x16x32_bf16 v[72:75], v[232:235], a[28:31], v[72:75]
    v_mfma_f32_16x16x32_bf16 v[76:79], v[236:239], a[28:31], v[76:79]
    s_waitcnt vmcnt(23)
    v_mfma_f32_16x16x32_bf16 v[64:67], v[240:243], a[32:35], v[64:67]
    v_mfma_f32_16x16x32_bf16 v[68:71], v[244:247], a[32:35], v[68:71]
    v_mfma_f32_16x16x32_bf16 v[72:75], v[248:251], a[32:35], v[72:75]
    v_mfma_f32_16x16x32_bf16 v[76:79], v[252:255], a[32:35], v[76:79]
    s_waitcnt vmcnt(22)
    v_mfma_f32_16x16x32_bf16 v[64:67], a[56:59], a[36:39], v[64:67]
    v_mfma_f32_16x16x32_bf16 v[68:71], a[60:63], a[36:39], v[68:71]
    v_mfma_f32_16x16x32_bf16 v[72:75], a[64:67], a[36:39], v[72:75]
    v_mfma_f32_16x16x32_bf16 v[76:79], a[68:71], a[36:39], v[76:79]
    s_waitcnt vmcnt(21)
    v_mfma_f32_16x16x32_bf16 v[64:67], a[72:75], a[40:43], v[64:67]
    v_mfma_f32_16x16x32_bf16 v[68:71], a[76:79], a[40:43], v[68:71]
    v_mfma_f32_16x16x32_bf16 v[72:75], a[80:83], a[40:43], v[72:75]
    v_mfma_f32_16x16x32_bf16 v[76:79], a[84:87], a[40:43], v[76:79]
    s_waitcnt vmcnt(20)
    v_mfma_f32_16x16x32_bf16 v[64:67], a[88:91], a[44:47], v[64:67]
    v_mfma_f32_16x16x32_bf16 v[68:71], a[92:95], a[44:47], v[68:71]
    v_mfma_f32_16x16x32_bf16 v[72:75], a[96:99], a[44:47], v[72:75]
    v_mfma_f32_16x16x32_bf16 v[76:79], a[100:103], a[44:47], v[76:79]
    s_waitcnt vmcnt(19)
    v_mfma_f32_16x16x32_bf16 v[64:67], a[104:107], a[48:51], v[64:67]
    v_mfma_f32_16x16x32_bf16 v[68:71], a[108:111], a[48:51], v[68:71]
    v_mfma_f32_16x16x32_bf16 v[72:75], a[112:115], a[48:51], v[72:75]
    v_mfma_f32_16x16x32_bf16 v[76:79], a[116:119], a[48:51], v[76:79]
    s_waitcnt vmcnt(18)
    s_waitcnt lgkmcnt(0)
    v_mfma_f32_16x16x32_bf16 v[64:67], a[120:123], a[52:55], v[64:67]
    v_mfma_f32_16x16x32_bf16 v[68:71], a[124:127], a[52:55], v[68:71]
    v_mfma_f32_16x16x32_bf16 v[72:75], a[128:131], a[52:55], v[72:75]
    v_mfma_f32_16x16x32_bf16 v[76:79], a[132:135], a[52:55], v[76:79]
    s_barrier
    s_waitcnt vmcnt(17)
    v_mfma_f32_16x16x32_bf16 v[80:83], v[112:115], a[136:139], 0
    v_mfma_f32_16x16x32_bf16 v[84:87], v[116:119], a[136:139], 0
    v_mfma_f32_16x16x32_bf16 v[88:91], v[120:123], a[136:139], 0
    v_mfma_f32_16x16x32_bf16 v[92:95], v[124:127], a[136:139], 0
    ds_write_b128 v3, v[64:67] offset:0
    ds_write_b128 v3, v[68:71] offset:1024
    s_waitcnt vmcnt(16)
    v_mfma_f32_16x16x32_bf16 v[80:83], v[128:131], a[140:143], v[80:83]
    ds_write_b128 v3, v[72:75] offset:8192
    ds_write_b128 v3, v[76:79] offset:9216
    v_mfma_f32_16x16x32_bf16 v[84:87], v[132:135], a[140:143], v[84:87]
    v_mfma_f32_16x16x32_bf16 v[88:91], v[136:139], a[140:143], v[88:91]
    v_mfma_f32_16x16x32_bf16 v[92:95], v[140:143], a[140:143], v[92:95]
    s_waitcnt vmcnt(15)
    v_mfma_f32_16x16x32_bf16 v[80:83], v[144:147], a[144:147], v[80:83]
    v_mfma_f32_16x16x32_bf16 v[84:87], v[148:151], a[144:147], v[84:87]
    v_mfma_f32_16x16x32_bf16 v[88:91], v[152:155], a[144:147], v[88:91]
    v_mfma_f32_16x16x32_bf16 v[92:95], v[156:159], a[144:147], v[92:95]
    s_waitcnt vmcnt(14)
    v_mfma_f32_16x16x32_bf16 v[80:83], v[160:163], a[148:151], v[80:83]
    v_mfma_f32_16x16x32_bf16 v[84:87], v[164:167], a[148:151], v[84:87]
    v_mfma_f32_16x16x32_bf16 v[88:91], v[168:171], a[148:151], v[88:91]
    v_mfma_f32_16x16x32_bf16 v[92:95], v[172:175], a[148:151], v[92:95]
    s_waitcnt vmcnt(13)
    v_mfma_f32_16x16x32_bf16 v[80:83], v[176:179], a[152:155], v[80:83]
    v_mfma_f32_16x16x32_bf16 v[84:87], v[180:183], a[152:155], v[84:87]
    v_mfma_f32_16x16x32_bf16 v[88:91], v[184:187], a[152:155], v[88:91]
    v_mfma_f32_16x16x32_bf16 v[92:95], v[188:191], a[152:155], v[92:95]
    s_waitcnt vmcnt(12)
    v_mfma_f32_16x16x32_bf16 v[80:83], v[192:195], a[156:159], v[80:83]
    v_mfma_f32_16x16x32_bf16 v[84:87], v[196:199], a[156:159], v[84:87]
    v_mfma_f32_16x16x32_bf16 v[88:91], v[200:203], a[156:159], v[88:91]
    v_mfma_f32_16x16x32_bf16 v[92:95], v[204:207], a[156:159], v[92:95]
    s_waitcnt vmcnt(11)
    v_mfma_f32_16x16x32_bf16 v[80:83], v[208:211], a[160:163], v[80:83]
    v_mfma_f32_16x16x32_bf16 v[84:87], v[212:215], a[160:163], v[84:87]
    v_mfma_f32_16x16x32_bf16 v[88:91], v[216:219], a[160:163], v[88:91]
    v_mfma_f32_16x16x32_bf16 v[92:95], v[220:223], a[160:163], v[92:95]
    s_waitcnt vmcnt(10)
    v_mfma_f32_16x16x32_bf16 v[80:83], v[224:227], a[164:167], v[80:83]
    v_mfma_f32_16x16x32_bf16 v[84:87], v[228:231], a[164:167], v[84:87]
    v_mfma_f32_16x16x32_bf16 v[88:91], v[232:235], a[164:167], v[88:91]
    v_mfma_f32_16x16x32_bf16 v[92:95], v[236:239], a[164:167], v[92:95]
    buffer_load_dword v0, v5, s[4:7], s57 offen offset:0 sc1
    s_waitcnt vmcnt(10)
    v_mfma_f32_16x16x32_bf16 v[80:83], v[240:243], a[168:171], v[80:83]
    v_mfma_f32_16x16x32_bf16 v[84:87], v[244:247], a[168:171], v[84:87]
    v_mfma_f32_16x16x32_bf16 v[88:91], v[248:251], a[168:171], v[88:91]
    v_mfma_f32_16x16x32_bf16 v[92:95], v[252:255], a[168:171], v[92:95]
    s_waitcnt vmcnt(9)
    v_mfma_f32_16x16x32_bf16 v[80:83], a[56:59], a[172:175], v[80:83]
    v_mfma_f32_16x16x32_bf16 v[84:87], a[60:63], a[172:175], v[84:87]
    v_mfma_f32_16x16x32_bf16 v[88:91], a[64:67], a[172:175], v[88:91]
    v_mfma_f32_16x16x32_bf16 v[92:95], a[68:71], a[172:175], v[92:95]
    s_waitcnt vmcnt(8)
    v_mfma_f32_16x16x32_bf16 v[80:83], a[72:75], a[176:179], v[80:83]
    v_mfma_f32_16x16x32_bf16 v[84:87], a[76:79], a[176:179], v[84:87]
    v_mfma_f32_16x16x32_bf16 v[88:91], a[80:83], a[176:179], v[88:91]
    v_mfma_f32_16x16x32_bf16 v[92:95], a[84:87], a[176:179], v[92:95]
    s_waitcnt vmcnt(7)
    v_mfma_f32_16x16x32_bf16 v[80:83], a[88:91], a[180:183], v[80:83]
    v_mfma_f32_16x16x32_bf16 v[84:87], a[92:95], a[180:183], v[84:87]
    v_mfma_f32_16x16x32_bf16 v[88:91], a[96:99], a[180:183], v[88:91]
    v_mfma_f32_16x16x32_bf16 v[92:95], a[100:103], a[180:183], v[92:95]
    s_waitcnt vmcnt(6)
    v_mfma_f32_16x16x32_bf16 v[80:83], a[104:107], a[184:187], v[80:83]
    v_mfma_f32_16x16x32_bf16 v[84:87], a[108:111], a[184:187], v[84:87]
    v_mfma_f32_16x16x32_bf16 v[88:91], a[112:115], a[184:187], v[88:91]
    v_mfma_f32_16x16x32_bf16 v[92:95], a[116:119], a[184:187], v[92:95]
    s_waitcnt vmcnt(5)
    v_mfma_f32_16x16x32_bf16 v[80:83], a[120:123], a[188:191], v[80:83]
    v_mfma_f32_16x16x32_bf16 v[84:87], a[124:127], a[188:191], v[84:87]
    v_mfma_f32_16x16x32_bf16 v[88:91], a[128:131], a[188:191], v[88:91]
    v_mfma_f32_16x16x32_bf16 v[92:95], a[132:135], a[188:191], v[92:95]
    s_waitcnt vmcnt(0)
    v_cmp_gt_u32 vcc, 8, v0
    s_cmp_eq_u64 vcc, 0
    s_nop 4
    s_cbranch_scc1 L_pok_67
    s_mov_b32 s39, 20000
L_poll_68:
    buffer_load_dword v0, v5, s[4:7], s57 offen offset:0 sc1
    s_waitcnt vmcnt(0)
    v_cmp_gt_u32 vcc, 8, v0
    s_sub_u32 s39, s39, 1
    s_nop 3
    s_cbranch_scc1 L_pollx_69
    s_cmp_lg_u64 vcc, 0
    s_cbranch_scc1 L_poll_68
L_pollx_69:
L_pok_67:
    s_add_u32 s66, s58, 0x38000
    buffer_load_dwordx4 a[192:195], v2, s[4:7], s66 offen offset:0
    s_add_u32 s66, s58, 0x38000
    buffer_load_dwordx4 a[196:199], v2, s[4:7], s66 offen offset:1024
    s_add_u32 s66, s58, 0x38000
    buffer_load_dwordx4 a[200:203], v2, s[4:7], s66 offen offset:2048
    s_add_u32 s66, s58, 0x38000
    buffer_load_dwordx4 a[204:207], v2, s[4:7], s66 offen offset:3072
    s_add_u32 s66, s58, 0x39000
    buffer_load_dwordx4 a[208:211], v2, s[4:7], s66 offen offset:0
    s_add_u32 s66, s58, 0x39000
    buffer_load_dwordx4 a[212:215], v2, s[4:7], s66 offen offset:1024
    s_add_u32 s66, s58, 0x39000
    buffer_load_dwordx4 a[216:219], v2, s[4:7], s66 offen offset:2048
    s_add_u32 s66, s58, 0x39000
    buffer_load_dwordx4 a[220:223], v2, s[4:7], s66 offen offset:3072
    s_add_u32 s66, s58, 0x3a000
    buffer_load_dwordx4 a[224:227], v2, s[4:7], s66 offen offset:0
    s_add_u32 s66, s58, 0x3a000
    buffer_load_dwordx4 a[228:231], v2, s[4:7], s66 offen offset:1024
    s_add_u32 s66, s58, 0x3a000
    buffer_load_dwordx4 a[232:235], v2, s[4:7], s66 offen offset:2048
    s_add_u32 s66, s58, 0x3a000
    buffer_load_dwordx4 a[236:239], v2, s[4:7], s66 offen offset:3072
    s_add_u32 s66, s58, 0x3b000
    buffer_load_dwordx4 a[240:243], v2, s[4:7], s66 offen offset:0
    s_add_u32 s66, s58, 0x3b000
    buffer_load_dwordx4 a[244:247], v2, s[4:7], s66 offen offset:1024
    s_add_u32 s66, s58, 0x54000
    buffer_load_dwordx4 a[0:3], v2, s[4:7], s66 offen offset:0
    s_add_u32 s66, s58, 0x54000
    buffer_load_dwordx4 a[4:7], v2, s[4:7], s66 offen offset:1024
    s_add_u32 s66, s58, 0x54000
    buffer_load_dwordx4 a[8:11], v2, s[4:7], s66 offen offset:2048
    s_add_u32 s66, s58, 0x54000
    buffer_load_dwordx4 a[12:15], v2, s[4:7], s66 offen offset:3072
    s_add_u32 s66, s58, 0x55000
    buffer_load_dwordx4 a[16:19], v2, s[4:7], s66 offen offset:0
    s_add_u32 s66, s58, 0x55000
    buffer_load_dwordx4 a[20:23], v2, s[4:7], s66 offen offset:1024
    s_add_u32 s66, s58, 0x55000
    buffer_load_dwordx4 a[24:27], v2, s[4:7], s66 offen offset:2048
    s_add_u32 s66, s58, 0x55000
    buffer_load_dwordx4 a[28:31], v2, s[4:7], s66 offen offset:3072
    s_add_u32 s66, s58, 0x56000
    buffer_load_dwordx4 a[32:35], v2, s[4:7], s66 offen offset:0
    s_add_u32 s66, s58, 0x56000
    buffer_load_dwordx4 a[36:39], v2, s[4:7], s66 offen offset:1024
    s_add_u32 s66, s58, 0x56000
    buffer_load_dwordx4 a[40:43], v2, s[4:7], s66 offen offset:2048
    s_add_u32 s66, s58, 0x56000
    buffer_load_dwordx4 a[44:47], v2, s[4:7], s66 offen offset:3072
    s_add_u32 s66, s58, 0x57000
    buffer_load_dwordx4 a[48:51], v2, s[4:7], s66 offen offset:0
    s_add_u32 s66, s58, 0x57000
    buffer_load_dwordx4 a[52:55], v2, s[4:7], s66 offen offset:1024
    s_waitcnt vmcnt(27)
    v_mfma_f32_16x16x32_bf16 v[32:35], v[112:115], a[192:195], 0
    v_mfma_f32_16x16x32_bf16 v[36:39], v[116:119], a[192:195], 0
    v_mfma_f32_16x16x32_bf16 v[40:43], v[120:123], a[192:195], 0
    v_mfma_f32_16x16x32_bf16 v[44:47], v[124:127], a[192:195], 0
    ds_write_b128 v3, v[80:83] offset:16384
    ds_write_b128 v3, v[84:87] offset:17408
    s_waitcnt vmcnt(26)
    v_mfma_f32_16x16x32_bf16 v[32:35], v[128:131], a[196:199], v[32:35]
    ds_write_b128 v3, v[88:91] offset:24576
    ds_write_b128 v3, v[92:95] offset:25600
    v_mfma_f32_16x16x32_bf16 v[36:39], v[132:135], a[196:199], v[36:39]
    v_mfma_f32_16x16x32_bf16 v[40:43], v[136:139], a[196:199], v[40:43]
    v_mfma_f32_16x16x32_bf16 v[44:47], v[140:143], a[196:199], v[44:47]
    s_waitcnt vmcnt(25)
    v_mfma_f32_16x16x32_bf16 v[32:35], v[144:147], a[200:203], v[32:35]
    s_waitcnt lgkmcnt(0)
    s_barrier
    ds_read_b128 v[64:67], v4 offset:0
    v_mfma_f32_16x16x32_bf16 v[36:39], v[148:151], a[200:203], v[36:39]
    ds_read_b128 v[68:71], v4 offset:1024
    ds_read_b128 v[72:75], v4 offset:2048
    v_mfma_f32_16x16x32_bf16 v[40:43], v[152:155], a[200:203], v[40:43]
    ds_read_b128 v[76:79], v4 offset:3072
    ds_read_b128 v[80:83], v4 offset:4096
    v_mfma_f32_16x16x32_bf16 v[44:47], v[156:159], a[200:203], v[44:47]
    ds_read_b128 v[84:87], v4 offset:5120
    ds_read_b128 v[88:91], v4 offset:6144
    s_waitcnt vmcnt(24)
    v_mfma_f32_16x16x32_bf16 v[32:35], v[160:163], a[204:207], v[32:35]
    ds_read_b128 v[92:95], v4 offset:7168
    v_lshlrev_b32 v24, 16, v16
    v_mfma_f32_16x16x32_bf16 v[36:39], v[164:167], a[204:207], v[36:39]
    v_and_b32 v25, 0xffff0000, v16
    v_lshlrev_b32 v26, 16, v17
    v_mfma_f32_16x16x32_bf16 v[40:43], v[168:171], a[204:207], v[40:43]
    v_and_b32 v27, 0xffff0000, v17
    v_lshlrev_b32 v28, 16, v18
    v_mfma_f32_16x16x32_bf16 v[44:47], v[172:175], a[204:207], v[44:47]
    v_and_b32 v29, 0xffff0000, v18
    v_lshlrev_b32 v30, 16, v19
    s_waitcnt vmcnt(23)
    v_mfma_f32_16x16x32_bf16 v[32:35], v[176:179], a[208:211], v[32:35]
    v_and_b32 v31, 0xffff0000, v19
    s_waitcnt lgkmcnt(6)
    v_add_f32 v24, v24, v64
    v_mfma_f32_16x16x32_bf16 v[36:39], v[180:183], a[208:211], v[36:39]
    v_add_f32 v25, v25, v65
    v_add_f32 v26, v26, v66
    v_mfma_f32_16x16x32_bf16 v[40:43], v[184:187], a[208:211], v[40:43]
    v_add_f32 v27, v27, v67
    v_add_f32 v28, v28, v68
    v_mfma_f32_16x16x32_bf16 v[44:47], v[188:191], a[208:211], v[44:47]
    v_add_f32 v29, v29, v69
    v_add_f32 v30, v30, v70
    s_waitcnt vmcnt(22)
    v_mfma_f32_16x16x32_bf16 v[32:35], v[192:195], a[212:215], v[32:35]
    v_add_f32 v31, v31, v71
    s_waitcnt lgkmcnt(4)
    v_add_f32 v24, v24, v72
    v_mfma_f32_16x16x32_bf16 v[36:39], v[196:199], a[212:215], v[36:39]
    v_add_f32 v25, v25, v73
    v_add_f32 v26, v26, v74
    v_mfma_f32_16x16x32_bf16 v[40:43], v[200:203], a[212:215], v[40:43]
    v_add_f32 v27, v27, v75
    v_add_f32 v28, v28, v76
    v_mfma_f32_16x16x32_bf16 v[44:47], v[204:207], a[212:215], v[44:47]
    v_add_f32 v29, v29, v77
    v_add_f32 v30, v30, v78
    s_waitcnt vmcnt(21)
    v_mfma_f32_16x16x32_bf16 v[32:35], v[208:211], a[216:219], v[32:35]
    v_add_f32 v31, v31, v79
    s_waitcnt lgkmcnt(2)
    v_add_f32 v24, v24, v80
    v_mfma_f32_16x16x32_bf16 v[36:39], v[212:215], a[216:219], v[36:39]
    v_add_f32 v25, v25, v81
    v_add_f32 v26, v26, v82
    v_mfma_f32_16x16x32_bf16 v[40:43], v[216:219], a[216:219], v[40:43]
    v_add_f32 v27, v27, v83
    v_add_f32 v28, v28, v84
    v_mfma_f32_16x16x32_bf16 v[44:47], v[220:223], a[216:219], v[44:47]
    v_add_f32 v29, v29, v85
    v_add_f32 v30, v30, v86
    s_waitcnt vmcnt(20)
    v_mfma_f32_16x16x32_bf16 v[32:35], v[224:227], a[220:223], v[32:35]
    v_add_f32 v31, v31, v87
    s_waitcnt lgkmcnt(0)
    v_add_f32 v24, v24, v88
    v_mfma_f32_16x16x32_bf16 v[36:39], v[228:231], a[220:223], v[36:39]
    v_add_f32 v25, v25, v89
    v_add_f32 v26, v26, v90
    v_mfma_f32_16x16x32_bf16 v[40:43], v[232:235], a[220:223], v[40:43]
    v_add_f32 v27, v27, v91
    v_add_f32 v28, v28, v92
    v_mfma_f32_16x16x32_bf16 v[44:47], v[236:239], a[220:223], v[44:47]
    v_add_f32 v29, v29, v93
    v_add_f32 v30, v30, v94
    s_waitcnt vmcnt(19)
    v_mfma_f32_16x16x32_bf16 v[32:35], v[240:243], a[224:227], v[32:35]
    v_add_f32 v31, v31, v95
    v_cvt_pk_bf16_f32 v16, v24, v25
    v_mfma_f32_16x16x32_bf16 v[36:39], v[244:247], a[224:227], v[36:39]
    v_cvt_pk_bf16_f32 v17, v26, v27
    v_cvt_pk_bf16_f32 v18, v28, v29
    v_mfma_f32_16x16x32_bf16 v[40:43], v[248:251], a[224:227], v[40:43]
    v_cvt_pk_bf16_f32 v19, v30, v31
    v_mfma_f32_16x16x32_bf16 v[44:47], v[252:255], a[224:227], v[44:47]
    v_permlane16_swap_b32 v16, v18
    v_permlane16_swap_b32 v17, v19
    s_waitcnt vmcnt(18)
    v_mfma_f32_16x16x32_bf16 v[32:35], a[56:59], a[228:231], v[32:35]
    buffer_store_dwordx4 v[16:19], v6, s[12:15], s64 offen
    s_add_u32 s64, s64, 65536
    v_mfma_f32_16x16x32_bf16 v[36:39], a[60:63], a[228:231], v[36:39]
    v_mfma_f32_16x16x32_bf16 v[40:43], a[64:67], a[228:231], v[40:43]
    v_mfma_f32_16x16x32_bf16 v[44:47], a[68:71], a[228:231], v[44:47]
    s_waitcnt vmcnt(18)
    v_mfma_f32_16x16x32_bf16 v[32:35], a[72:75], a[232:235], v[32:35]
    v_mfma_f32_16x16x32_bf16 v[36:39], a[76:79], a[232:235], v[36:39]
    v_mfma_f32_16x16x32_bf16 v[40:43], a[80:83], a[232:235], v[40:43]
    v_mfma_f32_16x16x32_bf16 v[44:47], a[84:87], a[232:235], v[44:47]
    s_waitcnt vmcnt(17)
    v_mfma_f32_16x16x32_bf16 v[32:35], a[88:91], a[236:239], v[32:35]
    v_mfma_f32_16x16x32_bf16 v[36:39], a[92:95], a[236:239], v[36:39]
    v_mfma_f32_16x16x32_bf16 v[40:43], a[96:99], a[236:239], v[40:43]
    v_mfma_f32_16x16x32_bf16 v[44:47], a[100:103], a[236:239], v[44:47]
    s_waitcnt vmcnt(16)
    v_mfma_f32_16x16x32_bf16 v[32:35], a[104:107], a[240:243], v[32:35]
    v_mfma_f32_16x16x32_bf16 v[36:39], a[108:111], a[240:243], v[36:39]
    v_mfma_f32_16x16x32_bf16 v[40:43], a[112:115], a[240:243], v[40:43]
    v_mfma_f32_16x16x32_bf16 v[44:47], a[116:119], a[240:243], v[44:47]
    s_waitcnt vmcnt(15)
    v_mfma_f32_16x16x32_bf16 v[32:35], a[120:123], a[244:247], v[32:35]
    v_mfma_f32_16x16x32_bf16 v[36:39], a[124:127], a[244:247], v[36:39]
    v_mfma_f32_16x16x32_bf16 v[40:43], a[128:131], a[244:247], v[40:43]
    v_mfma_f32_16x16x32_bf16 v[44:47], a[132:135], a[244:247], v[44:47]
    s_nop 4
    v_cmp_u_f32 vcc, v32, v32
    s_nop 4
    s_cbranch_vccnz L_slow_70
L_back_71:
    s_waitcnt vmcnt(14)
    v_mfma_f32_16x16x32_bf16 v[48:51], v[112:115], a[0:3], 0
    v_mfma_f32_16x16x32_bf16 v[52:55], v[116:119], a[0:3], 0
    v_mfma_f32_16x16x32_bf16 v[56:59], v[120:123], a[0:3], 0
    v_mfma_f32_16x16x32_bf16 v[60:63], v[124:127], a[0:3], 0
    ds_write_b128 v3, v[32:35] offset:32768
    ds_write_b128 v3, v[36:39] offset:33792
    s_waitcnt vmcnt(13)
    v_mfma_f32_16x16x32_bf16 v[48:51], v[128:131], a[4:7], v[48:51]
    ds_write_b128 v3, v[40:43] offset:40960
    ds_write_b128 v3, v[44:47] offset:41984
    v_mfma_f32_16x16x32_bf16 v[52:55], v[132:135], a[4:7], v[52:55]
    v_mfma_f32_16x16x32_bf16 v[56:59], v[136:139], a[4:7], v[56:59]
    v_mfma_f32_16x16x32_bf16 v[60:63], v[140:143], a[4:7], v[60:63]
    s_waitcnt vmcnt(12)
    v_mfma_f32_16x16x32_bf16 v[48:51], v[144:147], a[8:11], v[48:51]
    v_mfma_f32_16x16x32_bf16 v[52:55], v[148:151], a[8:11], v[52:55]
    v_mfma_f32_16x16x32_bf16 v[56:59], v[152:155], a[8:11], v[56:59]
    v_mfma_f32_16x16x32_bf16 v[60:63], v[156:159], a[8:11], v[60:63]
    s_waitcnt vmcnt(11)
    v_mfma_f32_16x16x32_bf16 v[48:51], v[160:163], a[12:15], v[48:51]
    v_mfma_f32_16x16x32_bf16 v[52:55], v[164:167], a[12:15], v[52:55]
    v_mfma_f32_16x16x32_bf16 v[56:59], v[168:171], a[12:15], v[56:59]
    v_mfma_f32_16x16x32_bf16 v[60:63], v[172:175], a[12:15], v[60:63]
    s_waitcnt vmcnt(10)
    v_mfma_f32_16x16x32_bf16 v[48:51], v[176:179], a[16:19], v[48:51]
    v_mfma_f32_16x16x32_bf16 v[52:55], v[180:183], a[16:19], v[52:55]
    v_mfma_f32_16x16x32_bf16 v[56:59], v[184:187], a[16:19], v[56:59]
    v_mfma_f32_16x16x32_bf16 v[60:63], v[188:191], a[16:19], v[60:63]
    s_waitcnt vmcnt(9)
    v_mfma_f32_16x16x32_bf16 v[48:51], v[192:195], a[20:23], v[48:51]
    v_mfma_f32_16x16x32_bf16 v[52:55], v[196:199], a[20:23], v[52:55]
    v_mfma_f32_16x16x32_bf16 v[56:59], v[200:203], a[20:23], v[56:59]
    v_mfma_f32_16x16x32_bf16 v[60:63], v[204:207], a[20:23], v[60:63]
    s_waitcnt vmcnt(8)
    v_mfma_f32_16x16x32_bf16 v[48:51], v[208:211], a[24:27], v[48:51]
    v_mfma_f32_16x16x32_bf16 v[52:55], v[212:215], a[24:27], v[52:55]
    v_mfma_f32_16x16x32_bf16 v[56:59], v[216:219], a[24:27], v[56:59]
    v_mfma_f32_16x16x32_bf16 v[60:63], v[220:223], a[24:27], v[60:63]
    s_waitcnt vmcnt(7)
    v_mfma_f32_16x16x32_bf16 v[48:51], v[224:227], a[28:31], v[48:51]
    v_mfma_f32_16x16x32_bf16 v[52:55], v[228:231], a[28:31], v[52:55]
    v_mfma_f32_16x16x32_bf16 v[56:59], v[232:235], a[28:31], v[56:59]
    v_mfma_f32_16x16x32_bf16 v[60:63], v[236:239], a[28:31], v[60:63]
    s_waitcnt vmcnt(6)
    v_mfma_f32_16x16x32_bf16 v[48:51], v[240:243], a[32:35], v[48:51]
    v_mfma_f32_16x16x32_bf16 v[52:55], v[244:247], a[32:35], v[52:55]
    v_mfma_f32_16x16x32_bf16 v[56:59], v[248:251], a[32:35], v[56:59]
    v_mfma_f32_16x16x32_bf16 v[60:63], v[252:255], a[32:35], v[60:63]
    s_waitcnt vmcnt(5)
    v_mfma_f32_16x16x32_bf16 v[48:51], a[56:59], a[36:39], v[48:51]
    v_mfma_f32_16x16x32_bf16 v[52:55], a[60:63], a[36:39], v[52:55]
    v_mfma_f32_16x16x32_bf16 v[56:59], a[64:67], a[36:39], v[56:59]
    v_mfma_f32_16x16x32_bf16 v[60:63], a[68:71], a[36:39], v[60:63]
    s_waitcnt vmcnt(4)
    v_mfma_f32_16x16x32_bf16 v[48:51], a[72:75], a[40:43], v[48:51]
    v_mfma_f32_16x16x32_bf16 v[52:55], a[76:79], a[40:43], v[52:55]
    v_mfma_f32_16x16x32_bf16 v[56:59], a[80:83], a[40:43], v[56:59]
    v_mfma_f32_16x16x32_bf16 v[60:63], a[84:87], a[40:43], v[60:63]
    s_waitcnt vmcnt(3)
    v_mfma_f32_16x16x32_bf16 v[48:51], a[88:91], a[44:47], v[48:51]
    v_mfma_f32_16x16x32_bf16 v[52:55], a[92:95], a[44:47], v[52:55]
    v_mfma_f32_16x16x32_bf16 v[56:59], a[96:99], a[44:47], v[56:59]
    v_mfma_f32_16x16x32_bf16 v[60:63], a[100:103], a[44:47], v[60:63]
    s_waitcnt vmcnt(2)
    v_mfma_f32_16x16x32_bf16 v[48:51], a[104:107], a[48:51], v[48:51]
    v_mfma_f32_16x16x32_bf16 v[52:55], a[108:111], a[48:51], v[52:55]
    v_mfma_f32_16x16x32_bf16 v[56:59], a[112:115], a[48:51], v[56:59]
    v_mfma_f32_16x16x32_bf16 v[60:63], a[116:119], a[48:51], v[60:63]
    s_waitcnt vmcnt(1)
    v_mfma_f32_16x16x32_bf16 v[48:51], a[120:123], a[52:55], v[48:51]
    v_mfma_f32_16x16x32_bf16 v[52:55], a[124:127], a[52:55], v[52:55]
    v_mfma_f32_16x16x32_bf16 v[56:59], a[128:131], a[52:55], v[56:59]
    v_mfma_f32_16x16x32_bf16 v[60:63], a[132:135], a[52:55], v[60:63]
    s_nop 4
    v_cmp_u_f32 vcc, v48, v48
    s_nop 4
    s_cbranch_vccnz L_slow_72
L_back_73:
    ds_write_b128 v3, v[48:51] offset:49152
    ds_write_b128 v3, v[52:55] offset:50176
    ds_write_b128 v3, v[56:59] offset:57344
    ds_write_b128 v3, v[60:63] offset:58368
    s_waitcnt lgkmcnt(0)
    s_barrier
    ds_read_b128 v[32:35], v4 offset:32768
    ds_read_b128 v[36:39], v4 offset:33792
    ds_read_b128 v[40:43], v4 offset:34816
    ds_read_b128 v[44:47], v4 offset:35840
    ds_read_b128 v[48:51], v4 offset:36864
    ds_read_b128 v[52:55], v4 offset:37888
    ds_read_b128 v[56:59], v4 offset:38912
    ds_read_b128 v[60:63], v4 offset:39936
    v_lshlrev_b32 v24, 16, v20
    v_and_b32 v25, 0xffff0000, v20
    v_lshlrev_b32 v26, 16, v21
    v_and_b32 v27, 0xffff0000, v21
    v_lshlrev_b32 v28, 16, v22
    v_and_b32 v29, 0xffff0000, v22
    v_lshlrev_b32 v30, 16, v23
    v_and_b32 v31, 0xffff0000, v23
    s_waitcnt lgkmcnt(6)
    v_pk_add_f32 v[24:25], v[24:25], v[32:33] op_sel:[0,0] op_sel_hi:[1,1]
    v_pk_add_f32 v[26:27], v[26:27], v[34:35] op_sel:[0,0] op_sel_hi:[1,1]
    v_pk_add_f32 v[28:29], v[28:29], v[36:37] op_sel:[0,0] op_sel_hi:[1,1]
    v_pk_add_f32 v[30:31], v[30:31], v[38:39] op_sel:[0,0] op_sel_hi:[1,1]
    s_waitcnt lgkmcnt(4)
    v_pk_add_f32 v[24:25], v[24:25], v[40:41] op_sel:[0,0] op_sel_hi:[1,1]
    v_pk_add_f32 v[26:27], v[26:27], v[42:43] op_sel:[0,0] op_sel_hi:[1,1]
    v_pk_add_f32 v[28:29], v[28:29], v[44:45] op_sel:[0,0] op_sel_hi:[1,1]
    v_pk_add_f32 v[30:31], v[30:31], v[46:47] op_sel:[0,0] op_sel_hi:[1,1]
    s_waitcnt lgkmcnt(2)
    v_pk_add_f32 v[24:25], v[24:25], v[48:49] op_sel:[0,0] op_sel_hi:[1,1]
    v_pk_add_f32 v[26:27], v[26:27], v[50:51] op_sel:[0,0] op_sel_hi:[1,1]
    v_pk_add_f32 v[28:29], v[28:29], v[52:53] op_sel:[0,0] op_sel_hi:[1,1]
    v_pk_add_f32 v[30:31], v[30:31], v[54:55] op_sel:[0,0] op_sel_hi:[1,1]
    s_waitcnt lgkmcnt(0)
    v_pk_add_f32 v[24:25], v[24:25], v[56:57] op_sel:[0,0] op_sel_hi:[1,1]
    v_pk_add_f32 v[26:27], v[26:27], v[58:59] op_sel:[0,0] op_sel_hi:[1,1]
    v_pk_add_f32 v[28:29], v[28:29], v[60:61] op_sel:[0,0] op_sel_hi:[1,1]
    v_pk_add_f32 v[30:31], v[30:31], v[62:63] op_sel:[0,0] op_sel_hi:[1,1]
    v_cvt_pk_bf16_f32 v20, v24, v25
    v_cvt_pk_bf16_f32 v21, v26, v27
    v_cvt_pk_bf16_f32 v22, v28, v29
    v_cvt_pk_bf16_f32 v23, v30, v31
    s_nop 0
    v_permlane16_swap_b32 v20, v22
    v_permlane16_swap_b32 v21, v23
    s_nop 0
    buffer_store_dwordx4 v[20:23], v6, s[12:15], s64 offen
    s_add_u32 s64, s64, 65536
L_end_k2_mega_kernel:
    s_endpgm
L_fbs_9:
    s_cmp_lg_u32 s69, 0
    s_cbranch_scc1 L_fbc_10
    s_branch L_fb_8
L_fbs_11:
    s_cmp_lg_u32 s69, 0
    s_cbranch_scc1 L_fbc_12
    s_branch L_fb_8
L_fb_8:
    s_waitcnt vmcnt(0) lgkmcnt(0)
    s_mov_b32 s69, 1
    buffer_load_dwordx4 v[24:27], v13, s[4:7], s36 offen
    buffer_load_dwordx4 v[128:131], v13, s[4:7], s37 offen offset:0
    buffer_load_dwordx4 v[132:135], v13, s[4:7], s37 offen offset:1024
    buffer_load_dwordx4 v[28:31], v13, s[4:7], s36 offen offset:2048
    buffer_load_dwordx4 v[136:139], v13, s[4:7], s37 offen offset:2048
    buffer_load_dwordx4 v[140:143], v13, s[4:7], s37 offen offset:3072
    s_add_u32 s38, s37, 4096
    buffer_load_dwordx4 v[144:147], v13, s[4:7], s38 offen offset:0
    buffer_load_dwordx4 v[148:151], v13, s[4:7], s38 offen offset:1024
    buffer_load_dwordx4 v[152:155], v13, s[4:7], s38 offen offset:2048
    buffer_load_dwordx4 v[156:159], v13, s[4:7], s38 offen offset:3072
    s_add_u32 s38, s37, 8192
    buffer_load_dwordx4 v[160:163], v13, s[4:7], s38 offen offset:0
    buffer_load_dwordx4 v[164:167], v13, s[4:7], s38 offen offset:1024
    buffer_load_dwordx4 v[168:171], v13, s[4:7], s38 offen offset:2048
    v_and_b32 v14, 31, v1
    v_lshrrev_b32 v15, 5, v1
    v_lshlrev_b32 v15, 2, v15
    v_sub_u32 v14, v14, v15
    v_mov_b32 v15, 0xff7fffff
    v_cmp_gt_i32 vcc, 0, v14
    s_nop 1
    v_cndmask_b32 v64, v15, 0, vcc
    v_cndmask_b32 v80, 0, v15, vcc
    v_cmp_gt_i32 vcc, 1, v14
    s_nop 1
    v_cndmask_b32 v65, v15, 0, vcc
    v_cndmask_b32 v81, 0, v15, vcc
    v_cmp_gt_i32 vcc, 2, v14
    s_nop 1
    v_cndmask_b32 v66, v15, 0, vcc
    v_cndmask_b32 v82, 0, v15, vcc
    v_cmp_gt_i32 vcc, 3, v14
    s_nop 1
    v_cndmask_b32 v67, v15, 0, vcc
    v_cndmask_b32 v83, 0, v15, vcc
    v_cmp_gt_i32 vcc, 8, v14
    s_nop 1
    v_cndmask_b32 v68, v15, 0, vcc
    v_cndmask_b32 v84, 0, v15, vcc
    v_cmp_gt_i32 vcc, 9, v14
    s_nop 1
    v_cndmask_b32 v69, v15, 0, vcc
    v_cndmask_b32 v85, 0, v15, vcc
    v_cmp_gt_i32 vcc, 10, v14
    s_nop 1
    v_cndmask_b32 v70, v15, 0, vcc
    v_cndmask_b32 v86, 0, v15, vcc
    v_cmp_gt_i32 vcc, 11, v14
    s_nop 1
    v_cndmask_b32 v71, v15, 0, vcc
    v_cndmask_b32 v87, 0, v15, vcc
    v_cmp_gt_i32 vcc, 16, v14
    s_nop 1
    v_cndmask_b32 v72, v15, 0, vcc
    v_cndmask_b32 v88, 0, v15, vcc
    v_cmp_gt_i32 vcc, 17, v14
    s_nop 1
    v_cndmask_b32 v73, v15, 0, vcc
    v_cndmask_b32 v89, 0, v15, vcc
    v_cmp_gt_i32 vcc, 18, v14
    s_nop 1
    v_cndmask_b32 v74, v15, 0, vcc
    v_cndmask_b32 v90, 0, v15, vcc
    v_cmp_gt_i32 vcc, 19, v14
    s_nop 1
    v_cndmask_b32 v75, v15, 0, vcc
    v_cndmask_b32 v91, 0, v15, vcc
    v_cmp_gt_i32 vcc, 24, v14
    s_nop 1
    v_cndmask_b32 v76, v15, 0, vcc
    v_cndmask_b32 v92, 0, v15, vcc
    v_cmp_gt_i32 vcc, 25, v14
    s_nop 1
    v_cndmask_b32 v77, v15, 0, vcc
    v_cndmask_b32 v93, 0, v15, vcc
    v_cmp_gt_i32 vcc, 26, v14
    s_nop 1
    v_cndmask_b32 v78, v15, 0, vcc
    v_cndmask_b32 v94, 0, v15, vcc
    v_cmp_gt_i32 vcc, 27, v14
    s_nop 1
    v_cndmask_b32 v79, v15, 0, vcc
    v_cndmask_b32 v95, 0, v15, vcc
    v_mov_b32 v8, 0xff7fffff
    v_mov_b32 v10, 0xff7fffff
    s_waitcnt vmcnt(0) lgkmcnt(0)
    v_mfma_f32_32x32x16_bf16 v[172:187], v[128:131], v[24:27], v[64:79]
    v_mfma_f32_32x32x16_bf16 v[188:203], v[132:135], v[24:27], 0
    v_mfma_f32_32x32x16_bf16 v[204:219], v[136:139], v[24:27], 0
    s_nop 9
    v_max3_f32 v8, v8, v172, v173
    v_max3_f32 v8, v8, v174, v175
    v_max3_f32 v8, v8, v176, v177
    v_max3_f32 v8, v8, v178, v179
    v_max3_f32 v8, v8, v180, v181
    v_max3_f32 v8, v8, v182, v183
    v_max3_f32 v8, v8, v184, v185
    v_max3_f32 v8, v8, v186, v187
    v_mfma_f32_32x32x16_bf16 v[172:187], v[140:143], v[24:27], 0
    v_max3_f32 v8, v8, v188, v189
    v_max3_f32 v8, v8, v190, v191
    v_max3_f32 v8, v8, v192, v193
    v_max3_f32 v8, v8, v194, v195
    v_max3_f32 v8, v8, v196, v197
    v_max3_f32 v8, v8, v198, v199
    v_max3_f32 v8, v8, v200, v201
    v_max3_f32 v8, v8, v202, v203
    v_mfma_f32_32x32x16_bf16 v[188:203], v[144:147], v[24:27], 0
    v_max3_f32 v8, v8, v204, v205
    v_max3_f32 v8, v8, v206, v207
    v_max3_f32 v8, v8, v208, v209
    v_max3_f32 v8, v8, v210, v211
    v_max3_f32 v8, v8, v212, v213
    v_max3_f32 v8, v8, v214, v215
    v_max3_f32 v8, v8, v216, v217
    v_max3_f32 v8, v8, v218, v219
    v_mfma_f32_32x32x16_bf16 v[204:219], v[148:151], v[24:27], 0
    v_max3_f32 v8, v8, v172, v173
    v_max3_f32 v8, v8, v174, v175
    v_max3_f32 v8, v8, v176, v177
    v_max3_f32 v8, v8, v178, v179
    v_max3_f32 v8, v8, v180, v181
    v_max3_f32 v8, v8, v182, v183
    v_max3_f32 v8, v8, v184, v185
    v_max3_f32 v8, v8, v186, v187
    v_mfma_f32_32x32x16_bf16 v[172:187], v[152:155], v[24:27], 0
    v_max3_f32 v8, v8, v188, v189
    v_max3_f32 v8, v8, v190, v191
    v_max3_f32 v8, v8, v192, v193
    v_max3_f32 v8, v8, v194, v195
    v_max3_f32 v8, v8, v196, v197
    v_max3_f32 v8, v8, v198, v199
    v_max3_f32 v8, v8, v200, v201
    v_max3_f32 v8, v8, v202, v203
    v_mfma_f32_32x32x16_bf16 v[188:203], v[156:159], v[24:27], 0
    v_max3_f32 v8, v8, v204, v205
    v_max3_f32 v8, v8, v206, v207
    v_max3_f32 v8, v8, v208, v209
    v_max3_f32 v8, v8, v210, v211
    v_max3_f32 v8, v8, v212, v213
    v_max3_f32 v8, v8, v214, v215
    v_max3_f32 v8, v8, v216, v217
    v_max3_f32 v8, v8, v218, v219
    v_mfma_f32_32x32x16_bf16 v[204:219], v[160:163], v[24:27], v[80:95]
    v_max3_f32 v8, v8, v172, v173
    v_max3_f32 v8, v8, v174, v175
    v_max3_f32 v8, v8, v176, v177
    v_max3_f32 v8, v8, v178, v179
    v_max3_f32 v8, v8, v180, v181
    v_max3_f32 v8, v8, v182, v183
    v_max3_f32 v8, v8, v184, v185
    v_max3_f32 v8, v8, v186, v187
    v_mfma_f32_32x32x16_bf16 v[172:187], v[136:139], v[28:31], v[64:79]
    v_max3_f32 v8, v8, v188, v189
    v_max3_f32 v8, v8, v190, v191
    v_max3_f32 v8, v8, v192, v193
    v_max3_f32 v8, v8, v194, v195
    v_max3_f32 v8, v8, v196, v197
    v_max3_f32 v8, v8, v198, v199
    v_max3_f32 v8, v8, v200, v201
    v_max3_f32 v8, v8, v202, v203
    v_mfma_f32_32x32x16_bf16 v[188:203], v[140:143], v[28:31], 0
    v_max3_f32 v8, v8, v204, v205
    v_max3_f32 v8, v8, v206, v207
    v_max3_f32 v8, v8, v208, v209
    v_max3_f32 v8, v8, v210, v211
    v_max3_f32 v8, v8, v212, v213
    v_max3_f32 v8, v8, v214, v215
    v_max3_f32 v8, v8, v216, v217
    v_max3_f32 v8, v8, v218, v219
    v_mov_b32 v9, v8
    s_nop 1
    v_permlane32_swap_b32 v8, v9
    s_nop 0
    v_max_f32 v8, v8, v9
    v_sub_f32 v8, 0, v8
    v_mov_b32 v9, v8
    v_mfma_f32_32x32x16_bf16 v[204:219], v[144:147], v[28:31], 0
    v_max3_f32 v10, v10, v172, v173
    v_max3_f32 v10, v10, v174, v175
    v_max3_f32 v10, v10, v176, v177
    v_max3_f32 v10, v10, v178, v179
    v_max3_f32 v10, v10, v180, v181
    v_max3_f32 v10, v10, v182, v183
    v_max3_f32 v10, v10, v184, v185
    v_max3_f32 v10, v10, v186, v187
    v_mfma_f32_32x32x16_bf16 v[172:187], v[148:151], v[28:31], 0
    v_max3_f32 v10, v10, v188, v189
    v_max3_f32 v10, v10, v190, v191
    v_max3_f32 v10, v10, v192, v193
    v_max3_f32 v10, v10, v194, v195
    v_max3_f32 v10, v10, v196, v197
    v_max3_f32 v10, v10, v198, v199
    v_max3_f32 v10, v10, v200, v201
    v_max3_f32 v10, v10, v202, v203
    v_mfma_f32_32x32x16_bf16 v[188:203], v[152:155], v[28:31], 0
    v_max3_f32 v10, v10, v204, v205
    v_max3_f32 v10, v10, v206, v207
    v_max3_f32 v10, v10, v208, v209
    v_max3_f32 v10, v10, v210, v211
    v_max3_f32 v10, v10, v212, v213
    v_max3_f32 v10, v10, v214, v215
    v_max3_f32 v10, v10, v216, v217
    v_max3_f32 v10, v10, v218, v219
    v_mfma_f32_32x32x16_bf16 v[204:219], v[156:159], v[28:31], 0
    v_max3_f32 v10, v10, v172, v173
    v_max3_f32 v10, v10, v174, v175
    v_max3_f32 v10, v10, v176, v177
    v_max3_f32 v10, v10, v178, v179
    v_max3_f32 v10, v10, v180, v181
    v_max3_f32 v10, v10, v182, v183
    v_max3_f32 v10, v10, v184, v185
    v_max3_f32 v10, v10, v186, v187
    v_mfma_f32_32x32x16_bf16 v[172:187], v[160:163], v[28:31], 0
    v_max3_f32 v10, v10, v188, v189
    v_max3_f32 v10, v10, v190, v191
    v_max3_f32 v10, v10, v192, v193
    v_max3_f32 v10, v10, v194, v195
    v_max3_f32 v10, v10, v196, v197
    v_max3_f32 v10, v10, v198, v199
    v_max3_f32 v10, v10, v200, v201
    v_max3_f32 v10, v10, v202, v203
    v_mfma_f32_32x32x16_bf16 v[188:203], v[164:167], v[28:31], 0
    v_max3_f32 v10, v10, v204, v205
    v_max3_f32 v10, v10, v206, v207
    v_max3_f32 v10, v10, v208, v209
    v_max3_f32 v10, v10, v210, v211
    v_max3_f32 v10, v10, v212, v213
    v_max3_f32 v10, v10, v214, v215
    v_max3_f32 v10, v10, v216, v217
    v_max3_f32 v10, v10, v218, v219
    v_mfma_f32_32x32x16_bf16 v[204:219], v[168:171], v[28:31], v[80:95]
    v_max3_f32 v10, v10, v172, v173
    v_max3_f32 v10, v10, v174, v175
    v_max3_f32 v10, v10, v176, v177
    v_max3_f32 v10, v10, v178, v179
    v_max3_f32 v10, v10, v180, v181
    v_max3_f32 v10, v10, v182, v183
    v_max3_f32 v10, v10, v184, v185
    v_max3_f32 v10, v10, v186, v187
    v_max3_f32 v10, v10, v188, v189
    v_max3_f32 v10, v10, v190, v191
    v_max3_f32 v10, v10, v192, v193
    v_max3_f32 v10, v10, v194, v195
    v_max3_f32 v10, v10, v196, v197
    v_max3_f32 v10, v10, v198, v199
    v_max3_f32 v10, v10, v200, v201
    v_max3_f32 v10, v10, v202, v203
    v_max3_f32 v10, v10, v204, v205
    v_max3_f32 v10, v10, v206, v207
    v_max3_f32 v10, v10, v208, v209
    v_max3_f32 v10, v10, v210, v211
    v_max3_f32 v10, v10, v212, v213
    v_max3_f32 v10, v10, v214, v215
    v_max3_f32 v10, v10, v216, v217
    v_max3_f32 v10, v10, v218, v219
    v_mov_b32 v11, v10
    s_nop 1
    v_permlane32_swap_b32 v10, v11
    s_nop 0
    v_max_f32 v10, v10, v11
    v_sub_f32 v10, 0, v10
    v_mov_b32 v11, v10
    v_mov_b64 v[64:65], v[8:9]
    v_mov_b64 v[66:67], v[8:9]
    v_mov_b64 v[68:69], v[8:9]
    v_mov_b64 v[70:71], v[8:9]
    v_mov_b64 v[72:73], v[8:9]
    v_mov_b64 v[74:75], v[8:9]
    v_mov_b64 v[76:77], v[8:9]
    v_mov_b64 v[78:79], v[8:9]
    v_mov_b64 v[80:81], v[10:11]
    v_mov_b64 v[82:83], v[10:11]
    v_mov_b64 v[84:85], v[10:11]
    v_mov_b64 v[86:87], v[10:11]
    v_mov_b64 v[88:89], v[10:11]
    v_mov_b64 v[90:91], v[10:11]
    v_mov_b64 v[92:93], v[10:11]
    v_mov_b64 v[94:95], v[10:11]
    s_nop 2
    s_branch L_top_7
L_fbs_15:
    s_cmp_lg_u32 s69, 0
    s_cbranch_scc1 L_fbc_16
    s_branch L_fb_14
L_fbs_17:
    s_cmp_lg_u32 s69, 0
    s_cbranch_scc1 L_fbc_18
    s_branch L_fb_14
L_fb_14:
    s_waitcnt vmcnt(0) lgkmcnt(0)
    s_mov_b32 s69, 1
    buffer_load_dwordx4 v[24:27], v13, s[4:7], s36 offen
    buffer_load_dwordx4 v[128:131], v13, s[4:7], s37 offen offset:0
    buffer_load_dwordx4 v[132:135], v13, s[4:7], s37 offen offset:1024
    buffer_load_dwordx4 v[28:31], v13, s[4:7], s36 offen offset:2048
    buffer_load_dwordx4 v[136:139], v13, s[4:7], s37 offen offset:2048
    buffer_load_dwordx4 v[140:143], v13, s[4:7], s37 offen offset:3072
    s_add_u32 s38, s37, 4096
    buffer_load_dwordx4 v[144:147], v13, s[4:7], s38 offen offset:0
    buffer_load_dwordx4 v[148:151], v13, s[4:7], s38 offen offset:1024
    buffer_load_dwordx4 v[152:155], v13, s[4:7], s38 offen offset:2048
    buffer_load_dwordx4 v[156:159], v13, s[4:7], s38 offen offset:3072
    s_add_u32 s38, s37, 8192
    buffer_load_dwordx4 v[160:163], v13, s[4:7], s38 offen offset:0
    buffer_load_dwordx4 v[164:167], v13, s[4:7], s38 offen offset:1024
    buffer_load_dwordx4 v[168:171], v13, s[4:7], s38 offen offset:2048
    v_and_b32 v14, 31, v1
    v_lshrrev_b32 v15, 5, v1
    v_lshlrev_b32 v15, 2, v15
    v_sub_u32 v14, v14, v15
    v_mov_b32 v15, 0xff7fffff
    v_cmp_gt_i32 vcc, 0, v14
    s_nop 1
    v_cndmask_b32 v64, v15, 0, vcc
    v_cndmask_b32 v80, 0, v15, vcc
    v_cmp_gt_i32 vcc, 1, v14
    s_nop 1
    v_cndmask_b32 v65, v15, 0, vcc
    v_cndmask_b32 v81, 0, v15, vcc
    v_cmp_gt_i32 vcc, 2, v14
    s_nop 1
    v_cndmask_b32 v66, v15, 0, vcc
    v_cndmask_b32 v82, 0, v15, vcc
    v_cmp_gt_i32 vcc, 3, v14
    s_nop 1
    v_cndmask_b32 v67, v15, 0, vcc
    v_cndmask_b32 v83, 0, v15, vcc
    v_cmp_gt_i32 vcc, 8, v14
    s_nop 1
    v_cndmask_b32 v68, v15, 0, vcc
    v_cndmask_b32 v84, 0, v15, vcc
    v_cmp_gt_i32 vcc, 9, v14
    s_nop 1
    v_cndmask_b32 v69, v15, 0, vcc
    v_cndmask_b32 v85, 0, v15, vcc
    v_cmp_gt_i32 vcc, 10, v14
    s_nop 1
    v_cndmask_b32 v70, v15, 0, vcc
    v_cndmask_b32 v86, 0, v15, vcc
    v_cmp_gt_i32 vcc, 11, v14
    s_nop 1
    v_cndmask_b32 v71, v15, 0, vcc
    v_cndmask_b32 v87, 0, v15, vcc
    v_cmp_gt_i32 vcc, 16, v14
    s_nop 1
    v_cndmask_b32 v72, v15, 0, vcc
    v_cndmask_b32 v88, 0, v15, vcc
    v_cmp_gt_i32 vcc, 17, v14
    s_nop 1
    v_cndmask_b32 v73, v15, 0, vcc
    v_cndmask_b32 v89, 0, v15, vcc
    v_cmp_gt_i32 vcc, 18, v14
    s_nop 1
    v_cndmask_b32 v74, v15, 0, vcc
    v_cndmask_b32 v90, 0, v15, vcc
    v_cmp_gt_i32 vcc, 19, v14
    s_nop 1
    v_cndmask_b32 v75, v15, 0, vcc
    v_cndmask_b32 v91, 0, v15, vcc
    v_cmp_gt_i32 vcc, 24, v14
    s_nop 1
    v_cndmask_b32 v76, v15, 0, vcc
    v_cndmask_b32 v92, 0, v15, vcc
    v_cmp_gt_i32 vcc, 25, v14
    s_nop 1
    v_cndmask_b32 v77, v15, 0, vcc
    v_cndmask_b32 v93, 0, v15, vcc
    v_cmp_gt_i32 vcc, 26, v14
    s_nop 1
    v_cndmask_b32 v78, v15, 0, vcc
    v_cndmask_b32 v94, 0, v15, vcc
    v_cmp_gt_i32 vcc, 27, v14
    s_nop 1
    v_cndmask_b32 v79, v15, 0, vcc
    v_cndmask_b32 v95, 0, v15, vcc
    v_mov_b32 v8, 0xff7fffff
    v_mov_b32 v10, 0xff7fffff
    s_waitcnt vmcnt(0) lgkmcnt(0)
    v_mfma_f32_32x32x16_bf16 v[172:187], v[160:163], v[24:27], v[80:95]
    v_mfma_f32_32x32x16_bf16 v[188:203], v[160:163], v[28:31], 0
    v_mfma_f32_32x32x16_bf16 v[204:219], v[164:167], v[28:31], 0
    s_nop 9
    v_max3_f32 v8, v8, v172, v173
    v_max3_f32 v8, v8, v174, v175
    v_max3_f32 v8, v8, v176, v177
    v_max3_f32 v8, v8, v178, v179
    v_max3_f32 v8, v8, v180, v181
    v_max3_f32 v8, v8, v182, v183
    v_max3_f32 v8, v8, v184, v185
    v_max3_f32 v8, v8, v186, v187
    v_mov_b32 v9, v8
    s_nop 1
    v_permlane32_swap_b32 v8, v9
    s_nop 0
    v_max_f32 v8, v8, v9
    v_sub_f32 v8, 0, v8
    v_mov_b32 v9, v8
    v_mfma_f32_32x32x16_bf16 v[172:187], v[168:171], v[28:31], v[80:95]
    v_max3_f32 v10, v10, v188, v189
    v_max3_f32 v10, v10, v190, v191
    v_max3_f32 v10, v10, v192, v193
    v_max3_f32 v10, v10, v194, v195
    v_max3_f32 v10, v10, v196, v197
    v_max3_f32 v10, v10, v198, v199
    v_max3_f32 v10, v10, v200, v201
    v_max3_f32 v10, v10, v202, v203
    v_max3_f32 v10, v10, v204, v205
    v_max3_f32 v10, v10, v206, v207
    v_max3_f32 v10, v10, v208, v209
    v_max3_f32 v10, v10, v210, v211
    v_max3_f32 v10, v10, v212, v213
    v_max3_f32 v10, v10, v214, v215
    v_max3_f32 v10, v10, v216, v217
    v_max3_f32 v10, v10, v218, v219
    v_max3_f32 v10, v10, v172, v173
    v_max3_f32 v10, v10, v174, v175
    v_max3_f32 v10, v10, v176, v177
    v_max3_f32 v10, v10, v178, v179
    v_max3_f32 v10, v10, v180, v181
    v_max3_f32 v10, v10, v182, v183
    v_max3_f32 v10, v10, v184, v185
    v_max3_f32 v10, v10, v186, v187
    v_mov_b32 v11, v10
    s_nop 1
    v_permlane32_swap_b32 v10, v11
    s_nop 0
    v_max_f32 v10, v10, v11
    v_sub_f32 v10, 0, v10
    v_mov_b32 v11, v10
    v_mov_b64 v[64:65], v[8:9]
    v_mov_b64 v[66:67], v[8:9]
    v_mov_b64 v[68:69], v[8:9]
    v_mov_b64 v[70:71], v[8:9]
    v_mov_b64 v[72:73], v[8:9]
    v_mov_b64 v[74:75], v[8:9]
    v_mov_b64 v[76:77], v[8:9]
    v_mov_b64 v[78:79], v[8:9]
    v_mov_b64 v[80:81], v[10:11]
    v_mov_b64 v[82:83], v[10:11]
    v_mov_b64 v[84:85], v[10:11]
    v_mov_b64 v[86:87], v[10:11]
    v_mov_b64 v[88:89], v[10:11]
    v_mov_b64 v[90:91], v[10:11]
    v_mov_b64 v[92:93], v[10:11]
    v_mov_b64 v[94:95], v[10:11]
    s_nop 2
    s_branch L_top_13
L_fbs_21:
    s_cmp_lg_u32 s69, 0
    s_cbranch_scc1 L_fbc_22
    s_branch L_fb_20
L_fbs_23:
    s_cmp_lg_u32 s69, 0
    s_cbranch_scc1 L_fbc_24
    s_branch L_fb_20
L_fb_20:
    s_waitcnt vmcnt(0) lgkmcnt(0)
    s_mov_b32 s69, 1
    buffer_load_dwordx4 v[24:27], v13, s[4:7], s36 offen
    buffer_load_dwordx4 v[128:131], v13, s[4:7], s37 offen offset:0
    buffer_load_dwordx4 v[132:135], v13, s[4:7], s37 offen offset:1024
    buffer_load_dwordx4 v[28:31], v13, s[4:7], s36 offen offset:2048
    buffer_load_dwordx4 v[136:139], v13, s[4:7], s37 offen offset:2048
    buffer_load_dwordx4 v[140:143], v13, s[4:7], s37 offen offset:3072
    s_add_u32 s38, s37, 4096
    buffer_load_dwordx4 v[144:147], v13, s[4:7], s38 offen offset:0
    buffer_load_dwordx4 v[148:151], v13, s[4:7], s38 offen offset:1024
    buffer_load_dwordx4 v[152:155], v13, s[4:7], s38 offen offset:2048
    buffer_load_dwordx4 v[156:159], v13, s[4:7], s38 offen offset:3072
    s_add_u32 s38, s37, 8192
    buffer_load_dwordx4 v[160:163], v13, s[4:7], s38 offen offset:0
    buffer_load_dwordx4 v[164:167], v13, s[4:7], s38 offen offset:1024
    buffer_load_dwordx4 v[168:171], v13, s[4:7], s38 offen offset:2048
    v_and_b32 v14, 31, v1
    v_lshrrev_b32 v15, 5, v1
    v_lshlrev_b32 v15, 2, v15
    v_sub_u32 v14, v14, v15
    v_mov_b32 v15, 0xff7fffff
    v_cmp_gt_i32 vcc, 0, v14
    s_nop 1
    v_cndmask_b32 v64, v15, 0, vcc
    v_cndmask_b32 v80, 0, v15, vcc
    v_cmp_gt_i32 vcc, 1, v14
    s_nop 1
    v_cndmask_b32 v65, v15, 0, vcc
    v_cndmask_b32 v81, 0, v15, vcc
    v_cmp_gt_i32 vcc, 2, v14
    s_nop 1
    v_cndmask_b32 v66, v15, 0, vcc
    v_cndmask_b32 v82, 0, v15, vcc
    v_cmp_gt_i32 vcc, 3, v14
    s_nop 1
    v_cndmask_b32 v67, v15, 0, vcc
    v_cndmask_b32 v83, 0, v15, vcc
    v_cmp_gt_i32 vcc, 8, v14
    s_nop 1
    v_cndmask_b32 v68, v15, 0, vcc
    v_cndmask_b32 v84, 0, v15, vcc
    v_cmp_gt_i32 vcc, 9, v14
    s_nop 1
    v_cndmask_b32 v69, v15, 0, vcc
    v_cndmask_b32 v85, 0, v15, vcc
    v_cmp_gt_i32 vcc, 10, v14
    s_nop 1
    v_cndmask_b32 v70, v15, 0, vcc
    v_cndmask_b32 v86, 0, v15, vcc
    v_cmp_gt_i32 vcc, 11, v14
    s_nop 1
    v_cndmask_b32 v71, v15, 0, vcc
    v_cndmask_b32 v87, 0, v15, vcc
    v_cmp_gt_i32 vcc, 16, v14
    s_nop 1
    v_cndmask_b32 v72, v15, 0, vcc
    v_cndmask_b32 v88, 0, v15, vcc
    v_cmp_gt_i32 vcc, 17, v14
    s_nop 1
    v_cndmask_b32 v73, v15, 0, vcc
    v_cndmask_b32 v89, 0, v15, vcc
    v_cmp_gt_i32 vcc, 18, v14
    s_nop 1
    v_cndmask_b32 v74, v15, 0, vcc
    v_cndmask_b32 v90, 0, v15, vcc
    v_cmp_gt_i32 vcc, 19, v14
    s_nop 1
    v_cndmask_b32 v75, v15, 0, vcc
    v_cndmask_b32 v91, 0, v15, vcc
    v_cmp_gt_i32 vcc, 24, v14
    s_nop 1
    v_cndmask_b32 v76, v15, 0, vcc
    v_cndmask_b32 v92, 0, v15, vcc
    v_cmp_gt_i32 vcc, 25, v14
    s_nop 1
    v_cndmask_b32 v77, v15, 0, vcc
    v_cndmask_b32 v93, 0, v15, vcc
    v_cmp_gt_i32 vcc, 26, v14
    s_nop 1
    v_cndmask_b32 v78, v15, 0, vcc
    v_cndmask_b32 v94, 0, v15, vcc
    v_cmp_gt_i32 vcc, 27, v14
    s_nop 1
    v_cndmask_b32 v79, v15, 0, vcc
    v_cndmask_b32 v95, 0, v15, vcc
    v_mov_b32 v8, 0xff7fffff
    v_mov_b32 v10, 0xff7fffff
    s_waitcnt vmcnt(0) lgkmcnt(0)
    v_mfma_f32_32x32x16_bf16 v[172:187], v[156:159], v[24:27], 0
    v_mfma_f32_32x32x16_bf16 v[188:203], v[160:163], v[24:27], v[80:95]
    v_mfma_f32_32x32x16_bf16 v[204:219], v[156:159], v[28:31], 0
    s_nop 9
    v_max3_f32 v8, v8, v172, v173
    v_max3_f32 v8, v8, v174, v175
    v_max3_f32 v8, v8, v176, v177
    v_max3_f32 v8, v8, v178, v179
    v_max3_f32 v8, v8, v180, v181
    v_max3_f32 v8, v8, v182, v183
    v_max3_f32 v8, v8, v184, v185
    v_max3_f32 v8, v8, v186, v187
    v_mfma_f32_32x32x16_bf16 v[172:187], v[160:163], v[28:31], 0
    v_max3_f32 v8, v8, v188, v189
    v_max3_f32 v8, v8, v190, v191
    v_max3_f32 v8, v8, v192, v193
    v_max3_f32 v8, v8, v194, v195
    v_max3_f32 v8, v8, v196, v197
    v_max3_f32 v8, v8, v198, v199
    v_max3_f32 v8, v8, v200, v201
    v_max3_f32 v8, v8, v202, v203
    v_mov_b32 v9, v8
    s_nop 1
    v_permlane32_swap_b32 v8, v9
    s_nop 0
    v_max_f32 v8, v8, v9
    v_sub_f32 v8, 0, v8
    v_mov_b32 v9, v8
    v_mfma_f32_32x32x16_bf16 v[188:203], v[164:167], v[28:31], 0
    v_max3_f32 v10, v10, v204, v205
    v_max3_f32 v10, v10, v206, v207
    v_max3_f32 v10, v10, v208, v209
    v_max3_f32 v10, v10, v210, v211
    v_max3_f32 v10, v10, v212, v213
    v_max3_f32 v10, v10, v214, v215
    v_max3_f32 v10, v10, v216, v217
    v_max3_f32 v10, v10, v218, v219
    v_mfma_f32_32x32x16_bf16 v[204:219], v[168:171], v[28:31], v[80:95]
    v_max3_f32 v10, v10, v172, v173
    v_max3_f32 v10, v10, v174, v175
    v_max3_f32 v10, v10, v176, v177
    v_max3_f32 v10, v10, v178, v179
    v_max3_f32 v10, v10, v180, v181
    v_max3_f32 v10, v10, v182, v183
    v_max3_f32 v10, v10, v184, v185
    v_max3_f32 v10, v10, v186, v187
    v_max3_f32 v10, v10, v188, v189
    v_max3_f32 v10, v10, v190, v191
    v_max3_f32 v10, v10, v192, v193
    v_max3_f32 v10, v10, v194, v195
    v_max3_f32 v10, v10, v196, v197
    v_max3_f32 v10, v10, v198, v199
    v_max3_f32 v10, v10, v200, v201
    v_max3_f32 v10, v10, v202, v203
    v_max3_f32 v10, v10, v204, v205
    v_max3_f32 v10, v10, v206, v207
    v_max3_f32 v10, v10, v208, v209
    v_max3_f32 v10, v10, v210, v211
    v_max3_f32 v10, v10, v212, v213
    v_max3_f32 v10, v10, v214, v215
    v_max3_f32 v10, v10, v216, v217
    v_max3_f32 v10, v10, v218, v219
    v_mov_b32 v11, v10
    s_nop 1
    v_permlane32_swap_b32 v10, v11
    s_nop 0
    v_max_f32 v10, v10, v11
    v_sub_f32 v10, 0, v10
    v_mov_b32 v11, v10
    v_mov_b64 v[64:65], v[8:9]
    v_mov_b64 v[66:67], v[8:9]
    v_mov_b64 v[68:69], v[8:9]
    v_mov_b64 v[70:71], v[8:9]
    v_mov_b64 v[72:73], v[8:9]
    v_mov_b64 v[74:75], v[8:9]
    v_mov_b64 v[76:77], v[8:9]
    v_mov_b64 v[78:79], v[8:9]
    v_mov_b64 v[80:81], v[10:11]
    v_mov_b64 v[82:83], v[10:11]
    v_mov_b64 v[84:85], v[10:11]
    v_mov_b64 v[86:87], v[10:11]
    v_mov_b64 v[88:89], v[10:11]
    v_mov_b64 v[90:91], v[10:11]
    v_mov_b64 v[92:93], v[10:11]
    v_mov_b64 v[94:95], v[10:11]
    s_nop 2
    s_branch L_top_19
L_fbs_27:
    s_cmp_lg_u32 s69, 0
    s_cbranch_scc1 L_fbc_28
    s_branch L_fb_26
L_fbs_29:
    s_cmp_lg_u32 s69, 0
    s_cbranch_scc1 L_fbc_30
    s_branch L_fb_26
L_fb_26:
    s_waitcnt vmcnt(0) lgkmcnt(0)
    s_mov_b32 s69, 1
    buffer_load_dwordx4 v[24:27], v13, s[4:7], s36 offen
    buffer_load_dwordx4 v[128:131], v13, s[4:7], s37 offen offset:0
    buffer_load_dwordx4 v[132:135], v13, s[4:7], s37 offen offset:1024
    buffer_load_dwordx4 v[28:31], v13, s[4:7], s36 offen offset:2048
    buffer_load_dwordx4 v[136:139], v13, s[4:7], s37 offen offset:2048
    buffer_load_dwordx4 v[140:143], v13, s[4:7], s37 offen offset:3072
    s_add_u32 s38, s37, 4096
    buffer_load_dwordx4 v[144:147], v13, s[4:7], s38 offen offset:0
    buffer_load_dwordx4 v[148:151], v13, s[4:7], s38 offen offset:1024
    buffer_load_dwordx4 v[152:155], v13, s[4:7], s38 offen offset:2048
    buffer_load_dwordx4 v[156:159], v13, s[4:7], s38 offen offset:3072
    s_add_u32 s38, s37, 8192
    buffer_load_dwordx4 v[160:163], v13, s[4:7], s38 offen offset:0
    buffer_load_dwordx4 v[164:167], v13, s[4:7], s38 offen offset:1024
    buffer_load_dwordx4 v[168:171], v13, s[4:7], s38 offen offset:2048
    v_and_b32 v14, 31, v1
    v_lshrrev_b32 v15, 5, v1
    v_lshlrev_b32 v15, 2, v15
    v_sub_u32 v14, v14, v15
    v_mov_b32 v15, 0xff7fffff
    v_cmp_gt_i32 vcc, 0, v14
    s_nop 1
    v_cndmask_b32 v64, v15, 0, vcc
    v_cndmask_b32 v80, 0, v15, vcc
    v_cmp_gt_i32 vcc, 1, v14
    s_nop 1
    v_cndmask_b32 v65, v15, 0, vcc
    v_cndmask_b32 v81, 0, v15, vcc
    v_cmp_gt_i32 vcc, 2, v14
    s_nop 1
    v_cndmask_b32 v66, v15, 0, vcc
    v_cndmask_b32 v82, 0, v15, vcc
    v_cmp_gt_i32 vcc, 3, v14
    s_nop 1
    v_cndmask_b32 v67, v15, 0, vcc
    v_cndmask_b32 v83, 0, v15, vcc
    v_cmp_gt_i32 vcc, 8, v14
    s_nop 1
    v_cndmask_b32 v68, v15, 0, vcc
    v_cndmask_b32 v84, 0, v15, vcc
    v_cmp_gt_i32 vcc, 9, v14
    s_nop 1
    v_cndmask_b32 v69, v15, 0, vcc
    v_cndmask_b32 v85, 0, v15, vcc
    v_cmp_gt_i32 vcc, 10, v14
    s_nop 1
    v_cndmask_b32 v70, v15, 0, vcc
    v_cndmask_b32 v86, 0, v15, vcc
    v_cmp_gt_i32 vcc, 11, v14
    s_nop 1
    v_cndmask_b32 v71, v15, 0, vcc
    v_cndmask_b32 v87, 0, v15, vcc
    v_cmp_gt_i32 vcc, 16, v14
    s_nop 1
    v_cndmask_b32 v72, v15, 0, vcc
    v_cndmask_b32 v88, 0, v15, vcc
    v_cmp_gt_i32 vcc, 17, v14
    s_nop 1
    v_cndmask_b32 v73, v15, 0, vcc
    v_cndmask_b32 v89, 0, v15, vcc
    v_cmp_gt_i32 vcc, 18, v14
    s_nop 1
    v_cndmask_b32 v74, v15, 0, vcc
    v_cndmask_b32 v90, 0, v15, vcc
    v_cmp_gt_i32 vcc, 19, v14
    s_nop 1
    v_cndmask_b32 v75, v15, 0, vcc
    v_cndmask_b32 v91, 0, v15, vcc
    v_cmp_gt_i32 vcc, 24, v14
    s_nop 1
    v_cndmask_b32 v76, v15, 0, vcc
    v_cndmask_b32 v92, 0, v15, vcc
    v_cmp_gt_i32 vcc, 25, v14
    s_nop 1
    v_cndmask_b32 v77, v15, 0, vcc
    v_cndmask_b32 v93, 0, v15, vcc
    v_cmp_gt_i32 vcc, 26, v14
    s_nop 1
    v_cndmask_b32 v78, v15, 0, vcc
    v_cndmask_b32 v94, 0, v15, vcc
    v_cmp_gt_i32 vcc, 27, v14
    s_nop 1
    v_cndmask_b32 v79, v15, 0, vcc
    v_cndmask_b32 v95, 0, v15, vcc
    v_mov_b32 v8, 0xff7fffff
    v_mov_b32 v10, 0xff7fffff
    s_waitcnt vmcnt(0) lgkmcnt(0)
    v_mfma_f32_32x32x16_bf16 v[172:187], v[144:147], v[24:27], 0
    v_mfma_f32_32x32x16_bf16 v[188:203], v[148:151], v[24:27], 0
    v_mfma_f32_32x32x16_bf16 v[204:219], v[152:155], v[24:27], 0
    s_nop 9
    v_max3_f32 v8, v8, v172, v173
    v_max3_f32 v8, v8, v174, v175
    v_max3_f32 v8, v8, v176, v177
    v_max3_f32 v8, v8, v178, v179
    v_max3_f32 v8, v8, v180, v181
    v_max3_f32 v8, v8, v182, v183
    v_max3_f32 v8, v8, v184, v185
    v_max3_f32 v8, v8, v186, v187
    v_mfma_f32_32x32x16_bf16 v[172:187], v[156:159], v[24:27], 0
    v_max3_f32 v8, v8, v188, v189
    v_max3_f32 v8, v8, v190, v191
    v_max3_f32 v8, v8, v192, v193
    v_max3_f32 v8, v8, v194, v195
    v_max3_f32 v8, v8, v196, v197
    v_max3_f32 v8, v8, v198, v199
    v_max3_f32 v8, v8, v200, v201
    v_max3_f32 v8, v8, v202, v203
    v_mfma_f32_32x32x16_bf16 v[188:203], v[160:163], v[24:27], v[80:95]
    v_max3_f32 v8, v8, v204, v205
    v_max3_f32 v8, v8, v206, v207
    v_max3_f32 v8, v8, v208, v209
    v_max3_f32 v8, v8, v210, v211
    v_max3_f32 v8, v8, v212, v213
    v_max3_f32 v8, v8, v214, v215
    v_max3_f32 v8, v8, v216, v217
    v_max3_f32 v8, v8, v218, v219
    v_mfma_f32_32x32x16_bf16 v[204:219], v[144:147], v[28:31], 0
    v_max3_f32 v8, v8, v172, v173
    v_max3_f32 v8, v8, v174, v175
    v_max3_f32 v8, v8, v176, v177
    v_max3_f32 v8, v8, v178, v179
    v_max3_f32 v8, v8, v180, v181
    v_max3_f32 v8, v8, v182, v183
    v_max3_f32 v8, v8, v184, v185
    v_max3_f32 v8, v8, v186, v187
    v_mfma_f32_32x32x16_bf16 v[172:187], v[148:151], v[28:31], 0
    v_max3_f32 v8, v8, v188, v189
    v_max3_f32 v8, v8, v190, v191
    v_max3_f32 v8, v8, v192, v193
    v_max3_f32 v8, v8, v194, v195
    v_max3_f32 v8, v8, v196, v197
    v_max3_f32 v8, v8, v198, v199
    v_max3_f32 v8, v8, v200, v201
    v_max3_f32 v8, v8, v202, v203
    v_mov_b32 v9, v8
    s_nop 1
    v_permlane32_swap_b32 v8, v9
    s_nop 0
    v_max_f32 v8, v8, v9
    v_sub_f32 v8, 0, v8
    v_mov_b32 v9, v8
    v_mfma_f32_32x32x16_bf16 v[188:203], v[152:155], v[28:31], 0
    v_max3_f32 v10, v10, v204, v205
    v_max3_f32 v10, v10, v206, v207
    v_max3_f32 v10, v10, v208, v209
    v_max3_f32 v10, v10, v210, v211
    v_max3_f32 v10, v10, v212, v213
    v_max3_f32 v10, v10, v214, v215
    v_max3_f32 v10, v10, v216, v217
    v_max3_f32 v10, v10, v218, v219
    v_mfma_f32_32x32x16_bf16 v[204:219], v[156:159], v[28:31], 0
    v_max3_f32 v10, v10, v172, v173
    v_max3_f32 v10, v10, v174, v175
    v_max3_f32 v10, v10, v176, v177
    v_max3_f32 v10, v10, v178, v179
    v_max3_f32 v10, v10, v180, v181
    v_max3_f32 v10, v10, v182, v183
    v_max3_f32 v10, v10, v184, v185
    v_max3_f32 v10, v10, v186, v187
    v_mfma_f32_32x32x16_bf16 v[172:187], v[160:163], v[28:31], 0
    v_max3_f32 v10, v10, v188, v189
    v_max3_f32 v10, v10, v190, v191
    v_max3_f32 v10, v10, v192, v193
    v_max3_f32 v10, v10, v194, v195
    v_max3_f32 v10, v10, v196, v197
    v_max3_f32 v10, v10, v198, v199
    v_max3_f32 v10, v10, v200, v201
    v_max3_f32 v10, v10, v202, v203
    v_mfma_f32_32x32x16_bf16 v[188:203], v[164:167], v[28:31], 0
    v_max3_f32 v10, v10, v204, v205
    v_max3_f32 v10, v10, v206, v207
    v_max3_f32 v10, v10, v208, v209
    v_max3_f32 v10, v10, v210, v211
    v_max3_f32 v10, v10, v212, v213
    v_max3_f32 v10, v10, v214, v215
    v_max3_f32 v10, v10, v216, v217
    v_max3_f32 v10, v10, v218, v219
    v_mfma_f32_32x32x16_bf16 v[204:219], v[168:171], v[28:31], v[80:95]
    v_max3_f32 v10, v10, v172, v173
    v_max3_f32 v10, v10, v174, v175
    v_max3_f32 v10, v10, v176, v177
    v_max3_f32 v10, v10, v178, v179
    v_max3_f32 v10, v10, v180, v181
    v_max3_f32 v10, v10, v182, v183
    v_max3_f32 v10, v10, v184, v185
    v_max3_f32 v10, v10, v186, v187
    v_max3_f32 v10, v10, v188, v189
    v_max3_f32 v10, v10, v190, v191
    v_max3_f32 v10, v10, v192, v193
    v_max3_f32 v10, v10, v194, v195
    v_max3_f32 v10, v10, v196, v197
    v_max3_f32 v10, v10, v198, v199
    v_max3_f32 v10, v10, v200, v201
    v_max3_f32 v10, v10, v202, v203
    v_max3_f32 v10, v10, v204, v205
    v_max3_f32 v10, v10, v206, v207
    v_max3_f32 v10, v10, v208, v209
    v_max3_f32 v10, v10, v210, v211
    v_max3_f32 v10, v10, v212, v213
    v_max3_f32 v10, v10, v214, v215
    v_max3_f32 v10, v10, v216, v217
    v_max3_f32 v10, v10, v218, v219
    v_mov_b32 v11, v10
    s_nop 1
    v_permlane32_swap_b32 v10, v11
    s_nop 0
    v_max_f32 v10, v10, v11
    v_sub_f32 v10, 0, v10
    v_mov_b32 v11, v10
    v_mov_b64 v[64:65], v[8:9]
    v_mov_b64 v[66:67], v[8:9]
    v_mov_b64 v[68:69], v[8:9]
    v_mov_b64 v[70:71], v[8:9]
    v_mov_b64 v[72:73], v[8:9]
    v_mov_b64 v[74:75], v[8:9]
    v_mov_b64 v[76:77], v[8:9]
    v_mov_b64 v[78:79], v[8:9]
    v_mov_b64 v[80:81], v[10:11]
    v_mov_b64 v[82:83], v[10:11]
    v_mov_b64 v[84:85], v[10:11]
    v_mov_b64 v[86:87], v[10:11]
    v_mov_b64 v[88:89], v[10:11]
    v_mov_b64 v[90:91], v[10:11]
    v_mov_b64 v[92:93], v[10:11]
    v_mov_b64 v[94:95], v[10:11]
    s_nop 2
    s_branch L_top_25
L_fbs_33:
    s_cmp_lg_u32 s69, 0
    s_cbranch_scc1 L_fbc_34
    s_branch L_fb_32
L_fbs_35:
    s_cmp_lg_u32 s69, 0
    s_cbranch_scc1 L_fbc_36
    s_branch L_fb_32
L_fb_32:
    s_waitcnt vmcnt(0) lgkmcnt(0)
    s_mov_b32 s69, 1
    buffer_load_dwordx4 v[24:27], v13, s[4:7], s36 offen
    buffer_load_dwordx4 v[128:131], v13, s[4:7], s37 offen offset:0
    buffer_load_dwordx4 v[132:135], v13, s[4:7], s37 offen offset:1024
    buffer_load_dwordx4 v[28:31], v13, s[4:7], s36 offen offset:2048
    buffer_load_dwordx4 v[136:139], v13, s[4:7], s37 offen offset:2048
    buffer_load_dwordx4 v[140:143], v13, s[4:7], s37 offen offset:3072
    s_add_u32 s38, s37, 4096
    buffer_load_dwordx4 v[144:147], v13, s[4:7], s38 offen offset:0
    buffer_load_dwordx4 v[148:151], v13, s[4:7], s38 offen offset:1024
    buffer_load_dwordx4 v[152:155], v13, s[4:7], s38 offen offset:2048
    buffer_load_dwordx4 v[156:159], v13, s[4:7], s38 offen offset:3072
    s_add_u32 s38, s37, 8192
    buffer_load_dwordx4 v[160:163], v13, s[4:7], s38 offen offset:0
    buffer_load_dwordx4 v[164:167], v13, s[4:7], s38 offen offset:1024
    buffer_load_dwordx4 v[168:171], v13, s[4:7], s38 offen offset:2048
    v_and_b32 v14, 31, v1
    v_lshrrev_b32 v15, 5, v1
    v_lshlrev_b32 v15, 2, v15
    v_sub_u32 v14, v14, v15
    v_mov_b32 v15, 0xff7fffff
    v_cmp_gt_i32 vcc, 0, v14
    s_nop 1
    v_cndmask_b32 v64, v15, 0, vcc
    v_cndmask_b32 v80, 0, v15, vcc
    v_cmp_gt_i32 vcc, 1, v14
    s_nop 1
    v_cndmask_b32 v65, v15, 0, vcc
    v_cndmask_b32 v81, 0, v15, vcc
    v_cmp_gt_i32 vcc, 2, v14
    s_nop 1
    v_cndmask_b32 v66, v15, 0, vcc
    v_cndmask_b32 v82, 0, v15, vcc
    v_cmp_gt_i32 vcc, 3, v14
    s_nop 1
    v_cndmask_b32 v67, v15, 0, vcc
    v_cndmask_b32 v83, 0, v15, vcc
    v_cmp_gt_i32 vcc, 8, v14
    s_nop 1
    v_cndmask_b32 v68, v15, 0, vcc
    v_cndmask_b32 v84, 0, v15, vcc
    v_cmp_gt_i32 vcc, 9, v14
    s_nop 1
    v_cndmask_b32 v69, v15, 0, vcc
    v_cndmask_b32 v85, 0, v15, vcc
    v_cmp_gt_i32 vcc, 10, v14
    s_nop 1
    v_cndmask_b32 v70, v15, 0, vcc
    v_cndmask_b32 v86, 0, v15, vcc
    v_cmp_gt_i32 vcc, 11, v14
    s_nop 1
    v_cndmask_b32 v71, v15, 0, vcc
    v_cndmask_b32 v87, 0, v15, vcc
    v_cmp_gt_i32 vcc, 16, v14
    s_nop 1
    v_cndmask_b32 v72, v15, 0, vcc
    v_cndmask_b32 v88, 0, v15, vcc
    v_cmp_gt_i32 vcc, 17, v14
    s_nop 1
    v_cndmask_b32 v73, v15, 0, vcc
    v_cndmask_b32 v89, 0, v15, vcc
    v_cmp_gt_i32 vcc, 18, v14
    s_nop 1
    v_cndmask_b32 v74, v15, 0, vcc
    v_cndmask_b32 v90, 0, v15, vcc
    v_cmp_gt_i32 vcc, 19, v14
    s_nop 1
    v_cndmask_b32 v75, v15, 0, vcc
    v_cndmask_b32 v91, 0, v15, vcc
    v_cmp_gt_i32 vcc, 24, v14
    s_nop 1
    v_cndmask_b32 v76, v15, 0, vcc
    v_cndmask_b32 v92, 0, v15, vcc
    v_cmp_gt_i32 vcc, 25, v14
    s_nop 1
    v_cndmask_b32 v77, v15, 0, vcc
    v_cndmask_b32 v93, 0, v15, vcc
    v_cmp_gt_i32 vcc, 26, v14
    s_nop 1
    v_cndmask_b32 v78, v15, 0, vcc
    v_cndmask_b32 v94, 0, v15, vcc
    v_cmp_gt_i32 vcc, 27, v14
    s_nop 1
    v_cndmask_b32 v79, v15, 0, vcc
    v_cndmask_b32 v95, 0, v15, vcc
    v_mov_b32 v8, 0xff7fffff
    v_mov_b32 v10, 0xff7fffff
    s_waitcnt vmcnt(0) lgkmcnt(0)
    v_mfma_f32_32x32x16_bf16 v[172:187], v[140:143], v[24:27], 0
    v_mfma_f32_32x32x16_bf16 v[188:203], v[144:147], v[24:27], 0
    v_mfma_f32_32x32x16_bf16 v[204:219], v[148:151], v[24:27], 0
    s_nop 9
    v_max3_f32 v8, v8, v172, v173
    v_max3_f32 v8, v8, v174, v175
    v_max3_f32 v8, v8, v176, v177
    v_max3_f32 v8, v8, v178, v179
    v_max3_f32 v8, v8, v180, v181
    v_max3_f32 v8, v8, v182, v183
    v_max3_f32 v8, v8, v184, v185
    v_max3_f32 v8, v8, v186, v187
    v_mfma_f32_32x32x16_bf16 v[172:187], v[152:155], v[24:27], 0
    v_max3_f32 v8, v8, v188, v189
    v_max3_f32 v8, v8, v190, v191
    v_max3_f32 v8, v8, v192, v193
    v_max3_f32 v8, v8, v194, v195
    v_max3_f32 v8, v8, v196, v197
    v_max3_f32 v8, v8, v198, v199
    v_max3_f32 v8, v8, v200, v201
    v_max3_f32 v8, v8, v202, v203
    v_mfma_f32_32x32x16_bf16 v[188:203], v[156:159], v[24:27], 0
    v_max3_f32 v8, v8, v204, v205
    v_max3_f32 v8, v8, v206, v207
    v_max3_f32 v8, v8, v208, v209
    v_max3_f32 v8, v8, v210, v211
    v_max3_f32 v8, v8, v212, v213
    v_max3_f32 v8, v8, v214, v215
    v_max3_f32 v8, v8, v216, v217
    v_max3_f32 v8, v8, v218, v219
    v_mfma_f32_32x32x16_bf16 v[204:219], v[160:163], v[24:27], v[80:95]
    v_max3_f32 v8, v8, v172, v173
    v_max3_f32 v8, v8, v174, v175
    v_max3_f32 v8, v8, v176, v177
    v_max3_f32 v8, v8, v178, v179
    v_max3_f32 v8, v8, v180, v181
    v_max3_f32 v8, v8, v182, v183
    v_max3_f32 v8, v8, v184, v185
    v_max3_f32 v8, v8, v186, v187
    v_mfma_f32_32x32x16_bf16 v[172:187], v[140:143], v[28:31], 0
    v_max3_f32 v8, v8, v188, v189
    v_max3_f32 v8, v8, v190, v191
    v_max3_f32 v8, v8, v192, v193
    v_max3_f32 v8, v8, v194, v195
    v_max3_f32 v8, v8, v196, v197
    v_max3_f32 v8, v8, v198, v199
    v_max3_f32 v8, v8, v200, v201
    v_max3_f32 v8, v8, v202, v203
    v_mfma_f32_32x32x16_bf16 v[188:203], v[144:147], v[28:31], 0
    v_max3_f32 v8, v8, v204, v205
    v_max3_f32 v8, v8, v206, v207
    v_max3_f32 v8, v8, v208, v209
    v_max3_f32 v8, v8, v210, v211
    v_max3_f32 v8, v8, v212, v213
    v_max3_f32 v8, v8, v214, v215
    v_max3_f32 v8, v8, v216, v217
    v_max3_f32 v8, v8, v218, v219
    v_mov_b32 v9, v8
    s_nop 1
    v_permlane32_swap_b32 v8, v9
    s_nop 0
    v_max_f32 v8, v8, v9
    v_sub_f32 v8, 0, v8
    v_mov_b32 v9, v8
    v_mfma_f32_32x32x16_bf16 v[204:219], v[148:151], v[28:31], 0
    v_max3_f32 v10, v10, v172, v173
    v_max3_f32 v10, v10, v174, v175
    v_max3_f32 v10, v10, v176, v177
    v_max3_f32 v10, v10, v178, v179
    v_max3_f32 v10, v10, v180, v181
    v_max3_f32 v10, v10, v182, v183
    v_max3_f32 v10, v10, v184, v185
    v_max3_f32 v10, v10, v186, v187
    v_mfma_f32_32x32x16_bf16 v[172:187], v[152:155], v[28:31], 0
    v_max3_f32 v10, v10, v188, v189
    v_max3_f32 v10, v10, v190, v191
    v_max3_f32 v10, v10, v192, v193
    v_max3_f32 v10, v10, v194, v195
    v_max3_f32 v10, v10, v196, v197
    v_max3_f32 v10, v10, v198, v199
    v_max3_f32 v10, v10, v200, v201
    v_max3_f32 v10, v10, v202, v203
    v_mfma_f32_32x32x16_bf16 v[188:203], v[156:159], v[28:31], 0
    v_max3_f32 v10, v10, v204, v205
    v_max3_f32 v10, v10, v206, v207
    v_max3_f32 v10, v10, v208, v209
    v_max3_f32 v10, v10, v210, v211
    v_max3_f32 v10, v10, v212, v213
    v_max3_f32 v10, v10, v214, v215
    v_max3_f32 v10, v10, v216, v217
    v_max3_f32 v10, v10, v218, v219
    v_mfma_f32_32x32x16_bf16 v[204:219], v[160:163], v[28:31], 0
    v_max3_f32 v10, v10, v172, v173
    v_max3_f32 v10, v10, v174, v175
    v_max3_f32 v10, v10, v176, v177
    v_max3_f32 v10, v10, v178, v179
    v_max3_f32 v10, v10, v180, v181
    v_max3_f32 v10, v10, v182, v183
    v_max3_f32 v10, v10, v184, v185
    v_max3_f32 v10, v10, v186, v187
    v_mfma_f32_32x32x16_bf16 v[172:187], v[164:167], v[28:31], 0
    v_max3_f32 v10, v10, v188, v189
    v_max3_f32 v10, v10, v190, v191
    v_max3_f32 v10, v10, v192, v193
    v_max3_f32 v10, v10, v194, v195
    v_max3_f32 v10, v10, v196, v197
    v_max3_f32 v10, v10, v198, v199
    v_max3_f32 v10, v10, v200, v201
    v_max3_f32 v10, v10, v202, v203
    v_mfma_f32_32x32x16_bf16 v[188:203], v[168:171], v[28:31], v[80:95]
    v_max3_f32 v10, v10, v204, v205
    v_max3_f32 v10, v10, v206, v207
    v_max3_f32 v10, v10, v208, v209
    v_max3_f32 v10, v10, v210, v211
    v_max3_f32 v10, v10, v212, v213
    v_max3_f32 v10, v10, v214, v215
    v_max3_f32 v10, v10, v216, v217
    v_max3_f32 v10, v10, v218, v219
    v_max3_f32 v10, v10, v172, v173
    v_max3_f32 v10, v10, v174, v175
    v_max3_f32 v10, v10, v176, v177
    v_max3_f32 v10, v10, v178, v179
    v_max3_f32 v10, v10, v180, v181
    v_max3_f32 v10, v10, v182, v183
    v_max3_f32 v10, v10, v184, v185
    v_max3_f32 v10, v10, v186, v187
    v_max3_f32 v10, v10, v188, v189
    v_max3_f32 v10, v10, v190, v191
    v_max3_f32 v10, v10, v192, v193
    v_max3_f32 v10, v10, v194, v195
    v_max3_f32 v10, v10, v196, v197
    v_max3_f32 v10, v10, v198, v199
    v_max3_f32 v10, v10, v200, v201
    v_max3_f32 v10, v10, v202, v203
    v_mov_b32 v11, v10
    s_nop 1
    v_permlane32_swap_b32 v10, v11
    s_nop 0
    v_max_f32 v10, v10, v11
    v_sub_f32 v10, 0, v10
    v_mov_b32 v11, v10
    v_mov_b64 v[64:65], v[8:9]
    v_mov_b64 v[66:67], v[8:9]
    v_mov_b64 v[68:69], v[8:9]
    v_mov_b64 v[70:71], v[8:9]
    v_mov_b64 v[72:73], v[8:9]
    v_mov_b64 v[74:75], v[8:9]
    v_mov_b64 v[76:77], v[8:9]
    v_mov_b64 v[78:79], v[8:9]
    v_mov_b64 v[80:81], v[10:11]
    v_mov_b64 v[82:83], v[10:11]
    v_mov_b64 v[84:85], v[10:11]
    v_mov_b64 v[86:87], v[10:11]
    v_mov_b64 v[88:89], v[10:11]
    v_mov_b64 v[90:91], v[10:11]
    v_mov_b64 v[92:93], v[10:11]
    v_mov_b64 v[94:95], v[10:11]
    s_nop 2
    s_branch L_top_31
L_late_37:
    s_mov_b32 s39, 20000
L_poll_74:
    buffer_load_dword v14, v5, s[4:7], s43 offen offset:0 sc1
    s_waitcnt vmcnt(0)
    v_cmp_gt_u32 vcc, 1, v14
    s_sub_u32 s39, s39, 1
    s_nop 3
    s_cbranch_scc1 L_pollx_75
    s_cmp_lg_u64 vcc, 0
    s_cbranch_scc1 L_poll_74
L_pollx_75:
    buffer_load_dwordx4 v[240:243], v2, s[4:7], s45 offen offset:0
    buffer_load_dwordx4 v[244:247], v2, s[4:7], s45 offen offset:1024
    buffer_load_dwordx4 v[248:251], v2, s[4:7], s45 offen offset:2048
    buffer_load_dwordx4 v[252:255], v2, s[4:7], s45 offen offset:3072
    buffer_load_dwordx4 v[224:227], v2, s[4:7], s44 offen offset:0
    buffer_load_dwordx4 v[228:231], v2, s[4:7], s44 offen offset:1024
    buffer_load_dwordx4 v[232:235], v2, s[4:7], s44 offen offset:2048
    buffer_load_dwordx4 v[236:239], v2, s[4:7], s44 offen offset:3072
    s_waitcnt vmcnt(0)
    s_branch L_lback_38
L_slow3_39:
    s_mov_b32 s39, 1000
L_retry3_76:
    s_waitcnt vmcnt(0) lgkmcnt(0)
    buffer_load_dwordx4 v[240:243], v2, s[4:7], s45 offen offset:0 sc1
    buffer_load_dwordx4 v[244:247], v2, s[4:7], s45 offen offset:1024 sc1
    buffer_load_dwordx4 v[248:251], v2, s[4:7], s45 offen offset:2048 sc1
    buffer_load_dwordx4 v[252:255], v2, s[4:7], s45 offen offset:3072 sc1
    buffer_load_dwordx4 v[224:227], v2, s[4:7], s44 offen offset:0 sc1
    buffer_load_dwordx4 v[228:231], v2, s[4:7], s44 offen offset:1024 sc1
    buffer_load_dwordx4 v[232:235], v2, s[4:7], s44 offen offset:2048 sc1
    buffer_load_dwordx4 v[236:239], v2, s[4:7], s44 offen offset:3072 sc1
    s_waitcnt vmcnt(0) lgkmcnt(0)
    v_mfma_f32_16x16x32_bf16 v[48:51], v[204:207], v[240:243], 0
    v_mfma_f32_16x16x32_bf16 v[52:55], v[208:211], v[240:243], 0
    v_mfma_f32_16x16x32_bf16 v[56:59], v[212:215], v[240:243], 0
    v_mfma_f32_16x16x32_bf16 v[60:63], v[216:219], v[240:243], 0
    v_mfma_f32_16x16x32_bf16 v[48:51], v[64:67], v[244:247], v[48:51]
    v_mfma_f32_16x16x32_bf16 v[52:55], v[68:71], v[244:247], v[52:55]
    v_mfma_f32_16x16x32_bf16 v[56:59], v[72:75], v[244:247], v[56:59]
    v_mfma_f32_16x16x32_bf16 v[60:63], v[76:79], v[244:247], v[60:63]
    v_mfma_f32_16x16x32_bf16 v[48:51], v[128:131], v[248:251], v[48:51]
    v_mfma_f32_16x16x32_bf16 v[52:55], v[132:135], v[248:251], v[52:55]
    v_mfma_f32_16x16x32_bf16 v[56:59], v[136:139], v[248:251], v[56:59]
    v_mfma_f32_16x16x32_bf16 v[60:63], v[140:143], v[248:251], v[60:63]
    v_mfma_f32_16x16x32_bf16 v[48:51], v[144:147], v[252:255], v[48:51]
    v_mfma_f32_16x16x32_bf16 v[52:55], v[148:151], v[252:255], v[52:55]
    v_mfma_f32_16x16x32_bf16 v[56:59], v[152:155], v[252:255], v[56:59]
    v_mfma_f32_16x16x32_bf16 v[60:63], v[156:159], v[252:255], v[60:63]
    v_mfma_f32_16x16x32_bf16 v[40:43], v[212:215], v[224:227], 0
    v_mfma_f32_16x16x32_bf16 v[44:47], v[216:219], v[224:227], 0
    v_mfma_f32_16x16x32_bf16 v[40:43], v[72:75], v[228:231], v[40:43]
    v_mfma_f32_16x16x32_bf16 v[44:47], v[76:79], v[228:231], v[44:47]
    s_nop 0
    ds_write_b128 v9, v[48:51] offset:0
    v_mfma_f32_16x16x32_bf16 v[40:43], v[136:139], v[232:235], v[40:43]
    v_mfma_f32_16x16x32_bf16 v[44:47], v[140:143], v[232:235], v[44:47]
    ds_write_b128 v9, v[52:55] offset:1024
    v_mfma_f32_16x16x32_bf16 v[40:43], v[152:155], v[236:239], v[40:43]
    v_mfma_f32_16x16x32_bf16 v[44:47], v[156:159], v[236:239], v[44:47]
    ds_write_b128 v10, v[56:59] offset:0
    v_mfma_f32_16x16x32_bf16 v[32:35], v[204:207], v[224:227], 0
    v_mfma_f32_16x16x32_bf16 v[36:39], v[208:211], v[224:227], 0
    ds_write_b128 v10, v[60:63] offset:1024
    v_mfma_f32_16x16x32_bf16 v[32:35], v[64:67], v[228:231], v[32:35]
    v_mfma_f32_16x16x32_bf16 v[36:39], v[68:71], v[228:231], v[36:39]
    v_mfma_f32_16x16x32_bf16 v[32:35], v[128:131], v[232:235], v[32:35]
    v_mfma_f32_16x16x32_bf16 v[36:39], v[132:135], v[232:235], v[36:39]
    ds_write_b128 v8, v[40:43] offset:0
    v_mfma_f32_16x16x32_bf16 v[32:35], v[144:147], v[236:239], v[32:35]
    v_mfma_f32_16x16x32_bf16 v[36:39], v[148:151], v[236:239], v[36:39]
    ds_write_b128 v8, v[44:47] offset:1024
    v_cmp_u_f32 vcc, v48, v40
    s_waitcnt vmcnt(0) lgkmcnt(0)
    s_sub_u32 s39, s39, 1
    s_nop 3
    s_cbranch_scc1 L_back3_40
    s_cbranch_vccnz L_retry3_76
    s_branch L_back3_40
L_slow3_41:
    s_mov_b32 s39, 1000
L_retry3_77:
    s_waitcnt vmcnt(0) lgkmcnt(0)
    buffer_load_dwordx4 v[80:83], v2, s[4:7], s73 offen offset:0 sc1
    buffer_load_dwordx4 v[84:87], v2, s[4:7], s73 offen offset:1024 sc1
    buffer_load_dwordx4 v[88:91], v2, s[4:7], s73 offen offset:2048 sc1
    buffer_load_dwordx4 v[92:95], v2, s[4:7], s73 offen offset:3072 sc1
    buffer_load_dwordx4 v[184:187], v2, s[4:7], s72 offen offset:0 sc1
    buffer_load_dwordx4 v[188:191], v2, s[4:7], s72 offen offset:1024 sc1
    buffer_load_dwordx4 v[192:195], v2, s[4:7], s72 offen offset:2048 sc1
    buffer_load_dwordx4 v[196:199], v2, s[4:7], s72 offen offset:3072 sc1
    s_waitcnt vmcnt(0) lgkmcnt(0)
    v_mfma_f32_16x16x32_bf16 v[48:51], v[204:207], v[80:83], 0
    v_mfma_f32_16x16x32_bf16 v[52:55], v[208:211], v[80:83], 0
    v_mfma_f32_16x16x32_bf16 v[56:59], v[212:215], v[80:83], 0
    v_mfma_f32_16x16x32_bf16 v[60:63], v[216:219], v[80:83], 0
    v_mfma_f32_16x16x32_bf16 v[48:51], v[64:67], v[84:87], v[48:51]
    v_mfma_f32_16x16x32_bf16 v[52:55], v[68:71], v[84:87], v[52:55]
    v_mfma_f32_16x16x32_bf16 v[56:59], v[72:75], v[84:87], v[56:59]
    v_mfma_f32_16x16x32_bf16 v[60:63], v[76:79], v[84:87], v[60:63]
    v_mfma_f32_16x16x32_bf16 v[48:51], v[128:131], v[88:91], v[48:51]
    v_mfma_f32_16x16x32_bf16 v[52:55], v[132:135], v[88:91], v[52:55]
    v_mfma_f32_16x16x32_bf16 v[56:59], v[136:139], v[88:91], v[56:59]
    v_mfma_f32_16x16x32_bf16 v[60:63], v[140:143], v[88:91], v[60:63]
    v_mfma_f32_16x16x32_bf16 v[48:51], v[144:147], v[92:95], v[48:51]
    v_mfma_f32_16x16x32_bf16 v[52:55], v[148:151], v[92:95], v[52:55]
    v_mfma_f32_16x16x32_bf16 v[56:59], v[152:155], v[92:95], v[56:59]
    v_mfma_f32_16x16x32_bf16 v[60:63], v[156:159], v[92:95], v[60:63]
    v_mfma_f32_16x16x32_bf16 v[40:43], v[212:215], v[184:187], 0
    v_mfma_f32_16x16x32_bf16 v[44:47], v[216:219], v[184:187], 0
    v_mfma_f32_16x16x32_bf16 v[40:43], v[72:75], v[188:191], v[40:43]
    v_mfma_f32_16x16x32_bf16 v[44:47], v[76:79], v[188:191], v[44:47]
    s_nop 0
    ds_write_b128 v9, v[48:51] offset:24576
    v_mfma_f32_16x16x32_bf16 v[40:43], v[136:139], v[192:195], v[40:43]
    v_mfma_f32_16x16x32_bf16 v[44:47], v[140:143], v[192:195], v[44:47]
    ds_write_b128 v9, v[52:55] offset:25600
    v_mfma_f32_16x16x32_bf16 v[40:43], v[152:155], v[196:199], v[40:43]
    v_mfma_f32_16x16x32_bf16 v[44:47], v[156:159], v[196:199], v[44:47]
    ds_write_b128 v10, v[56:59] offset:24576
    v_mfma_f32_16x16x32_bf16 v[32:35], v[204:207], v[184:187], 0
    v_mfma_f32_16x16x32_bf16 v[36:39], v[208:211], v[184:187], 0
    ds_write_b128 v10, v[60:63] offset:25600
    v_mfma_f32_16x16x32_bf16 v[32:35], v[64:67], v[188:191], v[32:35]
    v_mfma_f32_16x16x32_bf16 v[36:39], v[68:71], v[188:191], v[36:39]
    v_mfma_f32_16x16x32_bf16 v[32:35], v[128:131], v[192:195], v[32:35]
    v_mfma_f32_16x16x32_bf16 v[36:39], v[132:135], v[192:195], v[36:39]
    ds_write_b128 v8, v[40:43] offset:24576
    v_mfma_f32_16x16x32_bf16 v[32:35], v[144:147], v[196:199], v[32:35]
    v_mfma_f32_16x16x32_bf16 v[36:39], v[148:151], v[196:199], v[36:39]
    ds_write_b128 v8, v[44:47] offset:25600
    v_cmp_u_f32 vcc, v48, v40
    s_waitcnt vmcnt(0) lgkmcnt(0)
    s_sub_u32 s39, s39, 1
    s_nop 3
    s_cbranch_scc1 L_back3_42
    s_cbranch_vccnz L_retry3_77
    s_branch L_back3_42
L_slow4_46:
    s_mov_b32 s39, 1000
L_retry4_48:
    s_waitcnt vmcnt(0) lgkmcnt(0)
    s_barrier
    s_add_u32 m0, s51, 0x20000
    s_nop 0
    buffer_load_dwordx4 v2, s[4:7], s52 offen offset:0 sc1 lds
    s_add_u32 m0, s51, 0x20000
    s_nop 0
    buffer_load_dwordx4 v2, s[4:7], s52 offen offset:1024 sc1 lds
    s_add_u32 m0, s51, 0x0
    s_add_u32 s66, s50, 0x0
    buffer_load_dwordx4 v2, s[4:7], s66 offen offset:0 sc1 lds
    s_add_u32 m0, s51, 0x0
    s_add_u32 s66, s50, 0x0
    buffer_load_dwordx4 v2, s[4:7], s66 offen offset:1024 sc1 lds
    s_add_u32 m0, s51, 0x0
    s_add_u32 s66, s50, 0x0
    buffer_load_dwordx4 v2, s[4:7], s66 offen offset:2048 sc1 lds
    s_add_u32 m0, s51, 0x0
    s_add_u32 s66, s50, 0x0
    buffer_load_dwordx4 v2, s[4:7], s66 offen offset:3072 sc1 lds
    s_waitcnt vmcnt(0) lgkmcnt(0)
    s_barrier
    ds_read2st64_b32 v[88:89], v4 offset0:0 offset1:1
    ds_read2st64_b32 v[90:91], v4 offset0:16 offset1:17
    ds_read2st64_b32 v[92:93], v4 offset0:32 offset1:33
    ds_read2st64_b32 v[94:95], v4 offset0:48 offset1:49
    s_waitcnt lgkmcnt(0)
    v_add_f32 v88, v88, v89
    v_add_f32 v90, v90, v91
    v_add_f32 v92, v92, v93
    v_add_f32 v94, v94, v95
    v_add_f32 v88, v88, v90
    v_add_f32 v92, v92, v94
    v_add_f32 v88, v88, v92
    v_mov_b32 v89, v88
    s_nop 1
    v_permlane16_swap_b32 v88, v89
    s_nop 0
    v_add_f32 v88, v88, v89
    v_mov_b32 v89, v88
    s_nop 1
    v_permlane32_swap_b32 v88, v89
    s_nop 0
    v_mul_f32 v92, 0xbb000000, v88
    v_mul_f32 v94, 0x3b000000, v89
    v_add_f32 v94, 0x3727c5ac, v94
    v_fma_f32 v94, -v92, v92, v94
    v_rsq_f32 v93, v94
    s_nop 0
    v_mul_f32 v93, 0xbfb8aa3b, v93
    ds_write_b96 v6, v[92:94] offset:0
    s_waitcnt vmcnt(0) lgkmcnt(0)
    s_barrier
    ds_read_b96 v[8:10], v7 offset:0
    ds_read_b128 v[24:27], v2 offset:0
    s_waitcnt lgkmcnt(0)
    v_mfma_f32_16x16x32_bf16 v[32:35], a[0:3], v[24:27], 0
    v_mfma_f32_16x16x32_bf16 v[36:39], a[4:7], v[24:27], 0
    v_mfma_f32_16x16x32_bf16 v[40:43], a[8:11], v[24:27], 0
    v_mfma_f32_16x16x32_bf16 v[44:47], a[12:15], v[24:27], 0
    ds_read_b128 v[28:31], v2 offset:1024
    s_waitcnt lgkmcnt(0)
    v_mfma_f32_16x16x32_bf16 v[32:35], a[16:19], v[28:31], v[32:35]
    v_mfma_f32_16x16x32_bf16 v[36:39], a[20:23], v[28:31], v[36:39]
    v_mfma_f32_16x16x32_bf16 v[40:43], a[24:27], v[28:31], v[40:43]
    v_mfma_f32_16x16x32_bf16 v[44:47], a[28:31], v[28:31], v[44:47]
    ds_read_b128 v[24:27], v2 offset:2048
    s_waitcnt lgkmcnt(0)
    v_mfma_f32_16x16x32_bf16 v[32:35], a[32:35], v[24:27], v[32:35]
    v_mfma_f32_16x16x32_bf16 v[36:39], a[36:39], v[24:27], v[36:39]
    v_mfma_f32_16x16x32_bf16 v[40:43], a[40:43], v[24:27], v[40:43]
    v_mfma_f32_16x16x32_bf16 v[44:47], a[44:47], v[24:27], v[44:47]
    ds_read_b128 v[28:31], v2 offset:3072
    s_waitcnt lgkmcnt(0)
    v_mfma_f32_16x16x32_bf16 v[32:35], a[48:51], v[28:31], v[32:35]
    v_mfma_f32_16x16x32_bf16 v[36:39], a[52:55], v[28:31], v[36:39]
    v_mfma_f32_16x16x32_bf16 v[40:43], a[56:59], v[28:31], v[40:43]
    v_mfma_f32_16x16x32_bf16 v[44:47], a[60:63], v[28:31], v[44:47]
    ds_read_b128 v[24:27], v2 offset:4096
    s_waitcnt lgkmcnt(0)
    v_mfma_f32_16x16x32_bf16 v[32:35], a[64:67], v[24:27], v[32:35]
    v_mfma_f32_16x16x32_bf16 v[36:39], a[68:71], v[24:27], v[36:39]
    v_mfma_f32_16x16x32_bf16 v[40:43], a[72:75], v[24:27], v[40:43]
    v_mfma_f32_16x16x32_bf16 v[44:47], a[76:79], v[24:27], v[44:47]
    ds_read_b128 v[28:31], v2 offset:5120
    s_waitcnt lgkmcnt(0)
    v_mfma_f32_16x16x32_bf16 v[32:35], a[80:83], v[28:31], v[32:35]
    v_mfma_f32_16x16x32_bf16 v[36:39], a[84:87], v[28:31], v[36:39]
    v_mfma_f32_16x16x32_bf16 v[40:43], a[88:91], v[28:31], v[40:43]
    v_mfma_f32_16x16x32_bf16 v[44:47], a[92:95], v[28:31], v[44:47]
    ds_read_b128 v[24:27], v2 offset:6144
    s_waitcnt lgkmcnt(0)
    v_mfma_f32_16x16x32_bf16 v[32:35], a[96:99], v[24:27], v[32:35]
    v_mfma_f32_16x16x32_bf16 v[36:39], a[100:103], v[24:27], v[36:39]
    v_mfma_f32_16x16x32_bf16 v[40:43], a[104:107], v[24:27], v[40:43]
    v_mfma_f32_16x16x32_bf16 v[44:47], a[108:111], v[24:27], v[44:47]
    ds_read_b128 v[28:31], v2 offset:7168
    s_waitcnt lgkmcnt(0)
    v_mfma_f32_16x16x32_bf16 v[32:35], a[112:115], v[28:31], v[32:35]
    v_mfma_f32_16x16x32_bf16 v[36:39], a[116:119], v[28:31], v[36:39]
    v_mfma_f32_16x16x32_bf16 v[40:43], a[120:123], v[28:31], v[40:43]
    v_mfma_f32_16x16x32_bf16 v[44:47], a[124:127], v[28:31], v[44:47]
    ds_read_b128 v[24:27], v2 offset:8192
    s_waitcnt lgkmcnt(0)
    v_mfma_f32_16x16x32_bf16 v[32:35], a[128:131], v[24:27], v[32:35]
    v_mfma_f32_16x16x32_bf16 v[36:39], a[132:135], v[24:27], v[36:39]
    v_mfma_f32_16x16x32_bf16 v[40:43], a[136:139], v[24:27], v[40:43]
    v_mfma_f32_16x16x32_bf16 v[44:47], a[140:143], v[24:27], v[44:47]
    ds_read_b128 v[28:31], v2 offset:9216
    s_waitcnt lgkmcnt(0)
    v_mfma_f32_16x16x32_bf16 v[32:35], a[144:147], v[28:31], v[32:35]
    v_mfma_f32_16x16x32_bf16 v[36:39], a[148:151], v[28:31], v[36:39]
    v_mfma_f32_16x16x32_bf16 v[40:43], a[152:155], v[28:31], v[40:43]
    v_mfma_f32_16x16x32_bf16 v[44:47], a[156:159], v[28:31], v[44:47]
    ds_read_b128 v[24:27], v2 offset:10240
    s_waitcnt lgkmcnt(0)
    v_mfma_f32_16x16x32_bf16 v[32:35], a[160:163], v[24:27], v[32:35]
    v_mfma_f32_16x16x32_bf16 v[36:39], a[164:167], v[24:27], v[36:39]
    v_mfma_f32_16x16x32_bf16 v[40:43], a[168:171], v[24:27], v[40:43]
    v_mfma_f32_16x16x32_bf16 v[44:47], a[172:175], v[24:27], v[44:47]
    ds_read_b128 v[28:31], v2 offset:11264
    s_waitcnt lgkmcnt(0)
    v_mfma_f32_16x16x32_bf16 v[32:35], a[176:179], v[28:31], v[32:35]
    v_mfma_f32_16x16x32_bf16 v[36:39], a[180:183], v[28:31], v[36:39]
    v_mfma_f32_16x16x32_bf16 v[40:43], a[184:187], v[28:31], v[40:43]
    v_mfma_f32_16x16x32_bf16 v[44:47], a[188:191], v[28:31], v[44:47]
    ds_read_b128 v[24:27], v2 offset:12288
    s_waitcnt lgkmcnt(0)
    v_mfma_f32_16x16x32_bf16 v[32:35], a[192:195], v[24:27], v[32:35]
    v_mfma_f32_16x16x32_bf16 v[36:39], a[196:199], v[24:27], v[36:39]
    v_mfma_f32_16x16x32_bf16 v[40:43], a[200:203], v[24:27], v[40:43]
    v_mfma_f32_16x16x32_bf16 v[44:47], a[204:207], v[24:27], v[44:47]
    ds_read_b128 v[28:31], v2 offset:13312
    s_waitcnt lgkmcnt(0)
    v_mfma_f32_16x16x32_bf16 v[32:35], a[208:211], v[28:31], v[32:35]
    v_mfma_f32_16x16x32_bf16 v[36:39], a[212:215], v[28:31], v[36:39]
    v_mfma_f32_16x16x32_bf16 v[40:43], a[216:219], v[28:31], v[40:43]
    v_mfma_f32_16x16x32_bf16 v[44:47], a[220:223], v[28:31], v[44:47]
    ds_read_b128 v[24:27], v2 offset:14336
    s_waitcnt lgkmcnt(0)
    v_mfma_f32_16x16x32_bf16 v[32:35], a[224:227], v[24:27], v[32:35]
    v_mfma_f32_16x16x32_bf16 v[36:39], a[228:231], v[24:27], v[36:39]
    v_mfma_f32_16x16x32_bf16 v[40:43], a[232:235], v[24:27], v[40:43]
    v_mfma_f32_16x16x32_bf16 v[44:47], a[236:239], v[24:27], v[44:47]
    ds_read_b128 v[28:31], v2 offset:15360
    s_waitcnt lgkmcnt(0)
    v_mfma_f32_16x16x32_bf16 v[32:35], a[240:243], v[28:31], v[32:35]
    v_mfma_f32_16x16x32_bf16 v[36:39], a[244:247], v[28:31], v[36:39]
    v_mfma_f32_16x16x32_bf16 v[40:43], a[248:251], v[28:31], v[40:43]
    v_mfma_f32_16x16x32_bf16 v[44:47], a[252:255], v[28:31], v[44:47]
    s_nop 4
    v_cmp_u_f32 vcc, v32, v10
    s_sub_u32 s39, s39, 1
    s_nop 3
    s_cbranch_scc1 L_back4_47
    s_cbranch_vccnz L_retry4_48
    s_branch L_back4_47
L_slow4_52:
    s_mov_b32 s39, 1000
L_retry4_54:
    s_waitcnt vmcnt(0) lgkmcnt(0)
    s_barrier
    s_add_u32 m0, s51, 0x20000
    s_nop 0
    buffer_load_dwordx4 v2, s[4:7], s52 offen offset:0 sc1 lds
    s_add_u32 m0, s51, 0x20000
    s_nop 0
    buffer_load_dwordx4 v2, s[4:7], s52 offen offset:1024 sc1 lds
    s_add_u32 m0, s51, 0x4000
    s_add_u32 s66, s50, 0x4000
    buffer_load_dwordx4 v2, s[4:7], s66 offen offset:0 sc1 lds
    s_add_u32 m0, s51, 0x4000
    s_add_u32 s66, s50, 0x4000
    buffer_load_dwordx4 v2, s[4:7], s66 offen offset:1024 sc1 lds
    s_add_u32 m0, s51, 0x4000
    s_add_u32 s66, s50, 0x4000
    buffer_load_dwordx4 v2, s[4:7], s66 offen offset:2048 sc1 lds
    s_add_u32 m0, s51, 0x4000
    s_add_u32 s66, s50, 0x4000
    buffer_load_dwordx4 v2, s[4:7], s66 offen offset:3072 sc1 lds
    s_waitcnt vmcnt(0) lgkmcnt(0)
    s_barrier
    ds_read2st64_b32 v[88:89], v4 offset0:0 offset1:1
    ds_read2st64_b32 v[90:91], v4 offset0:16 offset1:17
    ds_read2st64_b32 v[92:93], v4 offset0:32 offset1:33
    ds_read2st64_b32 v[94:95], v4 offset0:48 offset1:49
    s_waitcnt lgkmcnt(0)
    v_add_f32 v88, v88, v89
    v_add_f32 v90, v90, v91
    v_add_f32 v92, v92, v93
    v_add_f32 v94, v94, v95
    v_add_f32 v88, v88, v90
    v_add_f32 v92, v92, v94
    v_add_f32 v88, v88, v92
    v_mov_b32 v89, v88
    s_nop 1
    v_permlane16_swap_b32 v88, v89
    s_nop 0
    v_add_f32 v88, v88, v89
    v_mov_b32 v89, v88
    s_nop 1
    v_permlane32_swap_b32 v88, v89
    s_nop 0
    v_mul_f32 v92, 0xbb000000, v88
    v_mul_f32 v94, 0x3b000000, v89
    v_add_f32 v94, 0x3727c5ac, v94
    v_fma_f32 v94, -v92, v92, v94
    v_rsq_f32 v93, v94
    s_nop 0
    v_mul_f32 v93, 0xbfb8aa3b, v93
    ds_write_b96 v6, v[92:94] offset:0
    s_waitcnt vmcnt(0) lgkmcnt(0)
    s_barrier
    ds_read_b96 v[12:14], v7 offset:256
    ds_read_b128 v[24:27], v2 offset:16384
    s_waitcnt lgkmcnt(0)
    v_mfma_f32_16x16x32_bf16 v[48:51], a[0:3], v[24:27], 0
    v_mfma_f32_16x16x32_bf16 v[52:55], a[4:7], v[24:27], 0
    v_mfma_f32_16x16x32_bf16 v[56:59], a[8:11], v[24:27], 0
    v_mfma_f32_16x16x32_bf16 v[60:63], a[12:15], v[24:27], 0
    ds_read_b128 v[28:31], v2 offset:17408
    s_waitcnt lgkmcnt(0)
    v_mfma_f32_16x16x32_bf16 v[48:51], a[16:19], v[28:31], v[48:51]
    v_mfma_f32_16x16x32_bf16 v[52:55], a[20:23], v[28:31], v[52:55]
    v_mfma_f32_16x16x32_bf16 v[56:59], a[24:27], v[28:31], v[56:59]
    v_mfma_f32_16x16x32_bf16 v[60:63], a[28:31], v[28:31], v[60:63]
    ds_read_b128 v[24:27], v2 offset:18432
    s_waitcnt lgkmcnt(0)
    v_mfma_f32_16x16x32_bf16 v[48:51], a[32:35], v[24:27], v[48:51]
    v_mfma_f32_16x16x32_bf16 v[52:55], a[36:39], v[24:27], v[52:55]
    v_mfma_f32_16x16x32_bf16 v[56:59], a[40:43], v[24:27], v[56:59]
    v_mfma_f32_16x16x32_bf16 v[60:63], a[44:47], v[24:27], v[60:63]
    ds_read_b128 v[28:31], v2 offset:19456
    s_waitcnt lgkmcnt(0)
    v_mfma_f32_16x16x32_bf16 v[48:51], a[48:51], v[28:31], v[48:51]
    v_mfma_f32_16x16x32_bf16 v[52:55], a[52:55], v[28:31], v[52:55]
    v_mfma_f32_16x16x32_bf16 v[56:59], a[56:59], v[28:31], v[56:59]
    v_mfma_f32_16x16x32_bf16 v[60:63], a[60:63], v[28:31], v[60:63]
    ds_read_b128 v[24:27], v2 offset:20480
    s_waitcnt lgkmcnt(0)
    v_mfma_f32_16x16x32_bf16 v[48:51], a[64:67], v[24:27], v[48:51]
    v_mfma_f32_16x16x32_bf16 v[52:55], a[68:71], v[24:27], v[52:55]
    v_mfma_f32_16x16x32_bf16 v[56:59], a[72:75], v[24:27], v[56:59]
    v_mfma_f32_16x16x32_bf16 v[60:63], a[76:79], v[24:27], v[60:63]
    ds_read_b128 v[28:31], v2 offset:21504
    s_waitcnt lgkmcnt(0)
    v_mfma_f32_16x16x32_bf16 v[48:51], a[80:83], v[28:31], v[48:51]
    v_mfma_f32_16x16x32_bf16 v[52:55], a[84:87], v[28:31], v[52:55]
    v_mfma_f32_16x16x32_bf16 v[56:59], a[88:91], v[28:31], v[56:59]
    v_mfma_f32_16x16x32_bf16 v[60:63], a[92:95], v[28:31], v[60:63]
    ds_read_b128 v[24:27], v2 offset:22528
    s_waitcnt lgkmcnt(0)
    v_mfma_f32_16x16x32_bf16 v[48:51], a[96:99], v[24:27], v[48:51]
    v_mfma_f32_16x16x32_bf16 v[52:55], a[100:103], v[24:27], v[52:55]
    v_mfma_f32_16x16x32_bf16 v[56:59], a[104:107], v[24:27], v[56:59]
    v_mfma_f32_16x16x32_bf16 v[60:63], a[108:111], v[24:27], v[60:63]
    ds_read_b128 v[28:31], v2 offset:23552
    s_waitcnt lgkmcnt(0)
    v_mfma_f32_16x16x32_bf16 v[48:51], a[112:115], v[28:31], v[48:51]
    v_mfma_f32_16x16x32_bf16 v[52:55], a[116:119], v[28:31], v[52:55]
    v_mfma_f32_16x16x32_bf16 v[56:59], a[120:123], v[28:31], v[56:59]
    v_mfma_f32_16x16x32_bf16 v[60:63], a[124:127], v[28:31], v[60:63]
    ds_read_b128 v[24:27], v2 offset:24576
    s_waitcnt lgkmcnt(0)
    v_mfma_f32_16x16x32_bf16 v[48:51], a[128:131], v[24:27], v[48:51]
    v_mfma_f32_16x16x32_bf16 v[52:55], a[132:135], v[24:27], v[52:55]
    v_mfma_f32_16x16x32_bf16 v[56:59], a[136:139], v[24:27], v[56:59]
    v_mfma_f32_16x16x32_bf16 v[60:63], a[140:143], v[24:27], v[60:63]
    ds_read_b128 v[28:31], v2 offset:25600
    s_waitcnt lgkmcnt(0)
    v_mfma_f32_16x16x32_bf16 v[48:51], a[144:147], v[28:31], v[48:51]
    v_mfma_f32_16x16x32_bf16 v[52:55], a[148:151], v[28:31], v[52:55]
    v_mfma_f32_16x16x32_bf16 v[56:59], a[152:155], v[28:31], v[56:59]
    v_mfma_f32_16x16x32_bf16 v[60:63], a[156:159], v[28:31], v[60:63]
    ds_read_b128 v[24:27], v2 offset:26624
    s_waitcnt lgkmcnt(0)
    v_mfma_f32_16x16x32_bf16 v[48:51], a[160:163], v[24:27], v[48:51]
    v_mfma_f32_16x16x32_bf16 v[52:55], a[164:167], v[24:27], v[52:55]
    v_mfma_f32_16x16x32_bf16 v[56:59], a[168:171], v[24:27], v[56:59]
    v_mfma_f32_16x16x32_bf16 v[60:63], a[172:175], v[24:27], v[60:63]
    ds_read_b128 v[28:31], v2 offset:27648
    s_waitcnt lgkmcnt(0)
    v_mfma_f32_16x16x32_bf16 v[48:51], a[176:179], v[28:31], v[48:51]
    v_mfma_f32_16x16x32_bf16 v[52:55], a[180:183], v[28:31], v[52:55]
    v_mfma_f32_16x16x32_bf16 v[56:59], a[184:187], v[28:31], v[56:59]
    v_mfma_f32_16x16x32_bf16 v[60:63], a[188:191], v[28:31], v[60:63]
    ds_read_b128 v[24:27], v2 offset:28672
    s_waitcnt lgkmcnt(0)
    v_mfma_f32_16x16x32_bf16 v[48:51], a[192:195], v[24:27], v[48:51]
    v_mfma_f32_16x16x32_bf16 v[52:55], a[196:199], v[24:27], v[52:55]
    v_mfma_f32_16x16x32_bf16 v[56:59], a[200:203], v[24:27], v[56:59]
    v_mfma_f32_16x16x32_bf16 v[60:63], a[204:207], v[24:27], v[60:63]
    ds_read_b128 v[28:31], v2 offset:29696
    s_waitcnt lgkmcnt(0)
    v_mfma_f32_16x16x32_bf16 v[48:51], a[208:211], v[28:31], v[48:51]
    v_mfma_f32_16x16x32_bf16 v[52:55], a[212:215], v[28:31], v[52:55]
    v_mfma_f32_16x16x32_bf16 v[56:59], a[216:219], v[28:31], v[56:59]
    v_mfma_f32_16x16x32_bf16 v[60:63], a[220:223], v[28:31], v[60:63]
    ds_read_b128 v[24:27], v2 offset:30720
    s_waitcnt lgkmcnt(0)
    v_mfma_f32_16x16x32_bf16 v[48:51], a[224:227], v[24:27], v[48:51]
    v_mfma_f32_16x16x32_bf16 v[52:55], a[228:231], v[24:27], v[52:55]
    v_mfma_f32_16x16x32_bf16 v[56:59], a[232:235], v[24:27], v[56:59]
    v_mfma_f32_16x16x32_bf16 v[60:63], a[236:239], v[24:27], v[60:63]
    ds_read_b128 v[28:31], v2 offset:31744
    s_waitcnt lgkmcnt(0)
    v_mfma_f32_16x16x32_bf16 v[48:51], a[240:243], v[28:31], v[48:51]
    v_mfma_f32_16x16x32_bf16 v[52:55], a[244:247], v[28:31], v[52:55]
    v_mfma_f32_16x16x32_bf16 v[56:59], a[248:251], v[28:31], v[56:59]
    v_mfma_f32_16x16x32_bf16 v[60:63], a[252:255], v[28:31], v[60:63]
    s_nop 4
    v_cmp_u_f32 vcc, v48, v14
    s_sub_u32 s39, s39, 1
    s_nop 3
    s_cbranch_scc1 L_back4_53
    s_cbranch_vccnz L_retry4_54
    s_branch L_back4_53
L_slow4_55:
    s_mov_b32 s39, 1000
L_retry4_57:
    s_waitcnt vmcnt(0) lgkmcnt(0)
    s_barrier
    s_add_u32 m0, s51, 0x20000
    s_nop 0
    buffer_load_dwordx4 v2, s[4:7], s52 offen offset:0 sc1 lds
    s_add_u32 m0, s51, 0x20000
    s_nop 0
    buffer_load_dwordx4 v2, s[4:7], s52 offen offset:1024 sc1 lds
    s_add_u32 m0, s51, 0x8000
    s_add_u32 s66, s50, 0x8000
    buffer_load_dwordx4 v2, s[4:7], s66 offen offset:0 sc1 lds
    s_add_u32 m0, s51, 0x8000
    s_add_u32 s66, s50, 0x8000
    buffer_load_dwordx4 v2, s[4:7], s66 offen offset:1024 sc1 lds
    s_add_u32 m0, s51, 0x8000
    s_add_u32 s66, s50, 0x8000
    buffer_load_dwordx4 v2, s[4:7], s66 offen offset:2048 sc1 lds
    s_add_u32 m0, s51, 0x8000
    s_add_u32 s66, s50, 0x8000
    buffer_load_dwordx4 v2, s[4:7], s66 offen offset:3072 sc1 lds
    s_waitcnt vmcnt(0) lgkmcnt(0)
    s_barrier
    ds_read2st64_b32 v[88:89], v4 offset0:0 offset1:1
    ds_read2st64_b32 v[90:91], v4 offset0:16 offset1:17
    ds_read2st64_b32 v[92:93], v4 offset0:32 offset1:33
    ds_read2st64_b32 v[94:95], v4 offset0:48 offset1:49
    s_waitcnt lgkmcnt(0)
    v_add_f32 v88, v88, v89
    v_add_f32 v90, v90, v91
    v_add_f32 v92, v92, v93
    v_add_f32 v94, v94, v95
    v_add_f32 v88, v88, v90
    v_add_f32 v92, v92, v94
    v_add_f32 v88, v88, v92
    v_mov_b32 v89, v88
    s_nop 1
    v_permlane16_swap_b32 v88, v89
    s_nop 0
    v_add_f32 v88, v88, v89
    v_mov_b32 v89, v88
    s_nop 1
    v_permlane32_swap_b32 v88, v89
    s_nop 0
    v_mul_f32 v92, 0xbb000000, v88
    v_mul_f32 v94, 0x3b000000, v89
    v_add_f32 v94, 0x3727c5ac, v94
    v_fma_f32 v94, -v92, v92, v94
    v_rsq_f32 v93, v94
    s_nop 0
    v_mul_f32 v93, 0xbfb8aa3b, v93
    ds_write_b96 v6, v[92:94] offset:0
    s_waitcnt vmcnt(0) lgkmcnt(0)
    s_barrier
    ds_read_b96 v[8:10], v7 offset:512
    ds_read_b128 v[24:27], v2 offset:32768
    s_waitcnt lgkmcnt(0)
    v_mfma_f32_16x16x32_bf16 v[32:35], a[0:3], v[24:27], 0
    v_mfma_f32_16x16x32_bf16 v[36:39], a[4:7], v[24:27], 0
    v_mfma_f32_16x16x32_bf16 v[40:43], a[8:11], v[24:27], 0
    v_mfma_f32_16x16x32_bf16 v[44:47], a[12:15], v[24:27], 0
    ds_read_b128 v[28:31], v2 offset:33792
    s_waitcnt lgkmcnt(0)
    v_mfma_f32_16x16x32_bf16 v[32:35], a[16:19], v[28:31], v[32:35]
    v_mfma_f32_16x16x32_bf16 v[36:39], a[20:23], v[28:31], v[36:39]
    v_mfma_f32_16x16x32_bf16 v[40:43], a[24:27], v[28:31], v[40:43]
    v_mfma_f32_16x16x32_bf16 v[44:47], a[28:31], v[28:31], v[44:47]
    ds_read_b128 v[24:27], v2 offset:34816
    s_waitcnt lgkmcnt(0)
    v_mfma_f32_16x16x32_bf16 v[32:35], a[32:35], v[24:27], v[32:35]
    v_mfma_f32_16x16x32_bf16 v[36:39], a[36:39], v[24:27], v[36:39]
    v_mfma_f32_16x16x32_bf16 v[40:43], a[40:43], v[24:27], v[40:43]
    v_mfma_f32_16x16x32_bf16 v[44:47], a[44:47], v[24:27], v[44:47]
    ds_read_b128 v[28:31], v2 offset:35840
    s_waitcnt lgkmcnt(0)
    v_mfma_f32_16x16x32_bf16 v[32:35], a[48:51], v[28:31], v[32:35]
    v_mfma_f32_16x16x32_bf16 v[36:39], a[52:55], v[28:31], v[36:39]
    v_mfma_f32_16x16x32_bf16 v[40:43], a[56:59], v[28:31], v[40:43]
    v_mfma_f32_16x16x32_bf16 v[44:47], a[60:63], v[28:31], v[44:47]
    ds_read_b128 v[24:27], v2 offset:36864
    s_waitcnt lgkmcnt(0)
    v_mfma_f32_16x16x32_bf16 v[32:35], a[64:67], v[24:27], v[32:35]
    v_mfma_f32_16x16x32_bf16 v[36:39], a[68:71], v[24:27], v[36:39]
    v_mfma_f32_16x16x32_bf16 v[40:43], a[72:75], v[24:27], v[40:43]
    v_mfma_f32_16x16x32_bf16 v[44:47], a[76:79], v[24:27], v[44:47]
    ds_read_b128 v[28:31], v2 offset:37888
    s_waitcnt lgkmcnt(0)
    v_mfma_f32_16x16x32_bf16 v[32:35], a[80:83], v[28:31], v[32:35]
    v_mfma_f32_16x16x32_bf16 v[36:39], a[84:87], v[28:31], v[36:39]
    v_mfma_f32_16x16x32_bf16 v[40:43], a[88:91], v[28:31], v[40:43]
    v_mfma_f32_16x16x32_bf16 v[44:47], a[92:95], v[28:31], v[44:47]
    ds_read_b128 v[24:27], v2 offset:38912
    s_waitcnt lgkmcnt(0)
    v_mfma_f32_16x16x32_bf16 v[32:35], a[96:99], v[24:27], v[32:35]
    v_mfma_f32_16x16x32_bf16 v[36:39], a[100:103], v[24:27], v[36:39]
    v_mfma_f32_16x16x32_bf16 v[40:43], a[104:107], v[24:27], v[40:43]
    v_mfma_f32_16x16x32_bf16 v[44:47], a[108:111], v[24:27], v[44:47]
    ds_read_b128 v[28:31], v2 offset:39936
    s_waitcnt lgkmcnt(0)
    v_mfma_f32_16x16x32_bf16 v[32:35], a[112:115], v[28:31], v[32:35]
    v_mfma_f32_16x16x32_bf16 v[36:39], a[116:119], v[28:31], v[36:39]
    v_mfma_f32_16x16x32_bf16 v[40:43], a[120:123], v[28:31], v[40:43]
    v_mfma_f32_16x16x32_bf16 v[44:47], a[124:127], v[28:31], v[44:47]
    ds_read_b128 v[24:27], v2 offset:40960
    s_waitcnt lgkmcnt(0)
    v_mfma_f32_16x16x32_bf16 v[32:35], a[128:131], v[24:27], v[32:35]
    v_mfma_f32_16x16x32_bf16 v[36:39], a[132:135], v[24:27], v[36:39]
    v_mfma_f32_16x16x32_bf16 v[40:43], a[136:139], v[24:27], v[40:43]
    v_mfma_f32_16x16x32_bf16 v[44:47], a[140:143], v[24:27], v[44:47]
    ds_read_b128 v[28:31], v2 offset:41984
    s_waitcnt lgkmcnt(0)
    v_mfma_f32_16x16x32_bf16 v[32:35], a[144:147], v[28:31], v[32:35]
    v_mfma_f32_16x16x32_bf16 v[36:39], a[148:151], v[28:31], v[36:39]
    v_mfma_f32_16x16x32_bf16 v[40:43], a[152:155], v[28:31], v[40:43]
    v_mfma_f32_16x16x32_bf16 v[44:47], a[156:159], v[28:31], v[44:47]
    ds_read_b128 v[24:27], v2 offset:43008
    s_waitcnt lgkmcnt(0)
    v_mfma_f32_16x16x32_bf16 v[32:35], a[160:163], v[24:27], v[32:35]
    v_mfma_f32_16x16x32_bf16 v[36:39], a[164:167], v[24:27], v[36:39]
    v_mfma_f32_16x16x32_bf16 v[40:43], a[168:171], v[24:27], v[40:43]
    v_mfma_f32_16x16x32_bf16 v[44:47], a[172:175], v[24:27], v[44:47]
    ds_read_b128 v[28:31], v2 offset:44032
    s_waitcnt lgkmcnt(0)
    v_mfma_f32_16x16x32_bf16 v[32:35], a[176:179], v[28:31], v[32:35]
    v_mfma_f32_16x16x32_bf16 v[36:39], a[180:183], v[28:31], v[36:39]
    v_mfma_f32_16x16x32_bf16 v[40:43], a[184:187], v[28:31], v[40:43]
    v_mfma_f32_16x16x32_bf16 v[44:47], a[188:191], v[28:31], v[44:47]
    ds_read_b128 v[24:27], v2 offset:45056
    s_waitcnt lgkmcnt(0)
    v_mfma_f32_16x16x32_bf16 v[32:35], a[192:195], v[24:27], v[32:35]
    v_mfma_f32_16x16x32_bf16 v[36:39], a[196:199], v[24:27], v[36:39]
    v_mfma_f32_16x16x32_bf16 v[40:43], a[200:203], v[24:27], v[40:43]
    v_mfma_f32_16x16x32_bf16 v[44:47], a[204:207], v[24:27], v[44:47]
    ds_read_b128 v[28:31], v2 offset:46080
    s_waitcnt lgkmcnt(0)
    v_mfma_f32_16x16x32_bf16 v[32:35], a[208:211], v[28:31], v[32:35]
    v_mfma_f32_16x16x32_bf16 v[36:39], a[212:215], v[28:31], v[36:39]
    v_mfma_f32_16x16x32_bf16 v[40:43], a[216:219], v[28:31], v[40:43]
    v_mfma_f32_16x16x32_bf16 v[44:47], a[220:223], v[28:31], v[44:47]
    ds_read_b128 v[24:27], v2 offset:47104
    s_waitcnt lgkmcnt(0)
    v_mfma_f32_16x16x32_bf16 v[32:35], a[224:227], v[24:27], v[32:35]
    v_mfma_f32_16x16x32_bf16 v[36:39], a[228:231], v[24:27], v[36:39]
    v_mfma_f32_16x16x32_bf16 v[40:43], a[232:235], v[24:27], v[40:43]
    v_mfma_f32_16x16x32_bf16 v[44:47], a[236:239], v[24:27], v[44:47]
    ds_read_b128 v[28:31], v2 offset:48128
    s_waitcnt lgkmcnt(0)
    v_mfma_f32_16x16x32_bf16 v[32:35], a[240:243], v[28:31], v[32:35]
    v_mfma_f32_16x16x32_bf16 v[36:39], a[244:247], v[28:31], v[36:39]
    v_mfma_f32_16x16x32_bf16 v[40:43], a[248:251], v[28:31], v[40:43]
    v_mfma_f32_16x16x32_bf16 v[44:47], a[252:255], v[28:31], v[44:47]
    s_nop 4
    v_cmp_u_f32 vcc, v32, v10
    s_sub_u32 s39, s39, 1
    s_nop 3
    s_cbranch_scc1 L_back4_56
    s_cbranch_vccnz L_retry4_57
    s_branch L_back4_56
L_slow4_58:
    s_mov_b32 s39, 1000
L_retry4_60:
    s_waitcnt vmcnt(0) lgkmcnt(0)
    s_barrier
    s_add_u32 m0, s51, 0x20000
    s_nop 0
    buffer_load_dwordx4 v2, s[4:7], s52 offen offset:0 sc1 lds
    s_add_u32 m0, s51, 0x20000
    s_nop 0
    buffer_load_dwordx4 v2, s[4:7], s52 offen offset:1024 sc1 lds
    s_add_u32 m0, s51, 0xc000
    s_add_u32 s66, s50, 0xc000
    buffer_load_dwordx4 v2, s[4:7], s66 offen offset:0 sc1 lds
    s_add_u32 m0, s51, 0xc000
    s_add_u32 s66, s50, 0xc000
    buffer_load_dwordx4 v2, s[4:7], s66 offen offset:1024 sc1 lds
    s_add_u32 m0, s51, 0xc000
    s_add_u32 s66, s50, 0xc000
    buffer_load_dwordx4 v2, s[4:7], s66 offen offset:2048 sc1 lds
    s_add_u32 m0, s51, 0xc000
    s_add_u32 s66, s50, 0xc000
    buffer_load_dwordx4 v2, s[4:7], s66 offen offset:3072 sc1 lds
    s_waitcnt vmcnt(0) lgkmcnt(0)
    s_barrier
    ds_read2st64_b32 v[88:89], v4 offset0:0 offset1:1
    ds_read2st64_b32 v[90:91], v4 offset0:16 offset1:17
    ds_read2st64_b32 v[92:93], v4 offset0:32 offset1:33
    ds_read2st64_b32 v[94:95], v4 offset0:48 offset1:49
    s_waitcnt lgkmcnt(0)
    v_add_f32 v88, v88, v89
    v_add_f32 v90, v90, v91
    v_add_f32 v92, v92, v93
    v_add_f32 v94, v94, v95
    v_add_f32 v88, v88, v90
    v_add_f32 v92, v92, v94
    v_add_f32 v88, v88, v92
    v_mov_b32 v89, v88
    s_nop 1
    v_permlane16_swap_b32 v88, v89
    s_nop 0
    v_add_f32 v88, v88, v89
    v_mov_b32 v89, v88
    s_nop 1
    v_permlane32_swap_b32 v88, v89
    s_nop 0
    v_mul_f32 v92, 0xbb000000, v88
    v_mul_f32 v94, 0x3b000000, v89
    v_add_f32 v94, 0x3727c5ac, v94
    v_fma_f32 v94, -v92, v92, v94
    v_rsq_f32 v93, v94
    s_nop 0
    v_mul_f32 v93, 0xbfb8aa3b, v93
    ds_write_b96 v6, v[92:94] offset:0
    s_waitcnt vmcnt(0) lgkmcnt(0)
    s_barrier
    ds_read_b96 v[12:14], v7 offset:768
    ds_read_b128 v[24:27], v2 offset:49152
    s_waitcnt lgkmcnt(0)
    v_mfma_f32_16x16x32_bf16 v[48:51], a[0:3], v[24:27], 0
    v_mfma_f32_16x16x32_bf16 v[52:55], a[4:7], v[24:27], 0
    v_mfma_f32_16x16x32_bf16 v[56:59], a[8:11], v[24:27], 0
    v_mfma_f32_16x16x32_bf16 v[60:63], a[12:15], v[24:27], 0
    ds_read_b128 v[28:31], v2 offset:50176
    s_waitcnt lgkmcnt(0)
    v_mfma_f32_16x16x32_bf16 v[48:51], a[16:19], v[28:31], v[48:51]
    v_mfma_f32_16x16x32_bf16 v[52:55], a[20:23], v[28:31], v[52:55]
    v_mfma_f32_16x16x32_bf16 v[56:59], a[24:27], v[28:31], v[56:59]
    v_mfma_f32_16x16x32_bf16 v[60:63], a[28:31], v[28:31], v[60:63]
    ds_read_b128 v[24:27], v2 offset:51200
    s_waitcnt lgkmcnt(0)
    v_mfma_f32_16x16x32_bf16 v[48:51], a[32:35], v[24:27], v[48:51]
    v_mfma_f32_16x16x32_bf16 v[52:55], a[36:39], v[24:27], v[52:55]
    v_mfma_f32_16x16x32_bf16 v[56:59], a[40:43], v[24:27], v[56:59]
    v_mfma_f32_16x16x32_bf16 v[60:63], a[44:47], v[24:27], v[60:63]
    ds_read_b128 v[28:31], v2 offset:52224
    s_waitcnt lgkmcnt(0)
    v_mfma_f32_16x16x32_bf16 v[48:51], a[48:51], v[28:31], v[48:51]
    v_mfma_f32_16x16x32_bf16 v[52:55], a[52:55], v[28:31], v[52:55]
    v_mfma_f32_16x16x32_bf16 v[56:59], a[56:59], v[28:31], v[56:59]
    v_mfma_f32_16x16x32_bf16 v[60:63], a[60:63], v[28:31], v[60:63]
    ds_read_b128 v[24:27], v2 offset:53248
    s_waitcnt lgkmcnt(0)
    v_mfma_f32_16x16x32_bf16 v[48:51], a[64:67], v[24:27], v[48:51]
    v_mfma_f32_16x16x32_bf16 v[52:55], a[68:71], v[24:27], v[52:55]
    v_mfma_f32_16x16x32_bf16 v[56:59], a[72:75], v[24:27], v[56:59]
    v_mfma_f32_16x16x32_bf16 v[60:63], a[76:79], v[24:27], v[60:63]
    ds_read_b128 v[28:31], v2 offset:54272
    s_waitcnt lgkmcnt(0)
    v_mfma_f32_16x16x32_bf16 v[48:51], a[80:83], v[28:31], v[48:51]
    v_mfma_f32_16x16x32_bf16 v[52:55], a[84:87], v[28:31], v[52:55]
    v_mfma_f32_16x16x32_bf16 v[56:59], a[88:91], v[28:31], v[56:59]
    v_mfma_f32_16x16x32_bf16 v[60:63], a[92:95], v[28:31], v[60:63]
    ds_read_b128 v[24:27], v2 offset:55296
    s_waitcnt lgkmcnt(0)
    v_mfma_f32_16x16x32_bf16 v[48:51], a[96:99], v[24:27], v[48:51]
    v_mfma_f32_16x16x32_bf16 v[52:55], a[100:103], v[24:27], v[52:55]
    v_mfma_f32_16x16x32_bf16 v[56:59], a[104:107], v[24:27], v[56:59]
    v_mfma_f32_16x16x32_bf16 v[60:63], a[108:111], v[24:27], v[60:63]
    ds_read_b128 v[28:31], v2 offset:56320
    s_waitcnt lgkmcnt(0)
    v_mfma_f32_16x16x32_bf16 v[48:51], a[112:115], v[28:31], v[48:51]
    v_mfma_f32_16x16x32_bf16 v[52:55], a[116:119], v[28:31], v[52:55]
    v_mfma_f32_16x16x32_bf16 v[56:59], a[120:123], v[28:31], v[56:59]
    v_mfma_f32_16x16x32_bf16 v[60:63], a[124:127], v[28:31], v[60:63]
    ds_read_b128 v[24:27], v2 offset:57344
    s_waitcnt lgkmcnt(0)
    v_mfma_f32_16x16x32_bf16 v[48:51], a[128:131], v[24:27], v[48:51]
    v_mfma_f32_16x16x32_bf16 v[52:55], a[132:135], v[24:27], v[52:55]
    v_mfma_f32_16x16x32_bf16 v[56:59], a[136:139], v[24:27], v[56:59]
    v_mfma_f32_16x16x32_bf16 v[60:63], a[140:143], v[24:27], v[60:63]
    ds_read_b128 v[28:31], v2 offset:58368
    s_waitcnt lgkmcnt(0)
    v_mfma_f32_16x16x32_bf16 v[48:51], a[144:147], v[28:31], v[48:51]
    v_mfma_f32_16x16x32_bf16 v[52:55], a[148:151], v[28:31], v[52:55]
    v_mfma_f32_16x16x32_bf16 v[56:59], a[152:155], v[28:31], v[56:59]
    v_mfma_f32_16x16x32_bf16 v[60:63], a[156:159], v[28:31], v[60:63]
    ds_read_b128 v[24:27], v2 offset:59392
    s_waitcnt lgkmcnt(0)
    v_mfma_f32_16x16x32_bf16 v[48:51], a[160:163], v[24:27], v[48:51]
    v_mfma_f32_16x16x32_bf16 v[52:55], a[164:167], v[24:27], v[52:55]
    v_mfma_f32_16x16x32_bf16 v[56:59], a[168:171], v[24:27], v[56:59]
    v_mfma_f32_16x16x32_bf16 v[60:63], a[172:175], v[24:27], v[60:63]
    ds_read_b128 v[28:31], v2 offset:60416
    s_waitcnt lgkmcnt(0)
    v_mfma_f32_16x16x32_bf16 v[48:51], a[176:179], v[28:31], v[48:51]
    v_mfma_f32_16x16x32_bf16 v[52:55], a[180:183], v[28:31], v[52:55]
    v_mfma_f32_16x16x32_bf16 v[56:59], a[184:187], v[28:31], v[56:59]
    v_mfma_f32_16x16x32_bf16 v[60:63], a[188:191], v[28:31], v[60:63]
    ds_read_b128 v[24:27], v2 offset:61440
    s_waitcnt lgkmcnt(0)
    v_mfma_f32_16x16x32_bf16 v[48:51], a[192:195], v[24:27], v[48:51]
    v_mfma_f32_16x16x32_bf16 v[52:55], a[196:199], v[24:27], v[52:55]
    v_mfma_f32_16x16x32_bf16 v[56:59], a[200:203], v[24:27], v[56:59]
    v_mfma_f32_16x16x32_bf16 v[60:63], a[204:207], v[24:27], v[60:63]
    ds_read_b128 v[28:31], v2 offset:62464
    s_waitcnt lgkmcnt(0)
    v_mfma_f32_16x16x32_bf16 v[48:51], a[208:211], v[28:31], v[48:51]
    v_mfma_f32_16x16x32_bf16 v[52:55], a[212:215], v[28:31], v[52:55]
    v_mfma_f32_16x16x32_bf16 v[56:59], a[216:219], v[28:31], v[56:59]
    v_mfma_f32_16x16x32_bf16 v[60:63], a[220:223], v[28:31], v[60:63]
    ds_read_b128 v[24:27], v2 offset:63488
    s_waitcnt lgkmcnt(0)
    v_mfma_f32_16x16x32_bf16 v[48:51], a[224:227], v[24:27], v[48:51]
    v_mfma_f32_16x16x32_bf16 v[52:55], a[228:231], v[24:27], v[52:55]
    v_mfma_f32_16x16x32_bf16 v[56:59], a[232:235], v[24:27], v[56:59]
    v_mfma_f32_16x16x32_bf16 v[60:63], a[236:239], v[24:27], v[60:63]
    ds_read_b128 v[28:31], v2 offset:64512
    s_waitcnt lgkmcnt(0)
    v_mfma_f32_16x16x32_bf16 v[48:51], a[240:243], v[28:31], v[48:51]
    v_mfma_f32_16x16x32_bf16 v[52:55], a[244:247], v[28:31], v[52:55]
    v_mfma_f32_16x16x32_bf16 v[56:59], a[248:251], v[28:31], v[56:59]
    v_mfma_f32_16x16x32_bf16 v[60:63], a[252:255], v[28:31], v[60:63]
    s_nop 4
    v_cmp_u_f32 vcc, v48, v14
    s_sub_u32 s39, s39, 1
    s_nop 3
    s_cbranch_scc1 L_back4_59
    s_cbranch_vccnz L_retry4_60
    s_branch L_back4_59
L_slow_70:
    s_mov_b32 s39, 200
L_retry_78:
    s_add_u32 s66, s58, 0x38000
    buffer_load_dwordx4 a[192:195], v2, s[4:7], s66 offen offset:0 sc1
    s_add_u32 s66, s58, 0x38000
    buffer_load_dwordx4 a[196:199], v2, s[4:7], s66 offen offset:1024 sc1
    s_add_u32 s66, s58, 0x38000
    buffer_load_dwordx4 a[200:203], v2, s[4:7], s66 offen offset:2048 sc1
    s_add_u32 s66, s58, 0x38000
    buffer_load_dwordx4 a[204:207], v2, s[4:7], s66 offen offset:3072 sc1
    s_add_u32 s66, s58, 0x39000
    buffer_load_dwordx4 a[208:211], v2, s[4:7], s66 offen offset:0 sc1
    s_add_u32 s66, s58, 0x39000
    buffer_load_dwordx4 a[212:215], v2, s[4:7], s66 offen offset:1024 sc1
    s_add_u32 s66, s58, 0x39000
    buffer_load_dwordx4 a[216:219], v2, s[4:7], s66 offen offset:2048 sc1
    s_add_u32 s66, s58, 0x39000
    buffer_load_dwordx4 a[220:223], v2, s[4:7], s66 offen offset:3072 sc1
    s_add_u32 s66, s58, 0x3a000
    buffer_load_dwordx4 a[224:227], v2, s[4:7], s66 offen offset:0 sc1
    s_add_u32 s66, s58, 0x3a000
    buffer_load_dwordx4 a[228:231], v2, s[4:7], s66 offen offset:1024 sc1
    s_add_u32 s66, s58, 0x3a000
    buffer_load_dwordx4 a[232:235], v2, s[4:7], s66 offen offset:2048 sc1
    s_add_u32 s66, s58, 0x3a000
    buffer_load_dwordx4 a[236:239], v2, s[4:7], s66 offen offset:3072 sc1
    s_add_u32 s66, s58, 0x3b000
    buffer_load_dwordx4 a[240:243], v2, s[4:7], s66 offen offset:0 sc1
    s_add_u32 s66, s58, 0x3b000
    buffer_load_dwordx4 a[244:247], v2, s[4:7], s66 offen offset:1024 sc1
    s_waitcnt vmcnt(0) lgkmcnt(0)
    v_mfma_f32_16x16x32_bf16 v[32:35], v[112:115], a[192:195], 0
    v_mfma_f32_16x16x32_bf16 v[36:39], v[116:119], a[192:195], 0
    v_mfma_f32_16x16x32_bf16 v[40:43], v[120:123], a[192:195], 0
    v_mfma_f32_16x16x32_bf16 v[44:47], v[124:127], a[192:195], 0
    v_mfma_f32_16x16x32_bf16 v[32:35], v[128:131], a[196:199], v[32:35]
    v_mfma_f32_16x16x32_bf16 v[36:39], v[132:135], a[196:199], v[36:39]
    v_mfma_f32_16x16x32_bf16 v[40:43], v[136:139], a[196:199], v[40:43]
    v_mfma_f32_16x16x32_bf16 v[44:47], v[140:143], a[196:199], v[44:47]
    v_mfma_f32_16x16x32_bf16 v[32:35], v[144:147], a[200:203], v[32:35]
    v_mfma_f32_16x16x32_bf16 v[36:39], v[148:151], a[200:203], v[36:39]
    v_mfma_f32_16x16x32_bf16 v[40:43], v[152:155], a[200:203], v[40:43]
    v_mfma_f32_16x16x32_bf16 v[44:47], v[156:159], a[200:203], v[44:47]
    v_mfma_f32_16x16x32_bf16 v[32:35], v[160:163], a[204:207], v[32:35]
    v_mfma_f32_16x16x32_bf16 v[36:39], v[164:167], a[204:207], v[36:39]
    v_mfma_f32_16x16x32_bf16 v[40:43], v[168:171], a[204:207], v[40:43]
    v_mfma_f32_16x16x32_bf16 v[44:47], v[172:175], a[204:207], v[44:47]
    v_mfma_f32_16x16x32_bf16 v[32:35], v[176:179], a[208:211], v[32:35]
    v_mfma_f32_16x16x32_bf16 v[36:39], v[180:183], a[208:211], v[36:39]
    v_mfma_f32_16x16x32_bf16 v[40:43], v[184:187], a[208:211], v[40:43]
    v_mfma_f32_16x16x32_bf16 v[44:47], v[188:191], a[208:211], v[44:47]
    v_mfma_f32_16x16x32_bf16 v[32:35], v[192:195], a[212:215], v[32:35]
    v_mfma_f32_16x16x32_bf16 v[36:39], v[196:199], a[212:215], v[36:39]
    v_mfma_f32_16x16x32_bf16 v[40:43], v[200:203], a[212:215], v[40:43]
    v_mfma_f32_16x16x32_bf16 v[44:47], v[204:207], a[212:215], v[44:47]
    v_mfma_f32_16x16x32_bf16 v[32:35], v[208:211], a[216:219], v[32:35]
    v_mfma_f32_16x16x32_bf16 v[36:39], v[212:215], a[216:219], v[36:39]
    v_mfma_f32_16x16x32_bf16 v[40:43], v[216:219], a[216:219], v[40:43]
    v_mfma_f32_16x16x32_bf16 v[44:47], v[220:223], a[216:219], v[44:47]
    v_mfma_f32_16x16x32_bf16 v[32:35], v[224:227], a[220:223], v[32:35]
    v_mfma_f32_16x16x32_bf16 v[36:39], v[228:231], a[220:223], v[36:39]
    v_mfma_f32_16x16x32_bf16 v[40:43], v[232:235], a[220:223], v[40:43]
    v_mfma_f32_16x16x32_bf16 v[44:47], v[236:239], a[220:223], v[44:47]
    v_mfma_f32_16x16x32_bf16 v[32:35], v[240:243], a[224:227], v[32:35]
    v_mfma_f32_16x16x32_bf16 v[36:39], v[244:247], a[224:227], v[36:39]
    v_mfma_f32_16x16x32_bf16 v[40:43], v[248:251], a[224:227], v[40:43]
    v_mfma_f32_16x16x32_bf16 v[44:47], v[252:255], a[224:227], v[44:47]
    v_mfma_f32_16x16x32_bf16 v[32:35], a[56:59], a[228:231], v[32:35]
    v_mfma_f32_16x16x32_bf16 v[36:39], a[60:63], a[228:231], v[36:39]
    v_mfma_f32_16x16x32_bf16 v[40:43], a[64:67], a[228:231], v[40:43]
    v_mfma_f32_16x16x32_bf16 v[44:47], a[68:71], a[228:231], v[44:47]
    v_mfma_f32_16x16x32_bf16 v[32:35], a[72:75], a[232:235], v[32:35]
    v_mfma_f32_16x16x32_bf16 v[36:39], a[76:79], a[232:235], v[36:39]
    v_mfma_f32_16x16x32_bf16 v[40:43], a[80:83], a[232:235], v[40:43]
    v_mfma_f32_16x16x32_bf16 v[44:47], a[84:87], a[232:235], v[44:47]
    v_mfma_f32_16x16x32_bf16 v[32:35], a[88:91], a[236:239], v[32:35]
    v_mfma_f32_16x16x32_bf16 v[36:39], a[92:95], a[236:239], v[36:39]
    v_mfma_f32_16x16x32_bf16 v[40:43], a[96:99], a[236:239], v[40:43]
    v_mfma_f32_16x16x32_bf16 v[44:47], a[100:103], a[236:239], v[44:47]
    v_mfma_f32_16x16x32_bf16 v[32:35], a[104:107], a[240:243], v[32:35]
    v_mfma_f32_16x16x32_bf16 v[36:39], a[108:111], a[240:243], v[36:39]
    v_mfma_f32_16x16x32_bf16 v[40:43], a[112:115], a[240:243], v[40:43]
    v_mfma_f32_16x16x32_bf16 v[44:47], a[116:119], a[240:243], v[44:47]
    v_mfma_f32_16x16x32_bf16 v[32:35], a[120:123], a[244:247], v[32:35]
    v_mfma_f32_16x16x32_bf16 v[36:39], a[124:127], a[244:247], v[36:39]
    v_mfma_f32_16x16x32_bf16 v[40:43], a[128:131], a[244:247], v[40:43]
    v_mfma_f32_16x16x32_bf16 v[44:47], a[132:135], a[244:247], v[44:47]
    s_sub_u32 s39, s39, 1
    s_nop 6
    s_cbranch_scc1 L_back_71
    v_cmp_u_f32 vcc, v32, v32
    s_nop 4
    s_cbranch_vccnz L_retry_78
    s_branch L_back_71
L_slow_72:
    s_mov_b32 s39, 200
L_retry_79:
    s_add_u32 s66, s58, 0x54000
    buffer_load_dwordx4 a[0:3], v2, s[4:7], s66 offen offset:0 sc1
    s_add_u32 s66, s58, 0x54000
    buffer_load_dwordx4 a[4:7], v2, s[4:7], s66 offen offset:1024 sc1
    s_add_u32 s66, s58, 0x54000
    buffer_load_dwordx4 a[8:11], v2, s[4:7], s66 offen offset:2048 sc1
    s_add_u32 s66, s58, 0x54000
    buffer_load_dwordx4 a[12:15], v2, s[4:7], s66 offen offset:3072 sc1
    s_add_u32 s66, s58, 0x55000
    buffer_load_dwordx4 a[16:19], v2, s[4:7], s66 offen offset:0 sc1
    s_add_u32 s66, s58, 0x55000
    buffer_load_dwordx4 a[20:23], v2, s[4:7], s66 offen offset:1024 sc1
    s_add_u32 s66, s58, 0x55000
    buffer_load_dwordx4 a[24:27], v2, s[4:7], s66 offen offset:2048 sc1
    s_add_u32 s66, s58, 0x55000
    buffer_load_dwordx4 a[28:31], v2, s[4:7], s66 offen offset:3072 sc1
    s_add_u32 s66, s58, 0x56000
    buffer_load_dwordx4 a[32:35], v2, s[4:7], s66 offen offset:0 sc1
    s_add_u32 s66, s58, 0x56000
    buffer_load_dwordx4 a[36:39], v2, s[4:7], s66 offen offset:1024 sc1
    s_add_u32 s66, s58, 0x56000
    buffer_load_dwordx4 a[40:43], v2, s[4:7], s66 offen offset:2048 sc1
    s_add_u32 s66, s58, 0x56000
    buffer_load_dwordx4 a[44:47], v2, s[4:7], s66 offen offset:3072 sc1
    s_add_u32 s66, s58, 0x57000
    buffer_load_dwordx4 a[48:51], v2, s[4:7], s66 offen offset:0 sc1
    s_add_u32 s66, s58, 0x57000
    buffer_load_dwordx4 a[52:55], v2, s[4:7], s66 offen offset:1024 sc1
    s_waitcnt vmcnt(0) lgkmcnt(0)
    v_mfma_f32_16x16x32_bf16 v[48:51], v[112:115], a[0:3], 0
    v_mfma_f32_16x16x32_bf16 v[52:55], v[116:119], a[0:3], 0
    v_mfma_f32_16x16x32_bf16 v[56:59], v[120:123], a[0:3], 0
    v_mfma_f32_16x16x32_bf16 v[60:63], v[124:127], a[0:3], 0
    v_mfma_f32_16x16x32_bf16 v[48:51], v[128:131], a[4:7], v[48:51]
    v_mfma_f32_16x16x32_bf16 v[52:55], v[132:135], a[4:7], v[52:55]
    v_mfma_f32_16x16x32_bf16 v[56:59], v[136:139], a[4:7], v[56:59]
    v_mfma_f32_16x16x32_bf16 v[60:63], v[140:143], a[4:7], v[60:63]
    v_mfma_f32_16x16x32_bf16 v[48:51], v[144:147], a[8:11], v[48:51]
    v_mfma_f32_16x16x32_bf16 v[52:55], v[148:151], a[8:11], v[52:55]
    v_mfma_f32_16x16x32_bf16 v[56:59], v[152:155], a[8:11], v[56:59]
    v_mfma_f32_16x16x32_bf16 v[60:63], v[156:159], a[8:11], v[60:63]
    v_mfma_f32_16x16x32_bf16 v[48:51], v[160:163], a[12:15], v[48:51]
    v_mfma_f32_16x16x32_bf16 v[52:55], v[164:167], a[12:15], v[52:55]
    v_mfma_f32_16x16x32_bf16 v[56:59], v[168:171], a[12:15], v[56:59]
    v_mfma_f32_16x16x32_bf16 v[60:63], v[172:175], a[12:15], v[60:63]
    v_mfma_f32_16x16x32_bf16 v[48:51], v[176:179], a[16:19], v[48:51]
    v_mfma_f32_16x16x32_bf16 v[52:55], v[180:183], a[16:19], v[52:55]
    v_mfma_f32_16x16x32_bf16 v[56:59], v[184:187], a[16:19], v[56:59]
    v_mfma_f32_16x16x32_bf16 v[60:63], v[188:191], a[16:19], v[60:63]
    v_mfma_f32_16x16x32_bf16 v[48:51], v[192:195], a[20:23], v[48:51]
    v_mfma_f32_16x16x32_bf16 v[52:55], v[196:199], a[20:23], v[52:55]
    v_mfma_f32_16x16x32_bf16 v[56:59], v[200:203], a[20:23], v[56:59]
    v_mfma_f32_16x16x32_bf16 v[60:63], v[204:207], a[20:23], v[60:63]
    v_mfma_f32_16x16x32_bf16 v[48:51], v[208:211], a[24:27], v[48:51]
    v_mfma_f32_16x16x32_bf16 v[52:55], v[212:215], a[24:27], v[52:55]
    v_mfma_f32_16x16x32_bf16 v[56:59], v[216:219], a[24:27], v[56:59]
    v_mfma_f32_16x16x32_bf16 v[60:63], v[220:223], a[24:27], v[60:63]
    v_mfma_f32_16x16x32_bf16 v[48:51], v[224:227], a[28:31], v[48:51]
    v_mfma_f32_16x16x32_bf16 v[52:55], v[228:231], a[28:31], v[52:55]
    v_mfma_f32_16x16x32_bf16 v[56:59], v[232:235], a[28:31], v[56:59]
    v_mfma_f32_16x16x32_bf16 v[60:63], v[236:239], a[28:31], v[60:63]
    v_mfma_f32_16x16x32_bf16 v[48:51], v[240:243], a[32:35], v[48:51]
    v_mfma_f32_16x16x32_bf16 v[52:55], v[244:247], a[32:35], v[52:55]
    v_mfma_f32_16x16x32_bf16 v[56:59], v[248:251], a[32:35], v[56:59]
    v_mfma_f32_16x16x32_bf16 v[60:63], v[252:255], a[32:35], v[60:63]
    v_mfma_f32_16x16x32_bf16 v[48:51], a[56:59], a[36:39], v[48:51]
    v_mfma_f32_16x16x32_bf16 v[52:55], a[60:63], a[36:39], v[52:55]
    v_mfma_f32_16x16x32_bf16 v[56:59], a[64:67], a[36:39], v[56:59]
    v_mfma_f32_16x16x32_bf16 v[60:63], a[68:71], a[36:39], v[60:63]
    v_mfma_f32_16x16x32_bf16 v[48:51], a[72:75], a[40:43], v[48:51]
    v_mfma_f32_16x16x32_bf16 v[52:55], a[76:79], a[40:43], v[52:55]
    v_mfma_f32_16x16x32_bf16 v[56:59], a[80:83], a[40:43], v[56:59]
    v_mfma_f32_16x16x32_bf16 v[60:63], a[84:87], a[40:43], v[60:63]
    v_mfma_f32_16x16x32_bf16 v[48:51], a[88:91], a[44:47], v[48:51]
    v_mfma_f32_16x16x32_bf16 v[52:55], a[92:95], a[44:47], v[52:55]
    v_mfma_f32_16x16x32_bf16 v[56:59], a[96:99], a[44:47], v[56:59]
    v_mfma_f32_16x16x32_bf16 v[60:63], a[100:103], a[44:47], v[60:63]
    v_mfma_f32_16x16x32_bf16 v[48:51], a[104:107], a[48:51], v[48:51]
    v_mfma_f32_16x16x32_bf16 v[52:55], a[108:111], a[48:51], v[52:55]
    v_mfma_f32_16x16x32_bf16 v[56:59], a[112:115], a[48:51], v[56:59]
    v_mfma_f32_16x16x32_bf16 v[60:63], a[116:119], a[48:51], v[60:63]
    v_mfma_f32_16x16x32_bf16 v[48:51], a[120:123], a[52:55], v[48:51]
    v_mfma_f32_16x16x32_bf16 v[52:55], a[124:127], a[52:55], v[52:55]
    v_mfma_f32_16x16x32_bf16 v[56:59], a[128:131], a[52:55], v[56:59]
    v_mfma_f32_16x16x32_bf16 v[60:63], a[132:135], a[52:55], v[60:63]
    s_sub_u32 s39, s39, 1
    s_nop 6
    s_cbranch_scc1 L_back_73
    v_cmp_u_f32 vcc, v48, v48
    s_nop 4
    s_cbranch_vccnz L_retry_79
    s_branch L_back_73
L_code_end:
.section .rodata,"a"
.p2align 6
.amdhsa_kernel k1_qkv_kernel
  .amdhsa_next_free_vgpr 204
  .amdhsa_next_free_sgpr 102
  .amdhsa_accum_offset 204
  .amdhsa_group_segment_fixed_size 0
  .amdhsa_kernarg_size 80
  .amdhsa_user_sgpr_count 2
  .amdhsa_user_sgpr_kernarg_segment_ptr 1
  .amdhsa_system_sgpr_workgroup_id_x 1
.end_amdhsa_kernel
.p2align 6
.amdhsa_kernel k2_mega_kernel
  .amdhsa_next_free_vgpr 512
  .amdhsa_next_free_sgpr 102
  .amdhsa_accum_offset 256
  .amdhsa_group_segment_fixed_size 0
  .amdhsa_kernarg_size 80
  .amdhsa_user_sgpr_count 2
  .amdhsa_user_sgpr_kernarg_segment_ptr 1
  .amdhsa_system_sgpr_workgroup_id_x 1
.end_amdhsa_kernel
```
